```python
import torch

def _softmax(x, axis=-1):
    return torch.softmax(x, dim=axis)
def _gelu(x):
    return torch.nn.functional.gelu(x, approximate="tanh")
def _silu(x):
    return torch.nn.functional.silu(x)
def _sigmoid(x):
    return torch.sigmoid(x)
def _layernorm(x, axis=-1, eps=1e-5):
    m = x.mean(dim=axis, keepdim=True)
    v = x.var(dim=axis, keepdim=True, unbiased=False)
    return (x - m) / torch.sqrt(v + eps)
def _scatter_add(tgt, idx, src, axis=0):
    return tgt.clone().index_add_(axis, idx, src)
def _segment_sum(src, seg, n):
    out = torch.zeros((n,) + src.shape[1:], dtype=src.dtype)
    return out.index_add_(0, seg, src)
def _pad(x, pw):
    flat = tuple(v for pair in reversed(pw) for v in pair)
    return torch.nn.functional.pad(x, flat)

kernel_name = 'concat_heads__gqa_block_cached__mha_block_cached__near_ridge'

def setup_inputs():

    _w = (lambda a: (lambda t: t.to(torch.bfloat16) if t.is_floating_point() else t)(torch.as_tensor(a)))
    def _A_setup():
        B, Sq, D = 8, 128, 448
        Hq, Hkv, Sk, Dh = 16, 8, 512, 256
        assert Hq % Hkv == 0, (Hq, Hkv)
        return {
            "x": _w((lambda *s: torch.randn(*s, dtype=torch.bfloat16) * 0.8)(B, Sq, D)),
            "k_cache": _w((lambda *s: torch.randn(*s, dtype=torch.bfloat16) * 0.8)(B, Hkv, Sk, Dh)),
            "v_cache": _w((lambda *s: torch.randn(*s, dtype=torch.bfloat16) * 0.05)(B, Hkv, Sk, Dh)),
            "wq": _w((lambda *s: torch.randn(*s, dtype=torch.bfloat16) * 0.8)(D, Hq * Dh) * (D ** -0.5)),
            "wo": _w((lambda *s: torch.randn(*s, dtype=torch.bfloat16) * 0.05)(Hq * Dh, D) * ((Hq * Dh) ** -0.5)),
        }
    _A_in = _A_setup()

    def _B_setup():
        B, Sq, D = 8, 128, 448
        H, Sk, Dh = 16, 512, 256
        return {
            "x": _w((lambda *s: torch.randn(*s, dtype=torch.bfloat16) * 0.8)(B, Sq, D)),
            "k_cache": _w((lambda *s: torch.randn(*s, dtype=torch.bfloat16) * 0.8)(B, H, Sk, Dh)),
            "v_cache": _w((lambda *s: torch.randn(*s, dtype=torch.bfloat16) * 0.05)(B, H, Sk, Dh)),
            "wq": _w((lambda *s: torch.randn(*s, dtype=torch.bfloat16) * 0.8)(D, H * Dh) * (D ** -0.5)),
            "wo": _w((lambda *s: torch.randn(*s, dtype=torch.bfloat16) * 0.05)(H * Dh, D) * ((H * Dh) ** -0.5)),
        }
    _B_in = _B_setup()

    return {
        "A_x": _A_in["x"],
        "A_k_cache": _A_in["k_cache"],
        "A_v_cache": _A_in["v_cache"],
        "A_wq": _A_in["wq"],
        "A_wo": _A_in["wo"],
        "B_x": _B_in["x"],
        "B_k_cache": _B_in["k_cache"],
        "B_v_cache": _B_in["v_cache"],
        "B_wq": _B_in["wq"],
        "B_wo": _B_in["wo"],
    }

def reference(A_x, A_k_cache, A_v_cache, A_wq, A_wo, B_x, B_k_cache, B_v_cache, B_wq, B_wo):
    def _A_ref(x, k_cache, v_cache, wq, wo):
        B, Sq, D = x.shape
        Hq, Dh = 16, 256
        Hkv = k_cache.shape[1]
        rep = Hq // Hkv
        q = (lambda x, *d: x.permute(*d))((x @ wq).reshape(B, Sq, Hq, Dh), 0, 2, 1, 3)
        k = (lambda x, n, axis: torch.repeat_interleave(x, n, dim=axis))(k_cache, rep, axis=1)
        v = (lambda x, n, axis: torch.repeat_interleave(x, n, dim=axis))(v_cache, rep, axis=1)
        scores = torch.einsum("bhqd,bhkd->bhqk", q, k) * (Dh ** -0.5)
        p = _softmax(scores, axis=-1)
        o = torch.einsum("bhqk,bhkd->bhqd", p, v)
        return (lambda x, *d: x.permute(*d))(o, 0, 2, 1, 3).reshape(B, Sq, Hq * Dh) @ wo

    def _B_ref(x, k_cache, v_cache, wq, wo):
        B, Sq, D = x.shape
        H, Dh = 16, 256
        q = (lambda x, *d: x.permute(*d))((x @ wq).reshape(B, Sq, H, Dh), 0, 2, 1, 3)
        scores = torch.einsum("bhqd,bhkd->bhqk", q, k_cache) * (Dh ** -0.5)
        p = _softmax(scores, axis=-1)
        o = torch.einsum("bhqk,bhkd->bhqd", p, v_cache)
        return (lambda x, *d: x.permute(*d))(o, 0, 2, 1, 3).reshape(B, Sq, H * Dh) @ wo

    a = _A_ref(A_x, A_k_cache, A_v_cache, A_wq, A_wo)
    b = _B_ref(B_x, B_k_cache, B_v_cache, B_wq, B_wo)
    return torch.concatenate([a, b], axis=-1)
```

```asm
; @launch grid=(256,1,1) block=(256,1,1) lds=152080
.amdgcn_target "amdgcn-amd-amdhsa--gfx950"
.text
.globl concat_heads__gqa_block_cached__mha_block_cached__near_ridge_kernel
.p2align 8
.type concat_heads__gqa_block_cached__mha_block_cached__near_ridge_kernel,@function
concat_heads__gqa_block_cached__mha_block_cached__near_ridge_kernel:
    s_cmp_ge_u32 s2, 256
    s_cbranch_scc1 L_end
    s_andn2_b32 s50, 1, s2
    s_mul_i32 s53, s50, 40
    s_add_u32 s54, s0, s53
    s_addc_u32 s55, s1, 0
    s_load_dwordx2 s[4:5], s[54:55], 0
    s_load_dwordx2 s[8:9], s[54:55], 24
    s_getpc_b64 s[40:41]
L_pc:
    s_and_b32 s47, s2, 0xf8
    v_lshl_add_u32 v2, v0, 8, s47
    v_lshlrev_b32 v2, 4, v2
    v_min_u32 v2, L_code_end-L_pc-4, v2
    global_load_dword v255, v2, s[40:41]
    v_lshrrev_b32 v31, 6, v0
    v_and_b32 v1, 63, v0
    v_readfirstlane_b32 s3, v31
    v_lshrrev_b32 v30, 4, v1
    v_lshrrev_b32 v2, 3, v0
    v_and_b32 v3, 7, v2
    v_lshl_add_u32 v2, v31, 5, v3
    v_mul_u32_u24 v26, 896, v2
    v_and_b32 v27, 7, v1
    v_xor_b32 v28, v27, v30
    v_lshl_add_u32 v252, v28, 4, v26
    v_xor_b32 v253, 64, v252
    v_add_u32 v253, 7168, v253
    s_lshr_b32 s51, s2, 5
    s_lshl_b32 s39, s3, 12
    s_mul_i32 s47, s51, 114688
    s_mov_b32 s6, 114688
    s_mov_b32 s7, 0x20000
    s_waitcnt lgkmcnt(0)
    s_add_u32 s4, s4, s47
    s_addc_u32 s5, s5, 0
    s_and_b32 s5, s5, 0xffff
    s_add_u32 m0, s39, 0
    s_mov_b32 s45, 0
    buffer_load_dwordx4 v252, s[4:7], s45 offen lds
    s_add_u32 m0, s39, 1024
    s_nop 0
    buffer_load_dwordx4 v253, s[4:7], s45 offen lds
    s_add_u32 m0, s39, 2048
    s_mov_b32 s45, 14336
    buffer_load_dwordx4 v252, s[4:7], s45 offen lds
    s_add_u32 m0, s39, 3072
    s_nop 0
    buffer_load_dwordx4 v253, s[4:7], s45 offen lds
    s_add_u32 m0, s39, 16896
    s_mov_b32 s45, 128
    buffer_load_dwordx4 v252, s[4:7], s45 offen lds
    s_add_u32 m0, s39, 17920
    s_nop 0
    buffer_load_dwordx4 v253, s[4:7], s45 offen lds
    s_add_u32 m0, s39, 18944
    s_mov_b32 s45, 14464
    buffer_load_dwordx4 v252, s[4:7], s45 offen lds
    s_add_u32 m0, s39, 19968
    s_nop 0
    buffer_load_dwordx4 v253, s[4:7], s45 offen lds
    s_load_dwordx2 s[12:13], s[54:55], 8
    s_load_dwordx2 s[16:17], s[54:55], 16
    s_load_dwordx2 s[20:21], s[54:55], 32
    s_load_dwordx2 s[24:25], s[0:1], 96
    s_load_dwordx4 s[80:83], s[0:1], 80
    s_bfe_u32 s47, s2, 131073
    s_bfe_u32 s49, s2, 131075
    s_lshl_b32 s52, s47, 2
    s_or_b32 s52, s52, s49
    v_lshlrev_b32 v2, 9, v2
    v_lshl_add_u32 v17, v28, 4, v2
    v_lshlrev_b32 v28, 1, v30
    v_xor_b32 v28, v27, v28
    v_lshl_add_u32 v20, v28, 4, v26
    v_lshrrev_b32 v26, 5, v1
    v_and_b32 v3, 3, v3
    v_lshl_add_u32 v3, v26, 3, v3
    v_lshlrev_b32 v3, 13, v3
    v_lshl_add_u32 v254, v28, 4, v3
    v_lshrrev_b32 v35, 0, v0
    v_lshlrev_b32 v35, 16, v35
    v_and_b32 v36, 0, v0
    v_lshl_add_u32 v35, v36, 7, v35
    v_and_b32 v36, 3, v0
    s_lshl_b32 s53, s51, 13
    s_mul_i32 s38, s3, 4224
    s_lshl_b32 s46, s3, 18
    s_bfe_u32 s96, s52, 0x20001
    s_mul_i32 s96, s96, 0
    s_xor_b32 s97, s96, 128
    s_xor_b32 s98, s96, 256
    s_xor_b32 s99, s96, 384
    v_add_u32 v13, s46, v254
    s_lshl_b32 s48, s52, 9
    s_sub_u32 s10, 3670016, s48
    s_mov_b32 s11, 0x20000
    s_add_u32 s8, s8, s48
    s_addc_u32 s9, s9, 0
    s_and_b32 s9, s9, 0xffff
    s_add_u32 m0, s38, 33792
    s_add_u32 s45, s96, 0
    buffer_load_dwordx4 v13, s[8:11], s45 offen lds
    s_add_u32 m0, s38, 34848
    s_add_u32 s45, s96, 131072
    buffer_load_dwordx4 v13, s[8:11], s45 offen lds
    s_add_u32 m0, s38, 35904
    s_add_u32 s45, s96, 32768
    buffer_load_dwordx4 v13, s[8:11], s45 offen lds
    s_add_u32 m0, s38, 36960
    s_add_u32 s45, s96, 163840
    buffer_load_dwordx4 v13, s[8:11], s45 offen lds
    s_add_u32 s100, s53, s97
    buffer_load_dword v37, v35, s[8:11], s100 offen
    v_xor_b32 v18, 64, v17
    v_add_u32 v18, 0x1000, v18
    v_and_b32 v29, 15, v1
    v_lshrrev_b32 v38, 2, v0
    v_mul_u32_u24 v38, 7168, v38
    v_lshl_add_u32 v38, v36, 7, v38
    v_add_u32 v36, 3, v36
    v_lshrrev_b32 v36, 2, v36
    v_lshl_add_u32 v36, v36, 20, v38
    s_mul_i32 s49, s51, 896
    s_waitcnt lgkmcnt(0)
    s_lshl_b32 s47, s51, 4
    s_add_u32 s47, s47, s52
    s_sub_u32 s48, 1, s50
    s_lshr_b32 s48, s47, s48
    s_lshl_b32 s48, s48, 18
    s_add_u32 s12, s12, s48
    s_addc_u32 s13, s13, 0
    s_and_b32 s13, s13, 0xffff
    s_mov_b32 s14, 0x40000
    s_mov_b32 s15, 0x20000
    s_add_u32 s16, s16, s48
    s_addc_u32 s17, s17, 0
    s_and_b32 s17, s17, 0xffff
    s_mov_b32 s18, 0x40000
    s_mov_b32 s19, 0x20000
    s_mul_i32 s48, s52, 229376
    s_add_u32 s20, s20, s48
    s_addc_u32 s21, s21, 0
    s_and_b32 s21, s21, 0xffff
    s_mov_b32 s22, 229376
    s_mov_b32 s23, 0x20000
    s_add_u32 s24, s24, 0
    s_addc_u32 s25, s25, 0
    s_mov_b32 s58, s24
    s_mov_b32 s59, s25
    s_lshl_b32 s48, s50, 7
    s_add_u32 s47, s47, s48
    s_mov_b32 s48, s47
    s_mul_i32 s48, s48, 114688
    s_add_u32 s24, s24, s48
    s_addc_u32 s25, s25, 0
    s_and_b32 s25, s25, 0xffff
    s_mov_b32 s26, 114688
    s_mov_b32 s27, 0x20000
    s_mov_b32 s94, s47
    s_mov_b32 s35, 1199570944
    s_mov_b32 s42, 931135488
    s_mov_b32 s36, 1035512379
    s_mov_b32 s37, 1035512379
    s_mul_i32 s43, s3, 28672
    s_mul_i32 s48, s52, 0
    s_add_u32 s43, s43, s48
    s_add_u32 s44, s46, 3145728
    s_sub_u32 s48, s46, 524288
    s_cmp_ge_u32 s3, 2
    s_cselect_b32 s48, s48, s44
    s_cselect_b32 s44, s97, s96
    s_cselect_b32 s46, s99, s98
    s_add_u32 s44, s44, s48
    s_add_u32 s46, s46, s48
    v_mul_u32_u24 v26, 1056, v29
    v_lshl_add_u32 v32, v30, 4, v26
    v_add_u32 v33, 50688, v32
    v_add_u32 v34, 101376, v32
    v_lshlrev_b32 v26, 7, v29
    v_lshrrev_b32 v27, 1, v29
    v_xor_b32 v27, v27, v30
    v_lshl_add_u32 v4, v27, 4, v26
    v_xor_b32 v7, 64, v4
    v_add_u32 v5, 50688, v4
    v_add_u32 v6, 101376, v4
    v_add_u32 v80, s39, v4
    v_add_u32 v81, s39, v5
    v_add_u32 v82, s39, v6
    v_add_u32 v8, 50688, v7
    v_add_u32 v9, 101376, v7
    v_add_u32 v83, s39, v7
    v_add_u32 v84, s39, v8
    v_add_u32 v85, s39, v9
    v_lshrrev_b32 v26, 5, v1
    v_lshlrev_b32 v26, 4, v26
    v_lshl_add_u32 v26, v31, 2, v26
    v_and_b32 v27, 31, v1
    v_lshlrev_b32 v27, 4, v27
    v_lshl_add_u32 v19, v26, 9, v27
    v_lshlrev_b32 v16, 4, v1
    v_xor_b32 v14, s96, v19
    v_lshrrev_b32 v26, 2, v1
    v_mul_u32_u24 v26, 1056, v26
    v_and_b32 v27, 3, v1
    v_lshl_add_u32 v10, v27, 3, v26
    v_add_u32 v11, 50688, v10
    v_add_u32 v12, 101376, v10
    s_lshr_b32 s47, s94, 4
    s_mul_i32 s48, s47, 8192
    s_add_u32 s48, s48, 33554432
    s_add_u32 s84, s58, s48
    s_addc_u32 s85, s59, 0
    s_lshl_b32 s47, s47, 4
    s_add_u32 s82, s82, s47
    s_addc_u32 s83, s83, 0
    s_mul_i32 s47, s3, 2048
    s_lshl_b32 s48, s52, 7
    s_add_u32 s47, s47, s48
    v_lshl_add_u32 v2, v1, 2, s47
    v_mov_b32 v3, 0
    v_mov_b32 v23, 0
    v_mov_b32 v24, 0
    v_mov_b32 v21, 1
    v_lshrrev_b32 v26, 5, v1
    v_mul_u32_u24 v26, 1056, v26
    v_bfe_u32 v27, v1, 2, 3
    v_lshl_add_u32 v26, v27, 7, v26
    v_and_b32 v28, 3, v1
    v_lshl_add_u32 v26, v28, 3, v26
    v_lshrrev_b32 v27, 1, v27
    v_lshl_add_u32 v240, v27, 5, v26
    v_xor_b32 v28, 1, v27
    v_lshl_add_u32 v241, v28, 5, v26
    v_xor_b32 v28, 2, v27
    v_lshl_add_u32 v242, v28, 5, v26
    v_xor_b32 v28, 3, v27
    v_lshl_add_u32 v243, v28, 5, v26
    v_add_u32 v244, 50688, v240
    v_add_u32 v245, 50688, v241
    v_add_u32 v246, 50688, v242
    v_add_u32 v247, 50688, v243
    v_add_u32 v248, 101376, v240
    v_add_u32 v249, 101376, v241
    v_add_u32 v250, 101376, v242
    v_add_u32 v251, 101376, v243
    v_mov_b32 v40, 0
    v_mov_b32 v41, 0
    v_mov_b32 v42, 0
    v_mov_b32 v43, 0
    v_mov_b32 v44, 0
    v_mov_b32 v45, 0
    v_mov_b32 v46, 0
    v_mov_b32 v47, 0
    s_add_u32 m0, s39, 50688
    s_mov_b32 s45, 256
    buffer_load_dwordx4 v252, s[4:7], s45 offen lds
    s_add_u32 m0, s39, 51712
    s_nop 0
    buffer_load_dwordx4 v253, s[4:7], s45 offen lds
    s_add_u32 m0, s39, 52736
    s_mov_b32 s45, 14592
    buffer_load_dwordx4 v252, s[4:7], s45 offen lds
    s_add_u32 m0, s39, 53760
    s_nop 0
    buffer_load_dwordx4 v253, s[4:7], s45 offen lds
    s_add_u32 m0, s39, 67584
    s_mov_b32 s45, 384
    buffer_load_dwordx4 v252, s[4:7], s45 offen lds
    s_add_u32 m0, s39, 68608
    s_nop 0
    buffer_load_dwordx4 v253, s[4:7], s45 offen lds
    s_add_u32 m0, s39, 69632
    s_mov_b32 s45, 14720
    buffer_load_dwordx4 v252, s[4:7], s45 offen lds
    s_add_u32 m0, s39, 70656
    s_nop 0
    buffer_load_dwordx4 v253, s[4:7], s45 offen lds
    s_add_u32 m0, s38, 84480
    s_add_u32 s45, s96, 1048576
    buffer_load_dwordx4 v13, s[8:11], s45 offen lds
    s_add_u32 m0, s38, 85536
    s_add_u32 s45, s96, 1179648
    buffer_load_dwordx4 v13, s[8:11], s45 offen lds
    s_add_u32 m0, s38, 86592
    s_add_u32 s45, s96, 1081344
    buffer_load_dwordx4 v13, s[8:11], s45 offen lds
    s_add_u32 m0, s38, 87648
    s_add_u32 s45, s96, 1212416
    buffer_load_dwordx4 v13, s[8:11], s45 offen lds
    s_waitcnt vmcnt(17)
    ds_read_b128 v[128:131], v80 offset:0
    ds_read_b128 v[132:135], v80 offset:2048
    ds_read_b128 v[136:139], v83 offset:0
    ds_read_b128 v[140:143], v83 offset:2048
    ds_read_b128 v[144:147], v80 offset:16896
    ds_read_b128 v[148:151], v80 offset:18944
    ds_read_b128 v[152:155], v83 offset:16896
    ds_read_b128 v[156:159], v83 offset:18944
    s_waitcnt vmcnt(13)
    s_barrier
    s_waitcnt lgkmcnt(0)
    ds_read_b64_tr_b16 a[192:193], v240 offset:33792
    ds_read_b64_tr_b16 a[194:195], v240 offset:35904
    ds_read_b64_tr_b16 a[196:197], v241 offset:33792
    ds_read_b64_tr_b16 a[198:199], v241 offset:35904
    ds_read_b64_tr_b16 a[200:201], v242 offset:33792
    ds_read_b64_tr_b16 a[202:203], v242 offset:35904
    ds_read_b64_tr_b16 a[204:205], v243 offset:33792
    ds_read_b64_tr_b16 a[206:207], v243 offset:35904
    ds_read_b64_tr_b16 a[208:209], v240 offset:38016
    ds_read_b64_tr_b16 a[210:211], v240 offset:40128
    ds_read_b64_tr_b16 a[212:213], v241 offset:38016
    ds_read_b64_tr_b16 a[214:215], v241 offset:40128
    s_waitcnt lgkmcnt(10)
    v_mfma_f32_16x16x32_bf16 v[96:99], a[192:195], v[128:131], 0
    s_waitcnt lgkmcnt(6)
    s_add_u32 m0, s39, 101376
    ds_read_b64_tr_b16 a[216:217], v242 offset:38016
    ds_read_b64_tr_b16 a[218:219], v242 offset:40128
    v_mfma_f32_16x16x32_bf16 v[100:103], a[192:195], v[132:135], 0
    s_mov_b32 s45, 512
    buffer_load_dwordx4 v252, s[4:7], s45 offen lds
    v_mfma_f32_16x16x32_bf16 v[108:111], a[196:199], v[132:135], 0
    s_add_u32 m0, s39, 102400
    ds_read_b64_tr_b16 a[220:221], v243 offset:38016
    ds_read_b64_tr_b16 a[222:223], v243 offset:40128
    v_mfma_f32_16x16x32_bf16 v[104:107], a[196:199], v[128:131], 0
    s_nop 0
    buffer_load_dwordx4 v253, s[4:7], s45 offen lds
    v_mfma_f32_16x16x32_bf16 v[112:115], a[200:203], v[128:131], 0
    s_waitcnt lgkmcnt(6)
    s_add_u32 m0, s39, 103424
    ds_read_b64_tr_b16 a[192:193], v240 offset:42240
    ds_read_b64_tr_b16 a[194:195], v240 offset:44352
    v_mfma_f32_16x16x32_bf16 v[116:119], a[200:203], v[132:135], 0
    s_mov_b32 s45, 14848
    buffer_load_dwordx4 v252, s[4:7], s45 offen lds
    v_mfma_f32_16x16x32_bf16 v[124:127], a[204:207], v[132:135], 0
    s_add_u32 m0, s39, 104448
    ds_read_b64_tr_b16 a[196:197], v241 offset:42240
    ds_read_b64_tr_b16 a[198:199], v241 offset:44352
    v_mfma_f32_16x16x32_bf16 v[120:123], a[204:207], v[128:131], 0
    s_nop 0
    buffer_load_dwordx4 v253, s[4:7], s45 offen lds
    v_mfma_f32_16x16x32_bf16 v[96:99], a[208:211], v[136:139], v[96:99]
    s_waitcnt lgkmcnt(6)
    s_add_u32 m0, s39, 118272
    ds_read_b64_tr_b16 a[200:201], v242 offset:42240
    ds_read_b64_tr_b16 a[202:203], v242 offset:44352
    v_mfma_f32_16x16x32_bf16 v[100:103], a[208:211], v[140:143], v[100:103]
    s_mov_b32 s45, 640
    buffer_load_dwordx4 v252, s[4:7], s45 offen lds
    v_mfma_f32_16x16x32_bf16 v[108:111], a[212:215], v[140:143], v[108:111]
    s_add_u32 m0, s39, 119296
    ds_read_b64_tr_b16 a[204:205], v243 offset:42240
    ds_read_b64_tr_b16 a[206:207], v243 offset:44352
    v_mfma_f32_16x16x32_bf16 v[104:107], a[212:215], v[136:139], v[104:107]
    s_nop 0
    buffer_load_dwordx4 v253, s[4:7], s45 offen lds
    v_mfma_f32_16x16x32_bf16 v[112:115], a[216:219], v[136:139], v[112:115]
    s_waitcnt lgkmcnt(6)
    s_add_u32 m0, s39, 120320
    ds_read_b64_tr_b16 a[208:209], v240 offset:46464
    ds_read_b64_tr_b16 a[210:211], v240 offset:48576
    v_mfma_f32_16x16x32_bf16 v[116:119], a[216:219], v[140:143], v[116:119]
    s_mov_b32 s45, 14976
    buffer_load_dwordx4 v252, s[4:7], s45 offen lds
    v_mfma_f32_16x16x32_bf16 v[124:127], a[220:223], v[140:143], v[124:127]
    s_add_u32 m0, s39, 121344
    ds_read_b64_tr_b16 a[212:213], v241 offset:46464
    ds_read_b64_tr_b16 a[214:215], v241 offset:48576
    v_mfma_f32_16x16x32_bf16 v[120:123], a[220:223], v[136:139], v[120:123]
    s_nop 0
    buffer_load_dwordx4 v253, s[4:7], s45 offen lds
    v_mfma_f32_16x16x32_bf16 v[96:99], a[192:195], v[144:147], v[96:99]
    s_waitcnt lgkmcnt(6)
    ds_read_b64_tr_b16 a[216:217], v242 offset:46464
    ds_read_b64_tr_b16 a[218:219], v242 offset:48576
    v_mfma_f32_16x16x32_bf16 v[100:103], a[192:195], v[148:151], v[100:103]
    s_waitcnt vmcnt(8)
    s_barrier
    ds_read_b128 v[160:163], v81 offset:0
    ds_read_b128 v[164:167], v81 offset:2048
    ds_read_b128 v[168:171], v84 offset:0
    ds_read_b128 v[172:175], v84 offset:2048
    v_mfma_f32_16x16x32_bf16 v[108:111], a[196:199], v[148:151], v[108:111]
    s_add_u32 m0, s38, 135168
    ds_read_b64_tr_b16 a[220:221], v243 offset:46464
    ds_read_b64_tr_b16 a[222:223], v243 offset:48576
    v_mfma_f32_16x16x32_bf16 v[104:107], a[196:199], v[144:147], v[104:107]
    s_add_u32 s45, s96, 2097152
    buffer_load_dwordx4 v13, s[8:11], s45 offen lds
    v_mfma_f32_16x16x32_bf16 v[112:115], a[200:203], v[144:147], v[112:115]
    s_waitcnt lgkmcnt(10)
    ds_read_b64_tr_b16 a[192:193], v244 offset:33792
    ds_read_b64_tr_b16 a[194:195], v244 offset:35904
    v_mfma_f32_16x16x32_bf16 v[116:119], a[200:203], v[148:151], v[116:119]
    s_nop 0
    ds_read_b128 v[176:179], v81 offset:16896
    ds_read_b128 v[180:183], v81 offset:18944
    v_mfma_f32_16x16x32_bf16 v[124:127], a[204:207], v[148:151], v[124:127]
    s_add_u32 m0, s38, 136224
    ds_read_b64_tr_b16 a[196:197], v245 offset:33792
    ds_read_b64_tr_b16 a[198:199], v245 offset:35904
    v_mfma_f32_16x16x32_bf16 v[120:123], a[204:207], v[144:147], v[120:123]
    s_add_u32 s45, s96, 2228224
    buffer_load_dwordx4 v13, s[8:11], s45 offen lds
    v_mfma_f32_16x16x32_bf16 v[96:99], a[208:211], v[152:155], v[96:99]
    s_waitcnt lgkmcnt(12)
    ds_read_b64_tr_b16 a[200:201], v246 offset:33792
    ds_read_b64_tr_b16 a[202:203], v246 offset:35904
    v_mfma_f32_16x16x32_bf16 v[100:103], a[208:211], v[156:159], v[100:103]
    s_nop 0
    ds_read_b128 v[184:187], v84 offset:16896
    ds_read_b128 v[188:191], v84 offset:18944
    v_mfma_f32_16x16x32_bf16 v[108:111], a[212:215], v[156:159], v[108:111]
    s_add_u32 m0, s38, 137280
    ds_read_b64_tr_b16 a[204:205], v247 offset:33792
    ds_read_b64_tr_b16 a[206:207], v247 offset:35904
    v_mfma_f32_16x16x32_bf16 v[104:107], a[212:215], v[152:155], v[104:107]
    s_add_u32 s45, s96, 2129920
    buffer_load_dwordx4 v13, s[8:11], s45 offen lds
    v_mfma_f32_16x16x32_bf16 v[112:115], a[216:219], v[152:155], v[112:115]
    s_waitcnt lgkmcnt(2)
    ds_read_b64_tr_b16 a[208:209], v244 offset:38016
    ds_read_b64_tr_b16 a[210:211], v244 offset:40128
    v_mfma_f32_16x16x32_bf16 v[116:119], a[216:219], v[156:159], v[116:119]
    v_mfma_f32_16x16x32_bf16 v[124:127], a[220:223], v[156:159], v[124:127]
    s_add_u32 m0, s38, 138336
    ds_read_b64_tr_b16 a[212:213], v245 offset:38016
    ds_read_b64_tr_b16 a[214:215], v245 offset:40128
    v_mfma_f32_16x16x32_bf16 v[120:123], a[220:223], v[152:155], v[120:123]
    s_add_u32 s45, s96, 2260992
    buffer_load_dwordx4 v13, s[8:11], s45 offen lds
    v_mfma_f32_16x16x32_bf16 v[96:99], a[192:195], v[160:163], v[96:99]
    s_waitcnt lgkmcnt(6)
    s_add_u32 m0, s39, 0
    ds_read_b64_tr_b16 a[216:217], v246 offset:38016
    ds_read_b64_tr_b16 a[218:219], v246 offset:40128
    v_mfma_f32_16x16x32_bf16 v[100:103], a[192:195], v[164:167], v[100:103]
    s_mov_b32 s45, 768
    buffer_load_dwordx4 v252, s[4:7], s45 offen lds
    v_mfma_f32_16x16x32_bf16 v[108:111], a[196:199], v[164:167], v[108:111]
    s_add_u32 m0, s39, 1024
    ds_read_b64_tr_b16 a[220:221], v247 offset:38016
    ds_read_b64_tr_b16 a[222:223], v247 offset:40128
    v_mfma_f32_16x16x32_bf16 v[104:107], a[196:199], v[160:163], v[104:107]
    s_nop 0
    buffer_load_dwordx4 v253, s[4:7], s45 offen lds
    v_mfma_f32_16x16x32_bf16 v[112:115], a[200:203], v[160:163], v[112:115]
    s_waitcnt lgkmcnt(6)
    s_add_u32 m0, s39, 2048
    ds_read_b64_tr_b16 a[192:193], v244 offset:42240
    ds_read_b64_tr_b16 a[194:195], v244 offset:44352
    v_mfma_f32_16x16x32_bf16 v[116:119], a[200:203], v[164:167], v[116:119]
    s_mov_b32 s45, 15104
    buffer_load_dwordx4 v252, s[4:7], s45 offen lds
    v_mfma_f32_16x16x32_bf16 v[124:127], a[204:207], v[164:167], v[124:127]
    s_add_u32 m0, s39, 3072
    ds_read_b64_tr_b16 a[196:197], v245 offset:42240
    ds_read_b64_tr_b16 a[198:199], v245 offset:44352
    v_mfma_f32_16x16x32_bf16 v[120:123], a[204:207], v[160:163], v[120:123]
    s_nop 0
    buffer_load_dwordx4 v253, s[4:7], s45 offen lds
    v_mfma_f32_16x16x32_bf16 v[96:99], a[208:211], v[168:171], v[96:99]
    s_waitcnt lgkmcnt(6)
    s_add_u32 m0, s38, 16896
    ds_read_b64_tr_b16 a[200:201], v246 offset:42240
    ds_read_b64_tr_b16 a[202:203], v246 offset:44352
    v_mfma_f32_16x16x32_bf16 v[100:103], a[208:211], v[172:175], v[100:103]
    s_add_u32 s45, s44, 0
    buffer_load_dwordx4 v254, s[8:11], s45 offen lds
    v_mfma_f32_16x16x32_bf16 v[108:111], a[212:215], v[172:175], v[108:111]
    s_add_u32 m0, s38, 17952
    ds_read_b64_tr_b16 a[204:205], v247 offset:42240
    ds_read_b64_tr_b16 a[206:207], v247 offset:44352
    v_mfma_f32_16x16x32_bf16 v[104:107], a[212:215], v[168:171], v[104:107]
    s_add_u32 s45, s44, 131072
    buffer_load_dwordx4 v254, s[8:11], s45 offen lds
    v_mfma_f32_16x16x32_bf16 v[112:115], a[216:219], v[168:171], v[112:115]
    s_waitcnt lgkmcnt(6)
    s_add_u32 m0, s38, 19008
    ds_read_b64_tr_b16 a[208:209], v244 offset:46464
    ds_read_b64_tr_b16 a[210:211], v244 offset:48576
    v_mfma_f32_16x16x32_bf16 v[116:119], a[216:219], v[172:175], v[116:119]
    s_add_u32 s45, s44, 32768
    buffer_load_dwordx4 v254, s[8:11], s45 offen lds
    v_mfma_f32_16x16x32_bf16 v[124:127], a[220:223], v[172:175], v[124:127]
    s_add_u32 m0, s38, 20064
    ds_read_b64_tr_b16 a[212:213], v245 offset:46464
    ds_read_b64_tr_b16 a[214:215], v245 offset:48576
    v_mfma_f32_16x16x32_bf16 v[120:123], a[220:223], v[168:171], v[120:123]
    s_add_u32 s45, s44, 163840
    buffer_load_dwordx4 v254, s[8:11], s45 offen lds
    v_mfma_f32_16x16x32_bf16 v[96:99], a[192:195], v[176:179], v[96:99]
    s_waitcnt lgkmcnt(6)
    ds_read_b64_tr_b16 a[216:217], v246 offset:46464
    ds_read_b64_tr_b16 a[218:219], v246 offset:48576
    v_mfma_f32_16x16x32_bf16 v[100:103], a[192:195], v[180:183], v[100:103]
    s_waitcnt vmcnt(8)
    s_barrier
    ds_read_b128 v[192:195], v82 offset:0
    ds_read_b128 v[196:199], v82 offset:2048
    ds_read_b128 v[200:203], v85 offset:0
    ds_read_b128 v[204:207], v85 offset:2048
    v_mfma_f32_16x16x32_bf16 v[108:111], a[196:199], v[180:183], v[108:111]
    s_nop 0
    ds_read_b64_tr_b16 a[220:221], v247 offset:46464
    ds_read_b64_tr_b16 a[222:223], v247 offset:48576
    v_mfma_f32_16x16x32_bf16 v[104:107], a[196:199], v[176:179], v[104:107]
    v_mfma_f32_16x16x32_bf16 v[112:115], a[200:203], v[176:179], v[112:115]
    s_waitcnt lgkmcnt(10)
    ds_read_b64_tr_b16 a[192:193], v248 offset:33792
    ds_read_b64_tr_b16 a[194:195], v248 offset:35904
    v_mfma_f32_16x16x32_bf16 v[116:119], a[200:203], v[180:183], v[116:119]
    s_nop 0
    ds_read_b128 v[208:211], v82 offset:16896
    ds_read_b128 v[212:215], v82 offset:18944
    v_mfma_f32_16x16x32_bf16 v[124:127], a[204:207], v[180:183], v[124:127]
    s_nop 0
    ds_read_b64_tr_b16 a[196:197], v249 offset:33792
    ds_read_b64_tr_b16 a[198:199], v249 offset:35904
    v_mfma_f32_16x16x32_bf16 v[120:123], a[204:207], v[176:179], v[120:123]
    v_mfma_f32_16x16x32_bf16 v[96:99], a[208:211], v[184:187], v[96:99]
    s_waitcnt lgkmcnt(12)
    ds_read_b64_tr_b16 a[200:201], v250 offset:33792
    ds_read_b64_tr_b16 a[202:203], v250 offset:35904
    v_mfma_f32_16x16x32_bf16 v[100:103], a[208:211], v[188:191], v[100:103]
    s_nop 0
    ds_read_b128 v[216:219], v85 offset:16896
    ds_read_b128 v[220:223], v85 offset:18944
    v_mfma_f32_16x16x32_bf16 v[108:111], a[212:215], v[188:191], v[108:111]
    s_nop 0
    ds_read_b64_tr_b16 a[204:205], v251 offset:33792
    ds_read_b64_tr_b16 a[206:207], v251 offset:35904
    v_mfma_f32_16x16x32_bf16 v[104:107], a[212:215], v[184:187], v[104:107]
    v_mfma_f32_16x16x32_bf16 v[112:115], a[216:219], v[184:187], v[112:115]
    s_waitcnt lgkmcnt(2)
    ds_read_b64_tr_b16 a[208:209], v248 offset:38016
    ds_read_b64_tr_b16 a[210:211], v248 offset:40128
    v_mfma_f32_16x16x32_bf16 v[116:119], a[216:219], v[188:191], v[116:119]
    s_nop 0
    s_add_u32 s100, s53, s98
    buffer_load_dword v37, v35, s[8:11], s100 offen
    v_mfma_f32_16x16x32_bf16 v[124:127], a[220:223], v[188:191], v[124:127]
    s_nop 0
    ds_read_b64_tr_b16 a[212:213], v249 offset:38016
    ds_read_b64_tr_b16 a[214:215], v249 offset:40128
    v_mfma_f32_16x16x32_bf16 v[120:123], a[220:223], v[184:187], v[120:123]
    v_mfma_f32_16x16x32_bf16 v[96:99], a[192:195], v[192:195], v[96:99]
    s_waitcnt lgkmcnt(6)
    s_add_u32 m0, s38, 33792
    ds_read_b64_tr_b16 a[216:217], v250 offset:38016
    ds_read_b64_tr_b16 a[218:219], v250 offset:40128
    v_mfma_f32_16x16x32_bf16 v[100:103], a[192:195], v[196:199], v[100:103]
    s_add_u32 s45, s97, 524288
    buffer_load_dwordx4 v13, s[8:11], s45 offen lds
    v_mfma_f32_16x16x32_bf16 v[108:111], a[196:199], v[196:199], v[108:111]
    s_add_u32 m0, s38, 34848
    ds_read_b64_tr_b16 a[220:221], v251 offset:38016
    ds_read_b64_tr_b16 a[222:223], v251 offset:40128
    v_mfma_f32_16x16x32_bf16 v[104:107], a[196:199], v[192:195], v[104:107]
    s_add_u32 s45, s97, 655360
    buffer_load_dwordx4 v13, s[8:11], s45 offen lds
    v_mfma_f32_16x16x32_bf16 v[112:115], a[200:203], v[192:195], v[112:115]
    s_waitcnt lgkmcnt(6)
    s_add_u32 m0, s38, 35904
    ds_read_b64_tr_b16 a[192:193], v248 offset:42240
    ds_read_b64_tr_b16 a[194:195], v248 offset:44352
    v_mfma_f32_16x16x32_bf16 v[116:119], a[200:203], v[196:199], v[116:119]
    s_add_u32 s45, s97, 557056
    buffer_load_dwordx4 v13, s[8:11], s45 offen lds
    v_mfma_f32_16x16x32_bf16 v[124:127], a[204:207], v[196:199], v[124:127]
    s_add_u32 m0, s38, 36960
    ds_read_b64_tr_b16 a[196:197], v249 offset:42240
    ds_read_b64_tr_b16 a[198:199], v249 offset:44352
    v_mfma_f32_16x16x32_bf16 v[120:123], a[204:207], v[192:195], v[120:123]
    s_add_u32 s45, s97, 688128
    buffer_load_dwordx4 v13, s[8:11], s45 offen lds
    v_mfma_f32_16x16x32_bf16 v[96:99], a[208:211], v[200:203], v[96:99]
    s_waitcnt lgkmcnt(6)
    s_add_u32 m0, s38, 50688
    ds_read_b64_tr_b16 a[200:201], v250 offset:42240
    ds_read_b64_tr_b16 a[202:203], v250 offset:44352
    v_mfma_f32_16x16x32_bf16 v[100:103], a[208:211], v[204:207], v[100:103]
    s_add_u32 s45, s97, 1572864
    buffer_load_dwordx4 v13, s[8:11], s45 offen lds
    v_mfma_f32_16x16x32_bf16 v[108:111], a[212:215], v[204:207], v[108:111]
    s_add_u32 m0, s38, 51744
    ds_read_b64_tr_b16 a[204:205], v251 offset:42240
    ds_read_b64_tr_b16 a[206:207], v251 offset:44352
    v_mfma_f32_16x16x32_bf16 v[104:107], a[212:215], v[200:203], v[104:107]
    s_add_u32 s45, s97, 1703936
    buffer_load_dwordx4 v13, s[8:11], s45 offen lds
    v_mfma_f32_16x16x32_bf16 v[112:115], a[216:219], v[200:203], v[112:115]
    s_waitcnt lgkmcnt(6)
    s_add_u32 m0, s38, 52800
    ds_read_b64_tr_b16 a[208:209], v248 offset:46464
    ds_read_b64_tr_b16 a[210:211], v248 offset:48576
    v_mfma_f32_16x16x32_bf16 v[116:119], a[216:219], v[204:207], v[116:119]
    s_add_u32 s45, s97, 1605632
    buffer_load_dwordx4 v13, s[8:11], s45 offen lds
    v_mfma_f32_16x16x32_bf16 v[124:127], a[220:223], v[204:207], v[124:127]
    s_add_u32 m0, s38, 53856
    ds_read_b64_tr_b16 a[212:213], v249 offset:46464
    ds_read_b64_tr_b16 a[214:215], v249 offset:48576
    v_mfma_f32_16x16x32_bf16 v[120:123], a[220:223], v[200:203], v[120:123]
    s_add_u32 s45, s97, 1736704
    buffer_load_dwordx4 v13, s[8:11], s45 offen lds
    v_mfma_f32_16x16x32_bf16 v[96:99], a[192:195], v[208:211], v[96:99]
    s_waitcnt lgkmcnt(6)
    ds_read_b64_tr_b16 a[216:217], v250 offset:46464
    ds_read_b64_tr_b16 a[218:219], v250 offset:48576
    v_mfma_f32_16x16x32_bf16 v[100:103], a[192:195], v[212:215], v[100:103]
    s_waitcnt vmcnt(9)
    s_barrier
    ds_read_b128 v[224:227], v80 offset:0
    ds_read_b128 v[228:231], v80 offset:2048
    ds_read_b128 v[232:235], v83 offset:0
    ds_read_b128 v[236:239], v83 offset:2048
    v_mfma_f32_16x16x32_bf16 v[108:111], a[196:199], v[212:215], v[108:111]
    s_nop 0
    ds_read_b64_tr_b16 a[220:221], v251 offset:46464
    ds_read_b64_tr_b16 a[222:223], v251 offset:48576
    v_mfma_f32_16x16x32_bf16 v[104:107], a[196:199], v[208:211], v[104:107]
    v_mfma_f32_16x16x32_bf16 v[112:115], a[200:203], v[208:211], v[112:115]
    s_waitcnt lgkmcnt(10)
    ds_read_b64_tr_b16 a[192:193], v240 offset:16896
    ds_read_b64_tr_b16 a[194:195], v240 offset:19008
    v_mfma_f32_16x16x32_bf16 v[116:119], a[200:203], v[212:215], v[116:119]
    v_mfma_f32_16x16x32_bf16 v[124:127], a[204:207], v[212:215], v[124:127]
    s_nop 0
    ds_read_b64_tr_b16 a[196:197], v241 offset:16896
    ds_read_b64_tr_b16 a[198:199], v241 offset:19008
    v_mfma_f32_16x16x32_bf16 v[120:123], a[204:207], v[208:211], v[120:123]
    v_mfma_f32_16x16x32_bf16 v[96:99], a[208:211], v[216:219], v[96:99]
    s_waitcnt lgkmcnt(10)
    ds_read_b64_tr_b16 a[200:201], v242 offset:16896
    ds_read_b64_tr_b16 a[202:203], v242 offset:19008
    v_mfma_f32_16x16x32_bf16 v[100:103], a[208:211], v[220:223], v[100:103]
    v_mfma_f32_16x16x32_bf16 v[108:111], a[212:215], v[220:223], v[108:111]
    s_nop 0
    ds_read_b64_tr_b16 a[204:205], v243 offset:16896
    ds_read_b64_tr_b16 a[206:207], v243 offset:19008
    v_mfma_f32_16x16x32_bf16 v[104:107], a[212:215], v[216:219], v[104:107]
    v_mfma_f32_16x16x32_bf16 v[112:115], a[216:219], v[216:219], v[112:115]
    s_waitcnt lgkmcnt(6)
    ds_read_b64_tr_b16 a[208:209], v240 offset:21120
    ds_read_b64_tr_b16 a[210:211], v240 offset:23232
    v_mfma_f32_16x16x32_bf16 v[116:119], a[216:219], v[220:223], v[116:119]
    s_nop 0
    s_mov_b32 exec_hi, 0
    global_store_dword v2, v3, s[84:85] sc1
    s_mov_b32 exec_hi, -1
    v_mfma_f32_16x16x32_bf16 v[124:127], a[220:223], v[220:223], v[124:127]
    s_nop 0
    ds_read_b64_tr_b16 a[212:213], v241 offset:21120
    ds_read_b64_tr_b16 a[214:215], v241 offset:23232
    v_mfma_f32_16x16x32_bf16 v[120:123], a[220:223], v[216:219], v[120:123]
    v_mfma_f32_16x16x32_bf16 v[96:99], a[192:195], v[224:227], v[96:99]
    s_waitcnt lgkmcnt(6)
    ds_read_b64_tr_b16 a[216:217], v242 offset:21120
    ds_read_b64_tr_b16 a[218:219], v242 offset:23232
    v_mfma_f32_16x16x32_bf16 v[100:103], a[192:195], v[228:231], v[100:103]
    s_barrier
    v_mfma_f32_16x16x32_bf16 v[108:111], a[196:199], v[228:231], v[108:111]
    s_add_u32 m0, s38, 67584
    ds_read_b64_tr_b16 a[220:221], v243 offset:21120
    ds_read_b64_tr_b16 a[222:223], v243 offset:23232
    v_mfma_f32_16x16x32_bf16 v[104:107], a[196:199], v[224:227], v[104:107]
    s_add_u32 s45, s97, 2621440
    buffer_load_dwordx4 v13, s[8:11], s45 offen lds
    v_mfma_f32_16x16x32_bf16 v[112:115], a[200:203], v[224:227], v[112:115]
    s_waitcnt lgkmcnt(6)
    ds_read_b64_tr_b16 a[192:193], v240 offset:25344
    ds_read_b64_tr_b16 a[194:195], v240 offset:27456
    v_mfma_f32_16x16x32_bf16 v[116:119], a[200:203], v[228:231], v[116:119]
    v_mfma_f32_16x16x32_bf16 v[124:127], a[204:207], v[228:231], v[124:127]
    s_add_u32 m0, s38, 68640
    ds_read_b64_tr_b16 a[196:197], v241 offset:25344
    ds_read_b64_tr_b16 a[198:199], v241 offset:27456
    v_mfma_f32_16x16x32_bf16 v[120:123], a[204:207], v[224:227], v[120:123]
    s_add_u32 s45, s97, 2752512
    buffer_load_dwordx4 v13, s[8:11], s45 offen lds
    v_mfma_f32_16x16x32_bf16 v[96:99], a[208:211], v[232:235], v[96:99]
    s_waitcnt lgkmcnt(6)
    ds_read_b64_tr_b16 a[200:201], v242 offset:25344
    ds_read_b64_tr_b16 a[202:203], v242 offset:27456
    v_mfma_f32_16x16x32_bf16 v[100:103], a[208:211], v[236:239], v[100:103]
    v_mfma_f32_16x16x32_bf16 v[108:111], a[212:215], v[236:239], v[108:111]
    s_add_u32 m0, s38, 69696
    ds_read_b64_tr_b16 a[204:205], v243 offset:25344
    ds_read_b64_tr_b16 a[206:207], v243 offset:27456
    v_mfma_f32_16x16x32_bf16 v[104:107], a[212:215], v[232:235], v[104:107]
    s_add_u32 s45, s97, 2654208
    buffer_load_dwordx4 v13, s[8:11], s45 offen lds
    v_mfma_f32_16x16x32_bf16 v[112:115], a[216:219], v[232:235], v[112:115]
    s_waitcnt lgkmcnt(6)
    ds_read_b64_tr_b16 a[208:209], v240 offset:29568
    ds_read_b64_tr_b16 a[210:211], v240 offset:31680
    v_mfma_f32_16x16x32_bf16 v[116:119], a[216:219], v[236:239], v[116:119]
    v_mfma_f32_16x16x32_bf16 v[124:127], a[220:223], v[236:239], v[124:127]
    s_add_u32 m0, s38, 70752
    ds_read_b64_tr_b16 a[212:213], v241 offset:29568
    ds_read_b64_tr_b16 a[214:215], v241 offset:31680
    v_mfma_f32_16x16x32_bf16 v[120:123], a[220:223], v[232:235], v[120:123]
    s_add_u32 s45, s97, 2785280
    buffer_load_dwordx4 v13, s[8:11], s45 offen lds
    v_mfma_f32_16x16x32_bf16 v[64:67], a[192:195], v[128:131], 0
    s_waitcnt lgkmcnt(6)
    ds_read_b64_tr_b16 a[216:217], v242 offset:29568
    ds_read_b64_tr_b16 a[218:219], v242 offset:31680
    s_waitcnt vmcnt(9)
    v_mfma_f32_16x16x32_bf16 v[68:71], a[192:195], v[132:135], 0
    s_barrier
    v_mfma_f32_16x16x32_bf16 v[76:79], a[196:199], v[132:135], 0
    s_add_u32 m0, s39, 84480
    ds_read_b64_tr_b16 a[220:221], v243 offset:29568
    ds_read_b64_tr_b16 a[222:223], v243 offset:31680
    v_mfma_f32_16x16x32_bf16 v[72:75], a[196:199], v[128:131], 0
    s_add_u32 s45, s96, 0
    buffer_load_dwordx4 v17, s[12:15], s45 offen nt lds
    v_mfma_f32_16x16x32_bf16 v[80:83], a[200:203], v[128:131], 0
    s_waitcnt lgkmcnt(6)
    ds_read_b64_tr_b16 a[192:193], v240 offset:33792
    ds_read_b64_tr_b16 a[194:195], v240 offset:35904
    v_mfma_f32_16x16x32_bf16 v[84:87], a[200:203], v[132:135], 0
    v_mul_f32 v96, s36, v96
    v_mul_f32 v97, s36, v97
    v_mul_f32 v98, s36, v98
    v_mfma_f32_16x16x32_bf16 v[92:95], a[204:207], v[132:135], 0
    s_add_u32 m0, s39, 85504
    ds_read_b64_tr_b16 a[196:197], v241 offset:33792
    ds_read_b64_tr_b16 a[198:199], v241 offset:35904
    v_mfma_f32_16x16x32_bf16 v[88:91], a[204:207], v[128:131], 0
    s_nop 0
    buffer_load_dwordx4 v18, s[12:15], s45 offen nt lds
    v_mul_f32 v99, s36, v99
    v_mfma_f32_16x16x32_bf16 v[64:67], a[208:211], v[136:139], v[64:67]
    s_waitcnt lgkmcnt(6)
    ds_read_b64_tr_b16 a[200:201], v242 offset:33792
    ds_read_b64_tr_b16 a[202:203], v242 offset:35904
    v_mfma_f32_16x16x32_bf16 v[68:71], a[208:211], v[140:143], v[68:71]
    v_mul_f32 v100, s36, v100
    v_mul_f32 v101, s36, v101
    v_mul_f32 v102, s36, v102
    v_mfma_f32_16x16x32_bf16 v[76:79], a[212:215], v[140:143], v[76:79]
    s_add_u32 m0, s39, 86528
    ds_read_b64_tr_b16 a[204:205], v243 offset:33792
    ds_read_b64_tr_b16 a[206:207], v243 offset:35904
    v_mfma_f32_16x16x32_bf16 v[72:75], a[212:215], v[136:139], v[72:75]
    s_add_u32 s45, s96, 8192
    buffer_load_dwordx4 v17, s[12:15], s45 offen nt lds
    v_mul_f32 v103, s36, v103
    v_mfma_f32_16x16x32_bf16 v[80:83], a[216:219], v[136:139], v[80:83]
    s_waitcnt lgkmcnt(6)
    ds_read_b64_tr_b16 a[208:209], v240 offset:38016
    ds_read_b64_tr_b16 a[210:211], v240 offset:40128
    v_mfma_f32_16x16x32_bf16 v[84:87], a[216:219], v[140:143], v[84:87]
    v_mul_f32 v104, s36, v104
    v_mul_f32 v105, s36, v105
    v_mfma_f32_16x16x32_bf16 v[92:95], a[220:223], v[140:143], v[92:95]
    s_add_u32 m0, s39, 87552
    ds_read_b64_tr_b16 a[212:213], v241 offset:38016
    ds_read_b64_tr_b16 a[214:215], v241 offset:40128
    v_mfma_f32_16x16x32_bf16 v[88:91], a[220:223], v[136:139], v[88:91]
    s_nop 0
    buffer_load_dwordx4 v18, s[12:15], s45 offen nt lds
    v_mul_f32 v106, s36, v106
    v_mfma_f32_16x16x32_bf16 v[64:67], a[192:195], v[144:147], v[64:67]
    s_waitcnt lgkmcnt(6)
    ds_read_b64_tr_b16 a[216:217], v242 offset:38016
    ds_read_b64_tr_b16 a[218:219], v242 offset:40128
    s_waitcnt vmcnt(9)
    v_mfma_f32_16x16x32_bf16 v[68:71], a[192:195], v[148:151], v[68:71]
    s_barrier
    v_mfma_f32_16x16x32_bf16 v[76:79], a[196:199], v[148:151], v[76:79]
    s_add_u32 m0, s39, 101376
    ds_read_b64_tr_b16 a[220:221], v243 offset:38016
    ds_read_b64_tr_b16 a[222:223], v243 offset:40128
    v_mfma_f32_16x16x32_bf16 v[72:75], a[196:199], v[144:147], v[72:75]
    s_add_u32 s45, s96, 65536
    buffer_load_dwordx4 v17, s[12:15], s45 offen nt lds
    v_mul_f32 v107, s36, v107
    v_mfma_f32_16x16x32_bf16 v[80:83], a[200:203], v[144:147], v[80:83]
    s_waitcnt lgkmcnt(6)
    ds_read_b64_tr_b16 a[192:193], v240 offset:42240
    ds_read_b64_tr_b16 a[194:195], v240 offset:44352
    v_mfma_f32_16x16x32_bf16 v[84:87], a[200:203], v[148:151], v[84:87]
    v_mul_f32 v108, s36, v108
    v_mul_f32 v109, s36, v109
    v_mul_f32 v110, s36, v110
    v_mfma_f32_16x16x32_bf16 v[92:95], a[204:207], v[148:151], v[92:95]
    s_add_u32 m0, s39, 102400
    ds_read_b64_tr_b16 a[196:197], v241 offset:42240
    ds_read_b64_tr_b16 a[198:199], v241 offset:44352
    v_mfma_f32_16x16x32_bf16 v[88:91], a[204:207], v[144:147], v[88:91]
    s_nop 0
    buffer_load_dwordx4 v18, s[12:15], s45 offen nt lds
    v_mul_f32 v111, s36, v111
    v_mfma_f32_16x16x32_bf16 v[64:67], a[208:211], v[152:155], v[64:67]
    s_waitcnt lgkmcnt(6)
    ds_read_b64_tr_b16 a[200:201], v242 offset:42240
    ds_read_b64_tr_b16 a[202:203], v242 offset:44352
    v_mfma_f32_16x16x32_bf16 v[68:71], a[208:211], v[156:159], v[68:71]
    v_cvt_pk_bf16_f32 v48, v96, v97
    v_cvt_pk_bf16_f32 v49, v98, v99
    v_cvt_pk_bf16_f32 v50, v104, v105
    v_mfma_f32_16x16x32_bf16 v[76:79], a[212:215], v[156:159], v[76:79]
    s_add_u32 m0, s39, 103424
    ds_read_b64_tr_b16 a[204:205], v243 offset:42240
    ds_read_b64_tr_b16 a[206:207], v243 offset:44352
    v_mfma_f32_16x16x32_bf16 v[72:75], a[212:215], v[152:155], v[72:75]
    s_add_u32 s45, s96, 73728
    buffer_load_dwordx4 v17, s[12:15], s45 offen nt lds
    v_cvt_pk_bf16_f32 v51, v106, v107
    v_mfma_f32_16x16x32_bf16 v[80:83], a[216:219], v[152:155], v[80:83]
    s_waitcnt lgkmcnt(6)
    ds_read_b64_tr_b16 a[208:209], v240 offset:46464
    ds_read_b64_tr_b16 a[210:211], v240 offset:48576
    v_mfma_f32_16x16x32_bf16 v[84:87], a[216:219], v[156:159], v[84:87]
    v_cvt_pk_bf16_f32 v52, v100, v101
    v_cvt_pk_bf16_f32 v53, v102, v103
    v_cvt_pk_bf16_f32 v54, v108, v109
    v_mfma_f32_16x16x32_bf16 v[92:95], a[220:223], v[156:159], v[92:95]
    s_add_u32 m0, s39, 104448
    ds_read_b64_tr_b16 a[212:213], v241 offset:46464
    ds_read_b64_tr_b16 a[214:215], v241 offset:48576
    v_mfma_f32_16x16x32_bf16 v[88:91], a[220:223], v[152:155], v[88:91]
    s_nop 0
    buffer_load_dwordx4 v18, s[12:15], s45 offen nt lds
    v_cvt_pk_bf16_f32 v55, v110, v111
    v_mfma_f32_16x16x32_bf16 v[64:67], a[192:195], v[160:163], v[64:67]
    s_waitcnt lgkmcnt(6)
    ds_read_b64_tr_b16 a[216:217], v242 offset:46464
    ds_read_b64_tr_b16 a[218:219], v242 offset:48576
    v_mfma_f32_16x16x32_bf16 v[68:71], a[192:195], v[164:167], v[68:71]
    v_mul_f32 v112, s36, v112
    v_mul_f32 v113, s36, v113
    v_mul_f32 v114, s36, v114
    v_mfma_f32_16x16x32_bf16 v[76:79], a[196:199], v[164:167], v[76:79]
    s_add_u32 m0, s38, 118272
    ds_read_b64_tr_b16 a[220:221], v243 offset:46464
    ds_read_b64_tr_b16 a[222:223], v243 offset:48576
    v_mfma_f32_16x16x32_bf16 v[72:75], a[196:199], v[160:163], v[72:75]
    s_add_u32 s45, s98, 0
    buffer_load_dwordx4 v13, s[8:11], s45 offen lds
    v_mul_f32 v115, s36, v115
    v_mfma_f32_16x16x32_bf16 v[80:83], a[200:203], v[160:163], v[80:83]
    s_waitcnt lgkmcnt(6)
    ds_read_b64_tr_b16 a[192:193], v244 offset:0
    ds_read_b64_tr_b16 a[194:195], v244 offset:2112
    v_mfma_f32_16x16x32_bf16 v[84:87], a[200:203], v[164:167], v[84:87]
    v_mul_f32 v116, s36, v116
    v_mul_f32 v117, s36, v117
    v_mfma_f32_16x16x32_bf16 v[92:95], a[204:207], v[164:167], v[92:95]
    s_add_u32 m0, s38, 119328
    ds_read_b64_tr_b16 a[196:197], v245 offset:0
    ds_read_b64_tr_b16 a[198:199], v245 offset:2112
    v_mfma_f32_16x16x32_bf16 v[88:91], a[204:207], v[160:163], v[88:91]
    s_add_u32 s45, s98, 131072
    buffer_load_dwordx4 v13, s[8:11], s45 offen lds
    v_mul_f32 v118, s36, v118
    v_mfma_f32_16x16x32_bf16 v[64:67], a[208:211], v[168:171], v[64:67]
    s_waitcnt lgkmcnt(6)
    ds_read_b64_tr_b16 a[200:201], v246 offset:0
    ds_read_b64_tr_b16 a[202:203], v246 offset:2112
    v_mfma_f32_16x16x32_bf16 v[68:71], a[208:211], v[172:175], v[68:71]
    v_mul_f32 v119, s36, v119
    v_mul_f32 v120, s36, v120
    v_mul_f32 v121, s36, v121
    v_mfma_f32_16x16x32_bf16 v[76:79], a[212:215], v[172:175], v[76:79]
    s_add_u32 m0, s38, 120384
    ds_read_b64_tr_b16 a[204:205], v247 offset:0
    ds_read_b64_tr_b16 a[206:207], v247 offset:2112
    v_mfma_f32_16x16x32_bf16 v[72:75], a[212:215], v[168:171], v[72:75]
    s_add_u32 s45, s98, 32768
    buffer_load_dwordx4 v13, s[8:11], s45 offen lds
    v_mul_f32 v122, s36, v122
    v_mfma_f32_16x16x32_bf16 v[80:83], a[216:219], v[168:171], v[80:83]
    s_waitcnt lgkmcnt(6)
    ds_read_b64_tr_b16 a[208:209], v244 offset:4224
    ds_read_b64_tr_b16 a[210:211], v244 offset:6336
    v_mfma_f32_16x16x32_bf16 v[84:87], a[216:219], v[172:175], v[84:87]
    s_nop 0
    s_add_u32 s100, s53, s99
    buffer_load_dword v37, v35, s[8:11], s100 offen
    v_mfma_f32_16x16x32_bf16 v[92:95], a[220:223], v[172:175], v[92:95]
    s_add_u32 m0, s38, 121440
    ds_read_b64_tr_b16 a[212:213], v245 offset:4224
    ds_read_b64_tr_b16 a[214:215], v245 offset:6336
    v_mfma_f32_16x16x32_bf16 v[88:91], a[220:223], v[168:171], v[88:91]
    s_add_u32 s45, s98, 163840
    buffer_load_dwordx4 v13, s[8:11], s45 offen lds
    v_mul_f32 v123, s36, v123
    v_mfma_f32_16x16x32_bf16 v[64:67], a[192:195], v[176:179], v[64:67]
    s_waitcnt lgkmcnt(6)
    ds_read_b64_tr_b16 a[216:217], v246 offset:4224
    ds_read_b64_tr_b16 a[218:219], v246 offset:6336
    s_waitcnt vmcnt(13)
    v_mfma_f32_16x16x32_bf16 v[68:71], a[192:195], v[180:183], v[68:71]
    s_barrier
    v_mfma_f32_16x16x32_bf16 v[76:79], a[196:199], v[180:183], v[76:79]
    s_add_u32 m0, s38, 135168
    ds_read_b64_tr_b16 a[220:221], v247 offset:4224
    ds_read_b64_tr_b16 a[222:223], v247 offset:6336
    v_mfma_f32_16x16x32_bf16 v[72:75], a[196:199], v[176:179], v[72:75]
    s_add_u32 s45, s98, 1048576
    buffer_load_dwordx4 v13, s[8:11], s45 offen lds
    v_mul_f32 v124, s36, v124
    v_mfma_f32_16x16x32_bf16 v[80:83], a[200:203], v[176:179], v[80:83]
    s_waitcnt lgkmcnt(6)
    ds_read_b64_tr_b16 a[192:193], v244 offset:8448
    ds_read_b64_tr_b16 a[194:195], v244 offset:10560
    v_mfma_f32_16x16x32_bf16 v[84:87], a[200:203], v[180:183], v[84:87]
    v_mul_f32 v125, s36, v125
    v_mul_f32 v126, s36, v126
    v_mul_f32 v127, s36, v127
    v_mfma_f32_16x16x32_bf16 v[92:95], a[204:207], v[180:183], v[92:95]
    s_add_u32 m0, s38, 136224
    ds_read_b64_tr_b16 a[196:197], v245 offset:8448
    ds_read_b64_tr_b16 a[198:199], v245 offset:10560
    v_mfma_f32_16x16x32_bf16 v[88:91], a[204:207], v[176:179], v[88:91]
    s_add_u32 s45, s98, 1179648
    buffer_load_dwordx4 v13, s[8:11], s45 offen lds
    v_cvt_pk_bf16_f32 v56, v112, v113
    v_mfma_f32_16x16x32_bf16 v[64:67], a[208:211], v[184:187], v[64:67]
    s_waitcnt lgkmcnt(6)
    ds_read_b64_tr_b16 a[200:201], v246 offset:8448
    ds_read_b64_tr_b16 a[202:203], v246 offset:10560
    v_mfma_f32_16x16x32_bf16 v[68:71], a[208:211], v[188:191], v[68:71]
    v_cvt_pk_bf16_f32 v57, v114, v115
    v_cvt_pk_bf16_f32 v58, v120, v121
    v_cvt_pk_bf16_f32 v59, v122, v123
    v_mfma_f32_16x16x32_bf16 v[76:79], a[212:215], v[188:191], v[76:79]
    s_add_u32 m0, s38, 137280
    ds_read_b64_tr_b16 a[204:205], v247 offset:8448
    ds_read_b64_tr_b16 a[206:207], v247 offset:10560
    v_mfma_f32_16x16x32_bf16 v[72:75], a[212:215], v[184:187], v[72:75]
    s_add_u32 s45, s98, 1081344
    buffer_load_dwordx4 v13, s[8:11], s45 offen lds
    v_cvt_pk_bf16_f32 v60, v116, v117
    v_mfma_f32_16x16x32_bf16 v[80:83], a[216:219], v[184:187], v[80:83]
    s_waitcnt lgkmcnt(6)
    ds_read_b64_tr_b16 a[208:209], v244 offset:12672
    ds_read_b64_tr_b16 a[210:211], v244 offset:14784
    v_mfma_f32_16x16x32_bf16 v[84:87], a[216:219], v[188:191], v[84:87]
    v_cvt_pk_bf16_f32 v61, v118, v119
    v_cvt_pk_bf16_f32 v62, v124, v125
    v_cvt_pk_bf16_f32 v63, v126, v127
    v_mfma_f32_16x16x32_bf16 v[92:95], a[220:223], v[188:191], v[92:95]
    s_add_u32 m0, s38, 138336
    ds_read_b64_tr_b16 a[212:213], v245 offset:12672
    ds_read_b64_tr_b16 a[214:215], v245 offset:14784
    v_mfma_f32_16x16x32_bf16 v[88:91], a[220:223], v[184:187], v[88:91]
    s_add_u32 s45, s98, 1212416
    buffer_load_dwordx4 v13, s[8:11], s45 offen lds
    v_mfma_f32_16x16x32_bf16 v[64:67], a[192:195], v[192:195], v[64:67]
    s_waitcnt lgkmcnt(6)
    ds_read_b64_tr_b16 a[216:217], v246 offset:12672
    ds_read_b64_tr_b16 a[218:219], v246 offset:14784
    v_mfma_f32_16x16x32_bf16 v[68:71], a[192:195], v[196:199], v[68:71]
    v_permlane32_swap_b32 v48, v50
    v_permlane32_swap_b32 v49, v51
    v_mfma_f32_16x16x32_bf16 v[76:79], a[196:199], v[196:199], v[76:79]
    s_add_u32 m0, s38, 0
    ds_read_b64_tr_b16 a[220:221], v247 offset:12672
    ds_read_b64_tr_b16 a[222:223], v247 offset:14784
    v_mfma_f32_16x16x32_bf16 v[72:75], a[196:199], v[192:195], v[72:75]
    s_add_u32 s45, s98, 2097152
    buffer_load_dwordx4 v13, s[8:11], s45 offen lds
    v_mfma_f32_16x16x32_bf16 v[80:83], a[200:203], v[192:195], v[80:83]
    s_waitcnt lgkmcnt(6)
    ds_read_b64_tr_b16 a[192:193], v244 offset:16896
    ds_read_b64_tr_b16 a[194:195], v244 offset:19008
    v_mfma_f32_16x16x32_bf16 v[84:87], a[200:203], v[196:199], v[84:87]
    v_permlane32_swap_b32 v52, v54
    v_permlane32_swap_b32 v53, v55
    v_mfma_f32_16x16x32_bf16 v[92:95], a[204:207], v[196:199], v[92:95]
    s_add_u32 m0, s38, 1056
    ds_read_b64_tr_b16 a[196:197], v245 offset:16896
    ds_read_b64_tr_b16 a[198:199], v245 offset:19008
    v_mfma_f32_16x16x32_bf16 v[88:91], a[204:207], v[192:195], v[88:91]
    s_add_u32 s45, s98, 2228224
    buffer_load_dwordx4 v13, s[8:11], s45 offen lds
    v_mfma_f32_16x16x32_bf16 v[64:67], a[208:211], v[200:203], v[64:67]
    s_waitcnt lgkmcnt(6)
    ds_read_b64_tr_b16 a[200:201], v246 offset:16896
    ds_read_b64_tr_b16 a[202:203], v246 offset:19008
    v_mfma_f32_16x16x32_bf16 v[68:71], a[208:211], v[204:207], v[68:71]
    v_permlane32_swap_b32 v56, v58
    v_mfma_f32_16x16x32_bf16 v[76:79], a[212:215], v[204:207], v[76:79]
    s_add_u32 m0, s38, 2112
    ds_read_b64_tr_b16 a[204:205], v247 offset:16896
    ds_read_b64_tr_b16 a[206:207], v247 offset:19008
    v_mfma_f32_16x16x32_bf16 v[72:75], a[212:215], v[200:203], v[72:75]
    s_add_u32 s45, s98, 2129920
    buffer_load_dwordx4 v13, s[8:11], s45 offen lds
    v_mfma_f32_16x16x32_bf16 v[80:83], a[216:219], v[200:203], v[80:83]
    s_waitcnt lgkmcnt(6)
    ds_read_b64_tr_b16 a[208:209], v244 offset:21120
    ds_read_b64_tr_b16 a[210:211], v244 offset:23232
    v_mfma_f32_16x16x32_bf16 v[84:87], a[216:219], v[204:207], v[84:87]
    v_permlane32_swap_b32 v57, v59
    v_permlane32_swap_b32 v60, v62
    v_mfma_f32_16x16x32_bf16 v[92:95], a[220:223], v[204:207], v[92:95]
    s_add_u32 m0, s38, 3168
    ds_read_b64_tr_b16 a[212:213], v245 offset:21120
    ds_read_b64_tr_b16 a[214:215], v245 offset:23232
    v_mfma_f32_16x16x32_bf16 v[88:91], a[220:223], v[200:203], v[88:91]
    s_add_u32 s45, s98, 2260992
    buffer_load_dwordx4 v13, s[8:11], s45 offen lds
    v_mfma_f32_16x16x32_bf16 v[64:67], a[192:195], v[208:211], v[64:67]
    s_waitcnt lgkmcnt(6)
    ds_read_b64_tr_b16 a[216:217], v246 offset:21120
    ds_read_b64_tr_b16 a[218:219], v246 offset:23232
    s_waitcnt vmcnt(17)
    v_mfma_f32_16x16x32_bf16 v[68:71], a[192:195], v[212:215], v[68:71]
    s_barrier
    v_mfma_f32_16x16x32_bf16 v[76:79], a[196:199], v[212:215], v[76:79]
    s_add_u32 m0, s38, 16896
    ds_read_b64_tr_b16 a[220:221], v247 offset:21120
    ds_read_b64_tr_b16 a[222:223], v247 offset:23232
    v_mfma_f32_16x16x32_bf16 v[72:75], a[196:199], v[208:211], v[72:75]
    s_add_u32 s45, s46, 0
    buffer_load_dwordx4 v254, s[8:11], s45 offen lds
    v_mfma_f32_16x16x32_bf16 v[80:83], a[200:203], v[208:211], v[80:83]
    s_waitcnt lgkmcnt(6)
    ds_read_b64_tr_b16 a[192:193], v244 offset:25344
    ds_read_b64_tr_b16 a[194:195], v244 offset:27456
    v_mfma_f32_16x16x32_bf16 v[84:87], a[200:203], v[212:215], v[84:87]
    v_permlane32_swap_b32 v61, v63
    v_permlane16_swap_b32 v48, v50
    v_permlane16_swap_b32 v49, v51
    v_mfma_f32_16x16x32_bf16 v[92:95], a[204:207], v[212:215], v[92:95]
    s_add_u32 m0, s38, 17952
    ds_read_b64_tr_b16 a[196:197], v245 offset:25344
    ds_read_b64_tr_b16 a[198:199], v245 offset:27456
    v_mfma_f32_16x16x32_bf16 v[88:91], a[204:207], v[208:211], v[88:91]
    s_add_u32 s45, s46, 131072
    buffer_load_dwordx4 v254, s[8:11], s45 offen lds
    v_mfma_f32_16x16x32_bf16 v[64:67], a[208:211], v[216:219], v[64:67]
    s_waitcnt lgkmcnt(6)
    ds_read_b64_tr_b16 a[200:201], v246 offset:25344
    ds_read_b64_tr_b16 a[202:203], v246 offset:27456
    v_mfma_f32_16x16x32_bf16 v[68:71], a[208:211], v[220:223], v[68:71]
    v_permlane16_swap_b32 v52, v54
    v_permlane16_swap_b32 v53, v55
    v_mfma_f32_16x16x32_bf16 v[76:79], a[212:215], v[220:223], v[76:79]
    s_add_u32 m0, s38, 19008
    ds_read_b64_tr_b16 a[204:205], v247 offset:25344
    ds_read_b64_tr_b16 a[206:207], v247 offset:27456
    v_mfma_f32_16x16x32_bf16 v[72:75], a[212:215], v[216:219], v[72:75]
    s_add_u32 s45, s46, 32768
    buffer_load_dwordx4 v254, s[8:11], s45 offen lds
    v_mfma_f32_16x16x32_bf16 v[80:83], a[216:219], v[216:219], v[80:83]
    s_waitcnt lgkmcnt(6)
    ds_read_b64_tr_b16 a[208:209], v244 offset:29568
    ds_read_b64_tr_b16 a[210:211], v244 offset:31680
    v_mfma_f32_16x16x32_bf16 v[84:87], a[216:219], v[220:223], v[84:87]
    v_permlane16_swap_b32 v56, v58
    v_permlane16_swap_b32 v57, v59
    v_mfma_f32_16x16x32_bf16 v[92:95], a[220:223], v[220:223], v[92:95]
    s_add_u32 m0, s38, 20064
    ds_read_b64_tr_b16 a[212:213], v245 offset:29568
    ds_read_b64_tr_b16 a[214:215], v245 offset:31680
    v_mfma_f32_16x16x32_bf16 v[88:91], a[220:223], v[216:219], v[88:91]
    s_add_u32 s45, s46, 163840
    buffer_load_dwordx4 v254, s[8:11], s45 offen lds
    v_mfma_f32_16x16x32_bf16 v[64:67], a[192:195], v[224:227], v[64:67]
    s_waitcnt lgkmcnt(6)
    ds_read_b64_tr_b16 a[216:217], v246 offset:29568
    ds_read_b64_tr_b16 a[218:219], v246 offset:31680
    v_mfma_f32_16x16x32_bf16 v[68:71], a[192:195], v[228:231], v[68:71]
    v_permlane16_swap_b32 v60, v62
    v_mfma_f32_16x16x32_bf16 v[76:79], a[196:199], v[228:231], v[76:79]
    s_add_u32 m0, s39, 33792
    ds_read_b64_tr_b16 a[220:221], v247 offset:29568
    ds_read_b64_tr_b16 a[222:223], v247 offset:31680
    v_mfma_f32_16x16x32_bf16 v[72:75], a[196:199], v[224:227], v[72:75]
    s_add_u32 s45, s97, 0
    buffer_load_dwordx4 v17, s[12:15], s45 offen nt lds
    v_mfma_f32_16x16x32_bf16 v[80:83], a[200:203], v[224:227], v[80:83]
    s_waitcnt lgkmcnt(6)
    ds_read_b128 a[192:195], v5 offset:33792
    ds_read_b128 a[196:199], v8 offset:33792
    v_mfma_f32_16x16x32_bf16 v[84:87], a[200:203], v[228:231], v[84:87]
    v_permlane16_swap_b32 v61, v63
    v_accvgpr_write_b32 a128, v48
    v_accvgpr_write_b32 a129, v49
    v_accvgpr_write_b32 a130, v50
    v_mfma_f32_16x16x32_bf16 v[92:95], a[204:207], v[228:231], v[92:95]
    s_add_u32 m0, s39, 34816
    v_accvgpr_write_b32 a131, v51
    v_accvgpr_write_b32 a132, v52
    v_accvgpr_write_b32 a133, v53
    v_mfma_f32_16x16x32_bf16 v[88:91], a[204:207], v[224:227], v[88:91]
    s_nop 0
    buffer_load_dwordx4 v18, s[12:15], s45 offen nt lds
    v_accvgpr_write_b32 a134, v54
    v_mfma_f32_16x16x32_bf16 v[64:67], a[208:211], v[232:235], v[64:67]
    s_waitcnt lgkmcnt(4)
    ds_read_b128 a[200:203], v5 offset:35840
    ds_read_b128 a[204:207], v8 offset:35840
    v_mfma_f32_16x16x32_bf16 v[68:71], a[208:211], v[236:239], v[68:71]
    v_accvgpr_write_b32 a135, v55
    v_accvgpr_write_b32 a136, v56
    v_mfma_f32_16x16x32_bf16 v[76:79], a[212:215], v[236:239], v[76:79]
    s_add_u32 m0, s39, 35840
    v_accvgpr_write_b32 a137, v57
    v_accvgpr_write_b32 a138, v58
    v_accvgpr_write_b32 a139, v59
    v_mfma_f32_16x16x32_bf16 v[72:75], a[212:215], v[232:235], v[72:75]
    s_add_u32 s45, s97, 8192
    buffer_load_dwordx4 v17, s[12:15], s45 offen nt lds
    v_accvgpr_write_b32 a140, v60
    v_mfma_f32_16x16x32_bf16 v[80:83], a[216:219], v[232:235], v[80:83]
    s_waitcnt lgkmcnt(3)
    ds_read_b128 a[208:211], v5 offset:37888
    ds_read_b128 a[212:215], v8 offset:37888
    v_mfma_f32_16x16x32_bf16 v[84:87], a[216:219], v[236:239], v[84:87]
    v_accvgpr_write_b32 a141, v61
    v_accvgpr_write_b32 a142, v62
    v_accvgpr_write_b32 a143, v63
    v_mfma_f32_16x16x32_bf16 v[92:95], a[220:223], v[236:239], v[92:95]
    s_add_u32 m0, s39, 36864
    v_mfma_f32_16x16x32_bf16 v[88:91], a[220:223], v[232:235], v[88:91]
    s_nop 0
    buffer_load_dwordx4 v18, s[12:15], s45 offen nt lds
    v_mfma_f32_16x16x32_bf16 a[0:3], a[192:195], a[128:131], 0
    s_waitcnt lgkmcnt(3)
    ds_read_b128 a[216:219], v5 offset:39936
    ds_read_b128 a[220:223], v8 offset:39936
    s_waitcnt vmcnt(21)
    v_mfma_f32_16x16x32_bf16 a[8:11], a[192:195], a[132:135], 0
    s_barrier
    v_mfma_f32_16x16x32_bf16 a[8:11], a[196:199], a[140:143], a[8:11]
    s_add_u32 m0, s39, 50688
    v_mfma_f32_16x16x32_bf16 a[0:3], a[196:199], a[136:139], a[0:3]
    s_add_u32 s45, s97, 65536
    buffer_load_dwordx4 v17, s[12:15], s45 offen nt lds
    v_mfma_f32_16x16x32_bf16 a[4:7], a[200:203], a[128:131], 0
    s_waitcnt lgkmcnt(3)
    ds_read_b128 a[192:195], v5 offset:41984
    ds_read_b128 a[196:199], v8 offset:41984
    v_mfma_f32_16x16x32_bf16 a[12:15], a[200:203], a[132:135], 0
    v_mul_f32 v64, s36, v64
    v_mfma_f32_16x16x32_bf16 a[12:15], a[204:207], a[140:143], a[12:15]
    s_add_u32 m0, s39, 51712
    v_mul_f32 v65, s36, v65
    v_mul_f32 v66, s36, v66
    v_mfma_f32_16x16x32_bf16 a[4:7], a[204:207], a[136:139], a[4:7]
    s_nop 0
    buffer_load_dwordx4 v18, s[12:15], s45 offen nt lds
    v_mfma_f32_16x16x32_bf16 a[16:19], a[208:211], a[128:131], 0
    s_waitcnt lgkmcnt(3)
    ds_read_b128 a[200:203], v5 offset:44032
    ds_read_b128 a[204:207], v8 offset:44032
    v_mfma_f32_16x16x32_bf16 a[24:27], a[208:211], a[132:135], 0
    s_nop 0
    s_cmp_lg_u32 s3, 0
    s_cbranch_scc1 L_nosig
    s_mov_b64 exec, 1
    global_atomic_add v3, v21, s[82:83] sc1
    s_mov_b64 exec, -1
L_nosig:
    v_mfma_f32_16x16x32_bf16 a[24:27], a[212:215], a[140:143], a[24:27]
    s_add_u32 m0, s39, 52736
    v_mul_f32 v67, s36, v67
    v_mfma_f32_16x16x32_bf16 a[16:19], a[212:215], a[136:139], a[16:19]
    s_add_u32 s45, s97, 73728
    buffer_load_dwordx4 v17, s[12:15], s45 offen nt lds
    v_mfma_f32_16x16x32_bf16 a[20:23], a[216:219], a[128:131], 0
    s_waitcnt lgkmcnt(3)
    ds_read_b128 a[208:211], v5 offset:46080
    ds_read_b128 a[212:215], v8 offset:46080
    v_mfma_f32_16x16x32_bf16 a[28:31], a[216:219], a[132:135], 0
    v_mul_f32 v68, s36, v68
    v_mul_f32 v69, s36, v69
    v_mfma_f32_16x16x32_bf16 a[28:31], a[220:223], a[140:143], a[28:31]
    s_add_u32 m0, s39, 53760
    v_mul_f32 v70, s36, v70
    v_mfma_f32_16x16x32_bf16 a[20:23], a[220:223], a[136:139], a[20:23]
    s_nop 0
    buffer_load_dwordx4 v18, s[12:15], s45 offen nt lds
    v_mfma_f32_16x16x32_bf16 a[32:35], a[192:195], a[128:131], 0
    s_waitcnt lgkmcnt(3)
    ds_read_b128 a[216:219], v5 offset:48128
    ds_read_b128 a[220:223], v8 offset:48128
    v_mfma_f32_16x16x32_bf16 a[40:43], a[192:195], a[132:135], 0
    v_mul_f32 v71, s36, v71
    v_mul_f32 v72, s36, v72
    v_mfma_f32_16x16x32_bf16 a[40:43], a[196:199], a[140:143], a[40:43]
    s_add_u32 m0, s38, 67584
    v_mul_f32 v73, s36, v73
    v_mfma_f32_16x16x32_bf16 a[32:35], a[196:199], a[136:139], a[32:35]
    s_add_u32 s45, s99, 524288
    buffer_load_dwordx4 v13, s[8:11], s45 offen lds
    v_mfma_f32_16x16x32_bf16 a[36:39], a[200:203], a[128:131], 0
    s_waitcnt lgkmcnt(3)
    ds_read_b128 a[192:195], v6 offset:0
    ds_read_b128 a[196:199], v9 offset:0
    v_mfma_f32_16x16x32_bf16 a[44:47], a[200:203], a[132:135], 0
    v_mul_f32 v74, s36, v74
    v_mfma_f32_16x16x32_bf16 a[44:47], a[204:207], a[140:143], a[44:47]
    s_add_u32 m0, s38, 68640
    v_mul_f32 v75, s36, v75
    v_mul_f32 v76, s36, v76
    v_mfma_f32_16x16x32_bf16 a[36:39], a[204:207], a[136:139], a[36:39]
    s_add_u32 s45, s99, 655360
    buffer_load_dwordx4 v13, s[8:11], s45 offen lds
    v_mfma_f32_16x16x32_bf16 a[48:51], a[208:211], a[128:131], 0
    s_waitcnt lgkmcnt(3)
    ds_read_b128 a[200:203], v6 offset:2048
    ds_read_b128 a[204:207], v9 offset:2048
    v_mfma_f32_16x16x32_bf16 a[56:59], a[208:211], a[132:135], 0
    v_mul_f32 v77, s36, v77
    v_mfma_f32_16x16x32_bf16 a[56:59], a[212:215], a[140:143], a[56:59]
    s_add_u32 m0, s38, 69696
    v_mul_f32 v78, s36, v78
    v_mul_f32 v79, s36, v79
    v_mfma_f32_16x16x32_bf16 a[48:51], a[212:215], a[136:139], a[48:51]
    s_add_u32 s45, s99, 557056
    buffer_load_dwordx4 v13, s[8:11], s45 offen lds
    v_mfma_f32_16x16x32_bf16 a[52:55], a[216:219], a[128:131], 0
    s_waitcnt lgkmcnt(3)
    ds_read_b128 a[208:211], v6 offset:4096
    ds_read_b128 a[212:215], v9 offset:4096
    v_mfma_f32_16x16x32_bf16 a[60:63], a[216:219], a[132:135], 0
    v_cvt_pk_bf16_f32 v48, v64, v65
    v_mfma_f32_16x16x32_bf16 a[60:63], a[220:223], a[140:143], a[60:63]
    s_add_u32 m0, s38, 70752
    v_cvt_pk_bf16_f32 v49, v66, v67
    v_cvt_pk_bf16_f32 v50, v72, v73
    v_mfma_f32_16x16x32_bf16 a[52:55], a[220:223], a[136:139], a[52:55]
    s_add_u32 s45, s99, 688128
    buffer_load_dwordx4 v13, s[8:11], s45 offen lds
    v_mfma_f32_16x16x32_bf16 a[64:67], a[192:195], a[128:131], 0
    s_waitcnt lgkmcnt(3)
    ds_read_b128 a[216:219], v6 offset:6144
    ds_read_b128 a[220:223], v9 offset:6144
    s_waitcnt vmcnt(24)
    v_mfma_f32_16x16x32_bf16 a[72:75], a[192:195], a[132:135], 0
    s_barrier
    v_mfma_f32_16x16x32_bf16 a[72:75], a[196:199], a[140:143], a[72:75]
    v_cvt_pk_bf16_f32 v51, v74, v75
    v_mfma_f32_16x16x32_bf16 a[64:67], a[196:199], a[136:139], a[64:67]
    v_cvt_pk_bf16_f32 v52, v68, v69
    v_mfma_f32_16x16x32_bf16 a[68:71], a[200:203], a[128:131], 0
    s_waitcnt lgkmcnt(3)
    ds_read_b128 a[192:195], v6 offset:8192
    ds_read_b128 a[196:199], v9 offset:8192
    v_mfma_f32_16x16x32_bf16 a[76:79], a[200:203], a[132:135], 0
    v_cvt_pk_bf16_f32 v53, v70, v71
    v_cvt_pk_bf16_f32 v54, v76, v77
    v_mfma_f32_16x16x32_bf16 a[76:79], a[204:207], a[140:143], a[76:79]
    s_add_u32 m0, s38, 84480
    v_cvt_pk_bf16_f32 v55, v78, v79
    v_mfma_f32_16x16x32_bf16 a[68:71], a[204:207], a[136:139], a[68:71]
    s_add_u32 s45, s99, 1572864
    buffer_load_dwordx4 v13, s[8:11], s45 offen lds
    v_mfma_f32_16x16x32_bf16 a[80:83], a[208:211], a[128:131], 0
    s_waitcnt lgkmcnt(3)
    ds_read_b128 a[200:203], v6 offset:10240
    ds_read_b128 a[204:207], v9 offset:10240
    v_mfma_f32_16x16x32_bf16 a[88:91], a[208:211], a[132:135], 0
    v_mul_f32 v80, s36, v80
    v_mul_f32 v81, s36, v81
    v_mfma_f32_16x16x32_bf16 a[88:91], a[212:215], a[140:143], a[88:91]
    v_mul_f32 v82, s36, v82
    v_mfma_f32_16x16x32_bf16 a[80:83], a[212:215], a[136:139], a[80:83]
    v_mul_f32 v83, s36, v83
    v_mul_f32 v84, s36, v84
    v_mfma_f32_16x16x32_bf16 a[84:87], a[216:219], a[128:131], 0
    s_waitcnt lgkmcnt(3)
    ds_read_b128 a[208:211], v6 offset:12288
    ds_read_b128 a[212:215], v9 offset:12288
    v_mfma_f32_16x16x32_bf16 a[92:95], a[216:219], a[132:135], 0
    v_mul_f32 v85, s36, v85
    v_mfma_f32_16x16x32_bf16 a[92:95], a[220:223], a[140:143], a[92:95]
    s_add_u32 m0, s38, 85536
    v_mul_f32 v86, s36, v86
    v_mul_f32 v87, s36, v87
    v_mfma_f32_16x16x32_bf16 a[84:87], a[220:223], a[136:139], a[84:87]
    s_add_u32 s45, s99, 1703936
    buffer_load_dwordx4 v13, s[8:11], s45 offen lds
    v_mfma_f32_16x16x32_bf16 a[96:99], a[192:195], a[128:131], 0
    s_waitcnt lgkmcnt(3)
    ds_read_b128 a[216:219], v6 offset:14336
    ds_read_b128 a[220:223], v9 offset:14336
    v_mfma_f32_16x16x32_bf16 a[104:107], a[192:195], a[132:135], 0
    v_mul_f32 v88, s36, v88
    v_mfma_f32_16x16x32_bf16 a[104:107], a[196:199], a[140:143], a[104:107]
    v_mul_f32 v89, s36, v89
    v_mfma_f32_16x16x32_bf16 a[96:99], a[196:199], a[136:139], a[96:99]
    v_mul_f32 v90, s36, v90
    v_mul_f32 v91, s36, v91
    v_mfma_f32_16x16x32_bf16 a[100:103], a[200:203], a[128:131], 0
    s_waitcnt lgkmcnt(3)
    ds_read_b64_tr_b16 a[192:193], v248 offset:16896
    ds_read_b64_tr_b16 a[194:195], v248 offset:19008
    v_mfma_f32_16x16x32_bf16 a[108:111], a[200:203], a[132:135], 0
    v_mul_f32 v92, s36, v92
    v_mfma_f32_16x16x32_bf16 a[108:111], a[204:207], a[140:143], a[108:111]
    s_add_u32 m0, s38, 86592
    ds_read_b64_tr_b16 a[196:197], v249 offset:16896
    ds_read_b64_tr_b16 a[198:199], v249 offset:19008
    v_mfma_f32_16x16x32_bf16 a[100:103], a[204:207], a[136:139], a[100:103]
    s_add_u32 s45, s99, 1605632
    buffer_load_dwordx4 v13, s[8:11], s45 offen lds
    v_mfma_f32_16x16x32_bf16 a[112:115], a[208:211], a[128:131], 0
    s_waitcnt lgkmcnt(5)
    ds_read_b64_tr_b16 a[200:201], v250 offset:16896
    ds_read_b64_tr_b16 a[202:203], v250 offset:19008
    v_mfma_f32_16x16x32_bf16 a[120:123], a[208:211], a[132:135], 0
    v_mul_f32 v93, s36, v93
    v_mul_f32 v94, s36, v94
    v_mfma_f32_16x16x32_bf16 a[120:123], a[212:215], a[140:143], a[120:123]
    s_nop 0
    ds_read_b64_tr_b16 a[204:205], v251 offset:16896
    ds_read_b64_tr_b16 a[206:207], v251 offset:19008
    v_mfma_f32_16x16x32_bf16 a[112:115], a[212:215], a[136:139], a[112:115]
    v_mul_f32 v95, s36, v95
    v_mfma_f32_16x16x32_bf16 a[116:119], a[216:219], a[128:131], 0
    s_waitcnt lgkmcnt(6)
    ds_read_b64_tr_b16 a[208:209], v248 offset:21120
    ds_read_b64_tr_b16 a[210:211], v248 offset:23232
    v_mfma_f32_16x16x32_bf16 a[124:127], a[216:219], a[132:135], 0
    v_cvt_pk_bf16_f32 v56, v80, v81
    v_cvt_pk_bf16_f32 v57, v82, v83
    v_mfma_f32_16x16x32_bf16 a[124:127], a[220:223], a[140:143], a[124:127]
    s_add_u32 m0, s38, 87648
    ds_read_b64_tr_b16 a[212:213], v249 offset:21120
    ds_read_b64_tr_b16 a[214:215], v249 offset:23232
    v_mfma_f32_16x16x32_bf16 a[116:119], a[220:223], a[136:139], a[116:119]
    s_add_u32 s45, s99, 1736704
    buffer_load_dwordx4 v13, s[8:11], s45 offen lds
    v_mfma_f32_16x16x32_bf16 v[96:99], a[192:195], v[128:131], 0
    s_waitcnt lgkmcnt(6)
    ds_read_b64_tr_b16 a[216:217], v250 offset:21120
    ds_read_b64_tr_b16 a[218:219], v250 offset:23232
    s_waitcnt vmcnt(24)
    v_mfma_f32_16x16x32_bf16 v[100:103], a[192:195], v[132:135], 0
    s_barrier
    v_mfma_f32_16x16x32_bf16 v[108:111], a[196:199], v[132:135], 0
    s_nop 0
    ds_read_b64_tr_b16 a[220:221], v251 offset:21120
    ds_read_b64_tr_b16 a[222:223], v251 offset:23232
    v_mfma_f32_16x16x32_bf16 v[104:107], a[196:199], v[128:131], 0
    v_cvt_pk_bf16_f32 v58, v88, v89
    v_mfma_f32_16x16x32_bf16 v[112:115], a[200:203], v[128:131], 0
    s_waitcnt lgkmcnt(6)
    ds_read_b64_tr_b16 a[192:193], v248 offset:25344
    ds_read_b64_tr_b16 a[194:195], v248 offset:27456
    v_mfma_f32_16x16x32_bf16 v[116:119], a[200:203], v[132:135], 0
    v_cvt_pk_bf16_f32 v59, v90, v91
    v_mfma_f32_16x16x32_bf16 v[124:127], a[204:207], v[132:135], 0
    s_add_u32 m0, s38, 101376
    ds_read_b64_tr_b16 a[196:197], v249 offset:25344
    ds_read_b64_tr_b16 a[198:199], v249 offset:27456
    v_mfma_f32_16x16x32_bf16 v[120:123], a[204:207], v[128:131], 0
    s_add_u32 s45, s99, 2621440
    buffer_load_dwordx4 v13, s[8:11], s45 offen lds
    v_mfma_f32_16x16x32_bf16 v[96:99], a[208:211], v[136:139], v[96:99]
    s_waitcnt lgkmcnt(6)
    ds_read_b64_tr_b16 a[200:201], v250 offset:25344
    ds_read_b64_tr_b16 a[202:203], v250 offset:27456
    v_mfma_f32_16x16x32_bf16 v[100:103], a[208:211], v[140:143], v[100:103]
    v_cvt_pk_bf16_f32 v60, v84, v85
    v_cvt_pk_bf16_f32 v61, v86, v87
    v_mfma_f32_16x16x32_bf16 v[108:111], a[212:215], v[140:143], v[108:111]
    s_nop 0
    ds_read_b64_tr_b16 a[204:205], v251 offset:25344
    ds_read_b64_tr_b16 a[206:207], v251 offset:27456
    v_mfma_f32_16x16x32_bf16 v[104:107], a[212:215], v[136:139], v[104:107]
    v_cvt_pk_bf16_f32 v62, v92, v93
    v_mfma_f32_16x16x32_bf16 v[112:115], a[216:219], v[136:139], v[112:115]
    s_waitcnt lgkmcnt(6)
    ds_read_b64_tr_b16 a[208:209], v248 offset:29568
    ds_read_b64_tr_b16 a[210:211], v248 offset:31680
    v_mfma_f32_16x16x32_bf16 v[116:119], a[216:219], v[140:143], v[116:119]
    v_cvt_pk_bf16_f32 v63, v94, v95
    v_mfma_f32_16x16x32_bf16 v[124:127], a[220:223], v[140:143], v[124:127]
    s_add_u32 m0, s38, 102432
    ds_read_b64_tr_b16 a[212:213], v249 offset:29568
    ds_read_b64_tr_b16 a[214:215], v249 offset:31680
    v_mfma_f32_16x16x32_bf16 v[120:123], a[220:223], v[136:139], v[120:123]
    s_add_u32 s45, s99, 2752512
    buffer_load_dwordx4 v13, s[8:11], s45 offen lds
    v_mfma_f32_16x16x32_bf16 v[96:99], a[192:195], v[144:147], v[96:99]
    s_waitcnt lgkmcnt(6)
    ds_read_b64_tr_b16 a[216:217], v250 offset:29568
    ds_read_b64_tr_b16 a[218:219], v250 offset:31680
    v_mfma_f32_16x16x32_bf16 v[100:103], a[192:195], v[148:151], v[100:103]
    v_permlane32_swap_b32 v48, v50
    v_mfma_f32_16x16x32_bf16 v[108:111], a[196:199], v[148:151], v[108:111]
    s_nop 0
    ds_read_b64_tr_b16 a[220:221], v251 offset:29568
    ds_read_b64_tr_b16 a[222:223], v251 offset:31680
    v_mfma_f32_16x16x32_bf16 v[104:107], a[196:199], v[144:147], v[104:107]
    v_permlane32_swap_b32 v49, v51
    v_mfma_f32_16x16x32_bf16 v[112:115], a[200:203], v[144:147], v[112:115]
    s_waitcnt lgkmcnt(6)
    ds_read_b64_tr_b16 a[192:193], v248 offset:33792
    ds_read_b64_tr_b16 a[194:195], v248 offset:35904
    v_mfma_f32_16x16x32_bf16 v[116:119], a[200:203], v[148:151], v[116:119]
    v_permlane32_swap_b32 v52, v54
    v_mfma_f32_16x16x32_bf16 v[124:127], a[204:207], v[148:151], v[124:127]
    s_add_u32 m0, s38, 103488
    ds_read_b64_tr_b16 a[196:197], v249 offset:33792
    ds_read_b64_tr_b16 a[198:199], v249 offset:35904
    v_mfma_f32_16x16x32_bf16 v[120:123], a[204:207], v[144:147], v[120:123]
    s_add_u32 s45, s99, 2654208
    buffer_load_dwordx4 v13, s[8:11], s45 offen lds
    v_mfma_f32_16x16x32_bf16 v[96:99], a[208:211], v[152:155], v[96:99]
    s_waitcnt lgkmcnt(6)
    ds_read_b64_tr_b16 a[200:201], v250 offset:33792
    ds_read_b64_tr_b16 a[202:203], v250 offset:35904
    v_mfma_f32_16x16x32_bf16 v[100:103], a[208:211], v[156:159], v[100:103]
    v_mfma_f32_16x16x32_bf16 v[108:111], a[212:215], v[156:159], v[108:111]
    s_nop 0
    ds_read_b64_tr_b16 a[204:205], v251 offset:33792
    ds_read_b64_tr_b16 a[206:207], v251 offset:35904
    v_mfma_f32_16x16x32_bf16 v[104:107], a[212:215], v[152:155], v[104:107]
    v_permlane32_swap_b32 v53, v55
    v_mfma_f32_16x16x32_bf16 v[112:115], a[216:219], v[152:155], v[112:115]
    s_waitcnt lgkmcnt(6)
    ds_read_b64_tr_b16 a[208:209], v248 offset:38016
    ds_read_b64_tr_b16 a[210:211], v248 offset:40128
    v_mfma_f32_16x16x32_bf16 v[116:119], a[216:219], v[156:159], v[116:119]
    v_permlane32_swap_b32 v56, v58
    v_mfma_f32_16x16x32_bf16 v[124:127], a[220:223], v[156:159], v[124:127]
    s_add_u32 m0, s38, 104544
    ds_read_b64_tr_b16 a[212:213], v249 offset:38016
    ds_read_b64_tr_b16 a[214:215], v249 offset:40128
    v_mfma_f32_16x16x32_bf16 v[120:123], a[220:223], v[152:155], v[120:123]
    s_add_u32 s45, s99, 2785280
    buffer_load_dwordx4 v13, s[8:11], s45 offen lds
    v_mfma_f32_16x16x32_bf16 v[96:99], a[192:195], v[160:163], v[96:99]
    s_waitcnt lgkmcnt(6)
    ds_read_b64_tr_b16 a[216:217], v250 offset:38016
    ds_read_b64_tr_b16 a[218:219], v250 offset:40128
    s_waitcnt vmcnt(24)
    v_mfma_f32_16x16x32_bf16 v[100:103], a[192:195], v[164:167], v[100:103]
    s_barrier
    v_mfma_f32_16x16x32_bf16 v[108:111], a[196:199], v[164:167], v[108:111]
    s_nop 0
    ds_read_b64_tr_b16 a[220:221], v251 offset:38016
    ds_read_b64_tr_b16 a[222:223], v251 offset:40128
    v_mfma_f32_16x16x32_bf16 v[104:107], a[196:199], v[160:163], v[104:107]
    v_mfma_f32_16x16x32_bf16 v[112:115], a[200:203], v[160:163], v[112:115]
    s_waitcnt lgkmcnt(6)
    ds_read_b64_tr_b16 a[192:193], v248 offset:42240
    ds_read_b64_tr_b16 a[194:195], v248 offset:44352
    v_mfma_f32_16x16x32_bf16 v[116:119], a[200:203], v[164:167], v[116:119]
    v_permlane32_swap_b32 v57, v59
    v_mfma_f32_16x16x32_bf16 v[124:127], a[204:207], v[164:167], v[124:127]
    s_add_u32 m0, s39, 118272
    ds_read_b64_tr_b16 a[196:197], v249 offset:42240
    ds_read_b64_tr_b16 a[198:199], v249 offset:44352
    v_mfma_f32_16x16x32_bf16 v[120:123], a[204:207], v[160:163], v[120:123]
    s_add_u32 s45, s98, 0
    buffer_load_dwordx4 v17, s[12:15], s45 offen nt lds
    v_mfma_f32_16x16x32_bf16 v[96:99], a[208:211], v[168:171], v[96:99]
    s_waitcnt lgkmcnt(6)
    ds_read_b64_tr_b16 a[200:201], v250 offset:42240
    ds_read_b64_tr_b16 a[202:203], v250 offset:44352
    v_mfma_f32_16x16x32_bf16 v[100:103], a[208:211], v[172:175], v[100:103]
    v_permlane32_swap_b32 v60, v62
    v_mfma_f32_16x16x32_bf16 v[108:111], a[212:215], v[172:175], v[108:111]
    s_nop 0
    ds_read_b64_tr_b16 a[204:205], v251 offset:42240
    ds_read_b64_tr_b16 a[206:207], v251 offset:44352
    v_mfma_f32_16x16x32_bf16 v[104:107], a[212:215], v[168:171], v[104:107]
    v_permlane32_swap_b32 v61, v63
    v_mfma_f32_16x16x32_bf16 v[112:115], a[216:219], v[168:171], v[112:115]
    s_waitcnt lgkmcnt(6)
    ds_read_b64_tr_b16 a[208:209], v248 offset:46464
    ds_read_b64_tr_b16 a[210:211], v248 offset:48576
    v_mfma_f32_16x16x32_bf16 v[116:119], a[216:219], v[172:175], v[116:119]
    v_mfma_f32_16x16x32_bf16 v[124:127], a[220:223], v[172:175], v[124:127]
    s_add_u32 m0, s39, 119296
    ds_read_b64_tr_b16 a[212:213], v249 offset:46464
    ds_read_b64_tr_b16 a[214:215], v249 offset:48576
    v_mfma_f32_16x16x32_bf16 v[120:123], a[220:223], v[168:171], v[120:123]
    s_nop 0
    buffer_load_dwordx4 v18, s[12:15], s45 offen nt lds
    v_mfma_f32_16x16x32_bf16 v[96:99], a[192:195], v[176:179], v[96:99]
    s_waitcnt lgkmcnt(6)
    ds_read_b64_tr_b16 a[216:217], v250 offset:46464
    ds_read_b64_tr_b16 a[218:219], v250 offset:48576
    v_mfma_f32_16x16x32_bf16 v[100:103], a[192:195], v[180:183], v[100:103]
    v_permlane16_swap_b32 v48, v50
    v_mfma_f32_16x16x32_bf16 v[108:111], a[196:199], v[180:183], v[108:111]
    s_nop 0
    ds_read_b64_tr_b16 a[220:221], v251 offset:46464
    ds_read_b64_tr_b16 a[222:223], v251 offset:48576
    v_mfma_f32_16x16x32_bf16 v[104:107], a[196:199], v[176:179], v[104:107]
    v_permlane16_swap_b32 v49, v51
    v_mfma_f32_16x16x32_bf16 v[112:115], a[200:203], v[176:179], v[112:115]
    s_waitcnt lgkmcnt(6)
    ds_read_b64_tr_b16 a[192:193], v240 offset:0
    ds_read_b64_tr_b16 a[194:195], v240 offset:2112
    v_mfma_f32_16x16x32_bf16 v[116:119], a[200:203], v[180:183], v[116:119]
    v_mfma_f32_16x16x32_bf16 v[124:127], a[204:207], v[180:183], v[124:127]
    s_add_u32 m0, s39, 120320
    ds_read_b64_tr_b16 a[196:197], v241 offset:0
    ds_read_b64_tr_b16 a[198:199], v241 offset:2112
    v_mfma_f32_16x16x32_bf16 v[120:123], a[204:207], v[176:179], v[120:123]
    s_add_u32 s45, s98, 8192
    buffer_load_dwordx4 v17, s[12:15], s45 offen nt lds
    v_mfma_f32_16x16x32_bf16 v[96:99], a[208:211], v[184:187], v[96:99]
    s_waitcnt lgkmcnt(6)
    ds_read_b64_tr_b16 a[200:201], v242 offset:0
    ds_read_b64_tr_b16 a[202:203], v242 offset:2112
    v_mfma_f32_16x16x32_bf16 v[100:103], a[208:211], v[188:191], v[100:103]
    v_permlane16_swap_b32 v52, v54
    v_mfma_f32_16x16x32_bf16 v[108:111], a[212:215], v[188:191], v[108:111]
    s_nop 0
    ds_read_b64_tr_b16 a[204:205], v243 offset:0
    ds_read_b64_tr_b16 a[206:207], v243 offset:2112
    v_mfma_f32_16x16x32_bf16 v[104:107], a[212:215], v[184:187], v[104:107]
    v_permlane16_swap_b32 v53, v55
    v_mfma_f32_16x16x32_bf16 v[112:115], a[216:219], v[184:187], v[112:115]
    s_waitcnt lgkmcnt(6)
    ds_read_b64_tr_b16 a[208:209], v240 offset:4224
    ds_read_b64_tr_b16 a[210:211], v240 offset:6336
    v_mfma_f32_16x16x32_bf16 v[116:119], a[216:219], v[188:191], v[116:119]
    v_permlane16_swap_b32 v56, v58
    v_mfma_f32_16x16x32_bf16 v[124:127], a[220:223], v[188:191], v[124:127]
    s_add_u32 m0, s39, 121344
    ds_read_b64_tr_b16 a[212:213], v241 offset:4224
    ds_read_b64_tr_b16 a[214:215], v241 offset:6336
    v_mfma_f32_16x16x32_bf16 v[120:123], a[220:223], v[184:187], v[120:123]
    s_nop 0
    buffer_load_dwordx4 v18, s[12:15], s45 offen nt lds
    v_mfma_f32_16x16x32_bf16 v[96:99], a[192:195], v[192:195], v[96:99]
    s_waitcnt lgkmcnt(6)
    ds_read_b64_tr_b16 a[216:217], v242 offset:4224
    ds_read_b64_tr_b16 a[218:219], v242 offset:6336
    s_waitcnt vmcnt(24)
    v_mfma_f32_16x16x32_bf16 v[100:103], a[192:195], v[196:199], v[100:103]
    s_barrier
    v_mfma_f32_16x16x32_bf16 v[108:111], a[196:199], v[196:199], v[108:111]
    s_nop 0
    ds_read_b64_tr_b16 a[220:221], v243 offset:4224
    ds_read_b64_tr_b16 a[222:223], v243 offset:6336
    v_mfma_f32_16x16x32_bf16 v[104:107], a[196:199], v[192:195], v[104:107]
    v_mfma_f32_16x16x32_bf16 v[112:115], a[200:203], v[192:195], v[112:115]
    s_waitcnt lgkmcnt(6)
    ds_read_b64_tr_b16 a[192:193], v240 offset:8448
    ds_read_b64_tr_b16 a[194:195], v240 offset:10560
    v_mfma_f32_16x16x32_bf16 v[116:119], a[200:203], v[196:199], v[116:119]
    v_permlane16_swap_b32 v57, v59
    v_mfma_f32_16x16x32_bf16 v[124:127], a[204:207], v[196:199], v[124:127]
    s_add_u32 m0, s38, 135168
    ds_read_b64_tr_b16 a[196:197], v241 offset:8448
    ds_read_b64_tr_b16 a[198:199], v241 offset:10560
    v_mfma_f32_16x16x32_bf16 v[120:123], a[204:207], v[192:195], v[120:123]
    s_mov_b32 s45, 0
    buffer_load_dwordx4 v20, s[20:23], s45 offen lds
    v_mfma_f32_16x16x32_bf16 v[96:99], a[208:211], v[200:203], v[96:99]
    s_waitcnt lgkmcnt(6)
    ds_read_b64_tr_b16 a[200:201], v242 offset:8448
    ds_read_b64_tr_b16 a[202:203], v242 offset:10560
    v_mfma_f32_16x16x32_bf16 v[100:103], a[208:211], v[204:207], v[100:103]
    v_permlane16_swap_b32 v60, v62
    v_mfma_f32_16x16x32_bf16 v[108:111], a[212:215], v[204:207], v[108:111]
    s_nop 0
    ds_read_b64_tr_b16 a[204:205], v243 offset:8448
    ds_read_b64_tr_b16 a[206:207], v243 offset:10560
    v_mfma_f32_16x16x32_bf16 v[104:107], a[212:215], v[200:203], v[104:107]
    v_mfma_f32_16x16x32_bf16 v[112:115], a[216:219], v[200:203], v[112:115]
    s_waitcnt lgkmcnt(6)
    ds_read_b64_tr_b16 a[208:209], v240 offset:12672
    ds_read_b64_tr_b16 a[210:211], v240 offset:14784
    v_mfma_f32_16x16x32_bf16 v[116:119], a[216:219], v[204:207], v[116:119]
    v_permlane16_swap_b32 v61, v63
    v_mfma_f32_16x16x32_bf16 v[124:127], a[220:223], v[204:207], v[124:127]
    s_add_u32 m0, s38, 136224
    ds_read_b64_tr_b16 a[212:213], v241 offset:12672
    ds_read_b64_tr_b16 a[214:215], v241 offset:14784
    v_mfma_f32_16x16x32_bf16 v[120:123], a[220:223], v[200:203], v[120:123]
    s_mov_b32 s45, 7168
    buffer_load_dwordx4 v20, s[20:23], s45 offen lds
    v_mfma_f32_16x16x32_bf16 v[96:99], a[192:195], v[208:211], v[96:99]
    s_waitcnt lgkmcnt(6)
    ds_read_b64_tr_b16 a[216:217], v242 offset:12672
    ds_read_b64_tr_b16 a[218:219], v242 offset:14784
    v_mfma_f32_16x16x32_bf16 v[100:103], a[192:195], v[212:215], v[100:103]
    v_accvgpr_write_b32 a144, v48
    v_accvgpr_write_b32 a145, v49
    v_mfma_f32_16x16x32_bf16 v[108:111], a[196:199], v[212:215], v[108:111]
    s_nop 0
    ds_read_b64_tr_b16 a[220:221], v243 offset:12672
    ds_read_b64_tr_b16 a[222:223], v243 offset:14784
    v_mfma_f32_16x16x32_bf16 v[104:107], a[196:199], v[208:211], v[104:107]
    v_accvgpr_write_b32 a146, v50
    v_mfma_f32_16x16x32_bf16 v[112:115], a[200:203], v[208:211], v[112:115]
    s_waitcnt lgkmcnt(6)
    ds_read_b64_tr_b16 a[192:193], v240 offset:16896
    ds_read_b64_tr_b16 a[194:195], v240 offset:19008
    v_mfma_f32_16x16x32_bf16 v[116:119], a[200:203], v[212:215], v[116:119]
    v_accvgpr_write_b32 a147, v51
    v_accvgpr_write_b32 a148, v52
    v_mfma_f32_16x16x32_bf16 v[124:127], a[204:207], v[212:215], v[124:127]
    s_add_u32 m0, s38, 137280
    ds_read_b64_tr_b16 a[196:197], v241 offset:16896
    ds_read_b64_tr_b16 a[198:199], v241 offset:19008
    v_mfma_f32_16x16x32_bf16 v[120:123], a[204:207], v[208:211], v[120:123]
    s_mov_b32 s45, 14336
    buffer_load_dwordx4 v20, s[20:23], s45 offen lds
    v_mfma_f32_16x16x32_bf16 v[96:99], a[208:211], v[216:219], v[96:99]
    s_waitcnt lgkmcnt(6)
    ds_read_b64_tr_b16 a[200:201], v242 offset:16896
    ds_read_b64_tr_b16 a[202:203], v242 offset:19008
    v_mfma_f32_16x16x32_bf16 v[100:103], a[208:211], v[220:223], v[100:103]
    v_accvgpr_write_b32 a149, v53
    v_mfma_f32_16x16x32_bf16 v[108:111], a[212:215], v[220:223], v[108:111]
    s_nop 0
    ds_read_b64_tr_b16 a[204:205], v243 offset:16896
    ds_read_b64_tr_b16 a[206:207], v243 offset:19008
    v_mfma_f32_16x16x32_bf16 v[104:107], a[212:215], v[216:219], v[104:107]
    v_accvgpr_write_b32 a150, v54
    v_mfma_f32_16x16x32_bf16 v[112:115], a[216:219], v[216:219], v[112:115]
    s_waitcnt lgkmcnt(6)
    ds_read_b64_tr_b16 a[208:209], v240 offset:21120
    ds_read_b64_tr_b16 a[210:211], v240 offset:23232
    v_mfma_f32_16x16x32_bf16 v[116:119], a[216:219], v[220:223], v[116:119]
    v_accvgpr_write_b32 a151, v55
    v_accvgpr_write_b32 a152, v56
    v_mfma_f32_16x16x32_bf16 v[124:127], a[220:223], v[220:223], v[124:127]
    s_add_u32 m0, s38, 138336
    ds_read_b64_tr_b16 a[212:213], v241 offset:21120
    ds_read_b64_tr_b16 a[214:215], v241 offset:23232
    v_mfma_f32_16x16x32_bf16 v[120:123], a[220:223], v[216:219], v[120:123]
    s_mov_b32 s45, 21504
    buffer_load_dwordx4 v20, s[20:23], s45 offen lds
    v_mfma_f32_16x16x32_bf16 v[96:99], a[192:195], v[224:227], v[96:99]
    s_waitcnt lgkmcnt(6)
    ds_read_b64_tr_b16 a[216:217], v242 offset:21120
    ds_read_b64_tr_b16 a[218:219], v242 offset:23232
    s_waitcnt vmcnt(24)
    v_mfma_f32_16x16x32_bf16 v[100:103], a[192:195], v[228:231], v[100:103]
    s_barrier
    v_mfma_f32_16x16x32_bf16 v[108:111], a[196:199], v[228:231], v[108:111]
    s_add_u32 m0, s39, 0
    ds_read_b64_tr_b16 a[220:221], v243 offset:21120
    ds_read_b64_tr_b16 a[222:223], v243 offset:23232
    v_mfma_f32_16x16x32_bf16 v[104:107], a[196:199], v[224:227], v[104:107]
    s_add_u32 s45, s98, 65536
    buffer_load_dwordx4 v17, s[12:15], s45 offen nt lds
    v_mfma_f32_16x16x32_bf16 v[112:115], a[200:203], v[224:227], v[112:115]
    s_waitcnt lgkmcnt(6)
    ds_read_b128 a[192:195], v4 offset:33792
    ds_read_b128 a[196:199], v7 offset:33792
    v_mfma_f32_16x16x32_bf16 v[116:119], a[200:203], v[228:231], v[116:119]
    v_accvgpr_write_b32 a153, v57
    v_mfma_f32_16x16x32_bf16 v[124:127], a[204:207], v[228:231], v[124:127]
    s_add_u32 m0, s39, 1024
    v_accvgpr_write_b32 a154, v58
    v_accvgpr_write_b32 a155, v59
    v_mfma_f32_16x16x32_bf16 v[120:123], a[204:207], v[224:227], v[120:123]
    s_nop 0
    buffer_load_dwordx4 v18, s[12:15], s45 offen nt lds
    v_mfma_f32_16x16x32_bf16 v[96:99], a[208:211], v[232:235], v[96:99]
    s_waitcnt lgkmcnt(4)
    ds_read_b128 a[200:203], v4 offset:35840
    ds_read_b128 a[204:207], v7 offset:35840
    v_mfma_f32_16x16x32_bf16 v[100:103], a[208:211], v[236:239], v[100:103]
    v_accvgpr_write_b32 a156, v60
    v_mfma_f32_16x16x32_bf16 v[108:111], a[212:215], v[236:239], v[108:111]
    s_add_u32 m0, s39, 2048
    v_accvgpr_write_b32 a157, v61
    v_accvgpr_write_b32 a158, v62
    v_mfma_f32_16x16x32_bf16 v[104:107], a[212:215], v[232:235], v[104:107]
    s_add_u32 s45, s98, 73728
    buffer_load_dwordx4 v17, s[12:15], s45 offen nt lds
    v_mfma_f32_16x16x32_bf16 v[112:115], a[216:219], v[232:235], v[112:115]
    s_waitcnt lgkmcnt(3)
    ds_read_b128 a[208:211], v4 offset:37888
    ds_read_b128 a[212:215], v7 offset:37888
    v_mfma_f32_16x16x32_bf16 v[116:119], a[216:219], v[236:239], v[116:119]
    v_accvgpr_write_b32 a159, v63
    v_mfma_f32_16x16x32_bf16 v[124:127], a[220:223], v[236:239], v[124:127]
    s_add_u32 m0, s39, 3072
    v_mfma_f32_16x16x32_bf16 v[120:123], a[220:223], v[232:235], v[120:123]
    s_nop 0
    buffer_load_dwordx4 v18, s[12:15], s45 offen nt lds
    v_mfma_f32_16x16x32_bf16 a[0:3], a[192:195], a[144:147], a[0:3]
    s_waitcnt lgkmcnt(3)
    ds_read_b128 a[216:219], v4 offset:39936
    ds_read_b128 a[220:223], v7 offset:39936
    s_waitcnt vmcnt(24)
    v_mfma_f32_16x16x32_bf16 a[8:11], a[192:195], a[148:151], a[8:11]
    s_barrier
    v_mfma_f32_16x16x32_bf16 a[8:11], a[196:199], a[156:159], a[8:11]
    v_mfma_f32_16x16x32_bf16 a[0:3], a[196:199], a[152:155], a[0:3]
    v_mfma_f32_16x16x32_bf16 a[4:7], a[200:203], a[144:147], a[4:7]
    s_waitcnt lgkmcnt(3)
    ds_read_b128 a[192:195], v4 offset:41984
    ds_read_b128 a[196:199], v7 offset:41984
    v_mfma_f32_16x16x32_bf16 a[12:15], a[200:203], a[148:151], a[12:15]
    v_mul_f32 v96, s36, v96
    v_mfma_f32_16x16x32_bf16 a[12:15], a[204:207], a[156:159], a[12:15]
    v_mul_f32 v97, s36, v97
    v_mul_f32 v98, s36, v98
    v_mfma_f32_16x16x32_bf16 a[4:7], a[204:207], a[152:155], a[4:7]
    v_mul_f32 v99, s36, v99
    v_mfma_f32_16x16x32_bf16 a[16:19], a[208:211], a[144:147], a[16:19]
    s_waitcnt lgkmcnt(3)
    ds_read_b128 a[200:203], v4 offset:44032
    ds_read_b128 a[204:207], v7 offset:44032
    v_mfma_f32_16x16x32_bf16 a[24:27], a[208:211], a[148:151], a[24:27]
    v_mul_f32 v100, s36, v100
    v_mfma_f32_16x16x32_bf16 a[24:27], a[212:215], a[156:159], a[24:27]
    v_mul_f32 v101, s36, v101
    v_mfma_f32_16x16x32_bf16 a[16:19], a[212:215], a[152:155], a[16:19]
    v_mul_f32 v102, s36, v102
    v_mul_f32 v103, s36, v103
    v_mfma_f32_16x16x32_bf16 a[20:23], a[216:219], a[144:147], a[20:23]
    s_waitcnt lgkmcnt(3)
    ds_read_b128 a[208:211], v4 offset:46080
    ds_read_b128 a[212:215], v7 offset:46080
    v_mfma_f32_16x16x32_bf16 a[28:31], a[216:219], a[148:151], a[28:31]
    v_mul_f32 v104, s36, v104
    v_mfma_f32_16x16x32_bf16 a[28:31], a[220:223], a[156:159], a[28:31]
    v_mul_f32 v105, s36, v105
    v_mfma_f32_16x16x32_bf16 a[20:23], a[220:223], a[152:155], a[20:23]
    v_mul_f32 v106, s36, v106
    v_mul_f32 v107, s36, v107
    v_mfma_f32_16x16x32_bf16 a[32:35], a[192:195], a[144:147], a[32:35]
    s_waitcnt lgkmcnt(3)
    ds_read_b128 a[216:219], v4 offset:48128
    ds_read_b128 a[220:223], v7 offset:48128
    v_mfma_f32_16x16x32_bf16 a[40:43], a[192:195], a[148:151], a[40:43]
    v_mul_f32 v108, s36, v108
    v_mfma_f32_16x16x32_bf16 a[40:43], a[196:199], a[156:159], a[40:43]
    v_mul_f32 v109, s36, v109
    v_mfma_f32_16x16x32_bf16 a[32:35], a[196:199], a[152:155], a[32:35]
    v_mul_f32 v110, s36, v110
    v_mfma_f32_16x16x32_bf16 a[36:39], a[200:203], a[144:147], a[36:39]
    s_waitcnt lgkmcnt(3)
    ds_read_b128 a[192:195], v5 offset:0
    ds_read_b128 a[196:199], v8 offset:0
    v_mfma_f32_16x16x32_bf16 a[44:47], a[200:203], a[148:151], a[44:47]
    v_mul_f32 v111, s36, v111
    v_cvt_pk_bf16_f32 v48, v96, v97
    v_mfma_f32_16x16x32_bf16 a[44:47], a[204:207], a[156:159], a[44:47]
    v_cvt_pk_bf16_f32 v49, v98, v99
    v_mfma_f32_16x16x32_bf16 a[36:39], a[204:207], a[152:155], a[36:39]
    v_cvt_pk_bf16_f32 v50, v104, v105
    v_mfma_f32_16x16x32_bf16 a[48:51], a[208:211], a[144:147], a[48:51]
    s_waitcnt lgkmcnt(3)
    ds_read_b128 a[200:203], v5 offset:2048
    ds_read_b128 a[204:207], v8 offset:2048
    v_mfma_f32_16x16x32_bf16 a[56:59], a[208:211], a[148:151], a[56:59]
    v_cvt_pk_bf16_f32 v51, v106, v107
    v_mfma_f32_16x16x32_bf16 a[56:59], a[212:215], a[156:159], a[56:59]
    v_cvt_pk_bf16_f32 v52, v100, v101
    v_cvt_pk_bf16_f32 v53, v102, v103
    v_mfma_f32_16x16x32_bf16 a[48:51], a[212:215], a[152:155], a[48:51]
    v_cvt_pk_bf16_f32 v54, v108, v109
    v_mfma_f32_16x16x32_bf16 a[52:55], a[216:219], a[144:147], a[52:55]
    s_waitcnt lgkmcnt(3)
    ds_read_b128 a[208:211], v5 offset:4096
    ds_read_b128 a[212:215], v8 offset:4096
    v_mfma_f32_16x16x32_bf16 a[60:63], a[216:219], a[148:151], a[60:63]
    v_cvt_pk_bf16_f32 v55, v110, v111
    v_mfma_f32_16x16x32_bf16 a[60:63], a[220:223], a[156:159], a[60:63]
    v_mul_f32 v112, s36, v112
    v_mul_f32 v113, s36, v113
    v_mfma_f32_16x16x32_bf16 a[52:55], a[220:223], a[152:155], a[52:55]
    v_mul_f32 v114, s36, v114
    v_mfma_f32_16x16x32_bf16 a[64:67], a[192:195], a[144:147], a[64:67]
    s_waitcnt lgkmcnt(3)
    ds_read_b128 a[216:219], v5 offset:6144
    ds_read_b128 a[220:223], v8 offset:6144
    v_mfma_f32_16x16x32_bf16 a[72:75], a[192:195], a[148:151], a[72:75]
    s_barrier
    v_mfma_f32_16x16x32_bf16 a[72:75], a[196:199], a[156:159], a[72:75]
    v_mul_f32 v115, s36, v115
    v_mfma_f32_16x16x32_bf16 a[64:67], a[196:199], a[152:155], a[64:67]
    v_mul_f32 v116, s36, v116
    v_mfma_f32_16x16x32_bf16 a[68:71], a[200:203], a[144:147], a[68:71]
    s_waitcnt lgkmcnt(3)
    ds_read_b128 a[192:195], v5 offset:8192
    ds_read_b128 a[196:199], v8 offset:8192
    v_mfma_f32_16x16x32_bf16 a[76:79], a[200:203], a[148:151], a[76:79]
    v_mul_f32 v117, s36, v117
    v_mul_f32 v118, s36, v118
    v_mfma_f32_16x16x32_bf16 a[76:79], a[204:207], a[156:159], a[76:79]
    s_add_u32 m0, s39, 33792
    v_mul_f32 v119, s36, v119
    v_mfma_f32_16x16x32_bf16 a[68:71], a[204:207], a[152:155], a[68:71]
    s_add_u32 s45, s99, 0
    buffer_load_dwordx4 v17, s[12:15], s45 offen nt lds
    v_mfma_f32_16x16x32_bf16 a[80:83], a[208:211], a[144:147], a[80:83]
    s_waitcnt lgkmcnt(3)
    ds_read_b128 a[200:203], v5 offset:10240
    ds_read_b128 a[204:207], v8 offset:10240
    v_mfma_f32_16x16x32_bf16 a[88:91], a[208:211], a[148:151], a[88:91]
    v_mul_f32 v120, s36, v120
    v_mfma_f32_16x16x32_bf16 a[88:91], a[212:215], a[156:159], a[88:91]
    v_mul_f32 v121, s36, v121
    v_mul_f32 v122, s36, v122
    v_mfma_f32_16x16x32_bf16 a[80:83], a[212:215], a[152:155], a[80:83]
    v_mul_f32 v123, s36, v123
    v_mfma_f32_16x16x32_bf16 a[84:87], a[216:219], a[144:147], a[84:87]
    s_waitcnt lgkmcnt(3)
    ds_read_b128 a[208:211], v5 offset:12288
    ds_read_b128 a[212:215], v8 offset:12288
    v_mfma_f32_16x16x32_bf16 a[92:95], a[216:219], a[148:151], a[92:95]
    v_mul_f32 v124, s36, v124
    v_mfma_f32_16x16x32_bf16 a[92:95], a[220:223], a[156:159], a[92:95]
    s_add_u32 m0, s39, 34816
    v_mul_f32 v125, s36, v125
    v_mfma_f32_16x16x32_bf16 a[84:87], a[220:223], a[152:155], a[84:87]
    s_nop 0
    buffer_load_dwordx4 v18, s[12:15], s45 offen nt lds
    v_mfma_f32_16x16x32_bf16 a[96:99], a[192:195], a[144:147], a[96:99]
    s_waitcnt lgkmcnt(3)
    ds_read_b128 a[216:219], v5 offset:14336
    ds_read_b128 a[220:223], v8 offset:14336
    v_mfma_f32_16x16x32_bf16 a[104:107], a[192:195], a[148:151], a[104:107]
    v_mul_f32 v126, s36, v126
    v_mul_f32 v127, s36, v127
    v_mfma_f32_16x16x32_bf16 a[104:107], a[196:199], a[156:159], a[104:107]
    v_cvt_pk_bf16_f32 v56, v112, v113
    v_mfma_f32_16x16x32_bf16 a[96:99], a[196:199], a[152:155], a[96:99]
    v_cvt_pk_bf16_f32 v57, v114, v115
    v_mfma_f32_16x16x32_bf16 a[100:103], a[200:203], a[144:147], a[100:103]
    s_waitcnt lgkmcnt(3)
    ds_read_b64_tr_b16 a[192:193], v240 offset:25344
    ds_read_b64_tr_b16 a[194:195], v240 offset:27456
    v_mfma_f32_16x16x32_bf16 a[108:111], a[200:203], a[148:151], a[108:111]
    v_cvt_pk_bf16_f32 v58, v120, v121
    v_cvt_pk_bf16_f32 v59, v122, v123
    v_mfma_f32_16x16x32_bf16 a[108:111], a[204:207], a[156:159], a[108:111]
    s_add_u32 m0, s39, 35840
    ds_read_b64_tr_b16 a[196:197], v241 offset:25344
    ds_read_b64_tr_b16 a[198:199], v241 offset:27456
    v_mfma_f32_16x16x32_bf16 a[100:103], a[204:207], a[152:155], a[100:103]
    s_add_u32 s45, s99, 8192
    buffer_load_dwordx4 v17, s[12:15], s45 offen nt lds
    v_mfma_f32_16x16x32_bf16 a[112:115], a[208:211], a[144:147], a[112:115]
    s_waitcnt lgkmcnt(5)
    ds_read_b64_tr_b16 a[200:201], v242 offset:25344
    ds_read_b64_tr_b16 a[202:203], v242 offset:27456
    v_mfma_f32_16x16x32_bf16 a[120:123], a[208:211], a[148:151], a[120:123]
    v_cvt_pk_bf16_f32 v60, v116, v117
    v_mfma_f32_16x16x32_bf16 a[120:123], a[212:215], a[156:159], a[120:123]
    s_nop 0
    ds_read_b64_tr_b16 a[204:205], v243 offset:25344
    ds_read_b64_tr_b16 a[206:207], v243 offset:27456
    v_mfma_f32_16x16x32_bf16 a[112:115], a[212:215], a[152:155], a[112:115]
    v_cvt_pk_bf16_f32 v61, v118, v119
    v_mfma_f32_16x16x32_bf16 a[116:119], a[216:219], a[144:147], a[116:119]
    s_waitcnt lgkmcnt(6)
    ds_read_b64_tr_b16 a[208:209], v240 offset:29568
    ds_read_b64_tr_b16 a[210:211], v240 offset:31680
    v_mfma_f32_16x16x32_bf16 a[124:127], a[216:219], a[148:151], a[124:127]
    v_cvt_pk_bf16_f32 v62, v124, v125
    v_mfma_f32_16x16x32_bf16 a[124:127], a[220:223], a[156:159], a[124:127]
    s_add_u32 m0, s39, 36864
    ds_read_b64_tr_b16 a[212:213], v241 offset:29568
    ds_read_b64_tr_b16 a[214:215], v241 offset:31680
    v_mfma_f32_16x16x32_bf16 a[116:119], a[220:223], a[152:155], a[116:119]
    s_nop 0
    buffer_load_dwordx4 v18, s[12:15], s45 offen nt lds
    v_mfma_f32_16x16x32_bf16 v[64:67], a[192:195], v[128:131], 0
    s_waitcnt lgkmcnt(6)
    ds_read_b64_tr_b16 a[216:217], v242 offset:29568
    ds_read_b64_tr_b16 a[218:219], v242 offset:31680
    s_waitcnt vmcnt(24)
    v_mfma_f32_16x16x32_bf16 v[68:71], a[192:195], v[132:135], 0
    s_barrier
    v_mfma_f32_16x16x32_bf16 v[76:79], a[196:199], v[132:135], 0
    s_add_u32 m0, s38, 50688
    ds_read_b64_tr_b16 a[220:221], v243 offset:29568
    ds_read_b64_tr_b16 a[222:223], v243 offset:31680
    v_mfma_f32_16x16x32_bf16 v[72:75], a[196:199], v[128:131], 0
    s_mov_b32 s45, 131072
    buffer_load_dwordx4 v14, s[12:15], s45 offen nt lds
    v_mfma_f32_16x16x32_bf16 v[80:83], a[200:203], v[128:131], 0
    s_waitcnt lgkmcnt(6)
    ds_read_b64_tr_b16 a[192:193], v244 offset:16896
    ds_read_b64_tr_b16 a[194:195], v244 offset:19008
    v_mfma_f32_16x16x32_bf16 v[84:87], a[200:203], v[132:135], 0
    v_cvt_pk_bf16_f32 v63, v126, v127
    v_mfma_f32_16x16x32_bf16 v[92:95], a[204:207], v[132:135], 0
    s_add_u32 m0, s38, 51232
    ds_read_b64_tr_b16 a[196:197], v245 offset:16896
    ds_read_b64_tr_b16 a[198:199], v245 offset:19008
    v_mfma_f32_16x16x32_bf16 v[88:91], a[204:207], v[128:131], 0
    s_nop 0
    buffer_load_dwordx4 v14, s[12:15], s45 offen offset:512 nt lds
    v_mfma_f32_16x16x32_bf16 v[64:67], a[208:211], v[136:139], v[64:67]
    s_waitcnt lgkmcnt(6)
    ds_read_b64_tr_b16 a[200:201], v246 offset:16896
    ds_read_b64_tr_b16 a[202:203], v246 offset:19008
    v_mfma_f32_16x16x32_bf16 v[68:71], a[208:211], v[140:143], v[68:71]
    v_permlane32_swap_b32 v48, v50
    v_mfma_f32_16x16x32_bf16 v[76:79], a[212:215], v[140:143], v[76:79]
    s_add_u32 m0, s38, 51776
    ds_read_b64_tr_b16 a[204:205], v247 offset:16896
    ds_read_b64_tr_b16 a[206:207], v247 offset:19008
    v_mfma_f32_16x16x32_bf16 v[72:75], a[212:215], v[136:139], v[72:75]
    s_nop 0
    buffer_load_dwordx4 v14, s[12:15], s45 offen offset:1024 nt lds
    v_mfma_f32_16x16x32_bf16 v[80:83], a[216:219], v[136:139], v[80:83]
    s_waitcnt lgkmcnt(6)
    ds_read_b64_tr_b16 a[208:209], v244 offset:21120
    ds_read_b64_tr_b16 a[210:211], v244 offset:23232
    v_mfma_f32_16x16x32_bf16 v[84:87], a[216:219], v[140:143], v[84:87]
    v_permlane32_swap_b32 v49, v51
    v_mfma_f32_16x16x32_bf16 v[92:95], a[220:223], v[140:143], v[92:95]
    s_add_u32 m0, s38, 52320
    ds_read_b64_tr_b16 a[212:213], v245 offset:21120
    ds_read_b64_tr_b16 a[214:215], v245 offset:23232
    v_mfma_f32_16x16x32_bf16 v[88:91], a[220:223], v[136:139], v[88:91]
    s_nop 0
    buffer_load_dwordx4 v14, s[12:15], s45 offen offset:1536 nt lds
    v_mfma_f32_16x16x32_bf16 v[64:67], a[192:195], v[144:147], v[64:67]
    s_waitcnt lgkmcnt(6)
    ds_read_b64_tr_b16 a[216:217], v246 offset:21120
    ds_read_b64_tr_b16 a[218:219], v246 offset:23232
    s_waitcnt vmcnt(24)
    v_mfma_f32_16x16x32_bf16 v[68:71], a[192:195], v[148:151], v[68:71]
    s_barrier
    v_mfma_f32_16x16x32_bf16 v[76:79], a[196:199], v[148:151], v[76:79]
    s_nop 0
    ds_read_b64_tr_b16 a[220:221], v247 offset:21120
    ds_read_b64_tr_b16 a[222:223], v247 offset:23232
    v_mfma_f32_16x16x32_bf16 v[72:75], a[196:199], v[144:147], v[72:75]
    s_mov_b32 s93, s52
    v_mfma_f32_16x16x32_bf16 v[80:83], a[200:203], v[144:147], v[80:83]
    s_waitcnt lgkmcnt(6)
    ds_read_b64_tr_b16 a[192:193], v244 offset:25344
    ds_read_b64_tr_b16 a[194:195], v244 offset:27456
    v_mfma_f32_16x16x32_bf16 v[84:87], a[200:203], v[148:151], v[84:87]
    s_mul_i32 s46, s50, 896
    v_permlane32_swap_b32 v52, v54
    v_mfma_f32_16x16x32_bf16 v[92:95], a[204:207], v[148:151], v[92:95]
    s_add_u32 m0, s38, 16896
    ds_read_b64_tr_b16 a[196:197], v245 offset:25344
    ds_read_b64_tr_b16 a[198:199], v245 offset:27456
    v_mfma_f32_16x16x32_bf16 v[88:91], a[204:207], v[144:147], v[88:91]
    s_mov_b32 s45, 114688
    buffer_load_dwordx4 v20, s[20:23], s45 offen lds
    v_mfma_f32_16x16x32_bf16 v[64:67], a[208:211], v[152:155], v[64:67]
    s_waitcnt lgkmcnt(6)
    ds_read_b64_tr_b16 a[200:201], v246 offset:25344
    ds_read_b64_tr_b16 a[202:203], v246 offset:27456
    v_mfma_f32_16x16x32_bf16 v[68:71], a[208:211], v[156:159], v[68:71]
    s_lshr_b32 s34, s93, 2
    v_permlane32_swap_b32 v53, v55
    v_mfma_f32_16x16x32_bf16 v[76:79], a[212:215], v[156:159], v[76:79]
    s_nop 0
    ds_read_b64_tr_b16 a[204:205], v247 offset:25344
    ds_read_b64_tr_b16 a[206:207], v247 offset:27456
    v_mfma_f32_16x16x32_bf16 v[72:75], a[212:215], v[152:155], v[72:75]
    s_mul_i32 s54, s34, 2048
    v_mfma_f32_16x16x32_bf16 v[80:83], a[216:219], v[152:155], v[80:83]
    s_waitcnt lgkmcnt(6)
    ds_read_b64_tr_b16 a[208:209], v244 offset:29568
    ds_read_b64_tr_b16 a[210:211], v244 offset:31680
    v_mfma_f32_16x16x32_bf16 v[84:87], a[216:219], v[156:159], v[84:87]
    s_mul_i32 s30, s34, 28672
    v_permlane32_swap_b32 v56, v58
    v_mfma_f32_16x16x32_bf16 v[92:95], a[220:223], v[156:159], v[92:95]
    s_add_u32 m0, s38, 17952
    ds_read_b64_tr_b16 a[212:213], v245 offset:29568
    ds_read_b64_tr_b16 a[214:215], v245 offset:31680
    v_mfma_f32_16x16x32_bf16 v[88:91], a[220:223], v[152:155], v[88:91]
    s_mov_b32 s45, 121856
    buffer_load_dwordx4 v20, s[20:23], s45 offen lds
    v_mfma_f32_16x16x32_bf16 v[64:67], a[192:195], v[160:163], v[64:67]
    s_waitcnt lgkmcnt(6)
    ds_read_b64_tr_b16 a[216:217], v246 offset:29568
    ds_read_b64_tr_b16 a[218:219], v246 offset:31680
    v_mfma_f32_16x16x32_bf16 v[68:71], a[192:195], v[164:167], v[68:71]
    s_lshl_b32 s34, s34, 1
    v_mfma_f32_16x16x32_bf16 v[76:79], a[196:199], v[164:167], v[76:79]
    s_nop 0
    ds_read_b64_tr_b16 a[220:221], v247 offset:29568
    ds_read_b64_tr_b16 a[222:223], v247 offset:31680
    v_mfma_f32_16x16x32_bf16 v[72:75], a[196:199], v[160:163], v[72:75]
    s_lshl_b32 s32, s51, 3
    v_permlane32_swap_b32 v57, v59
    v_mfma_f32_16x16x32_bf16 v[80:83], a[200:203], v[160:163], v[80:83]
    s_waitcnt lgkmcnt(6)
    ds_read_b64_tr_b16 a[192:193], v244 offset:33792
    ds_read_b64_tr_b16 a[194:195], v244 offset:35904
    v_mfma_f32_16x16x32_bf16 v[84:87], a[200:203], v[164:167], v[84:87]
    s_add_u32 s32, s32, s34
    v_permlane32_swap_b32 v60, v62
    v_mfma_f32_16x16x32_bf16 v[92:95], a[204:207], v[164:167], v[92:95]
    s_add_u32 m0, s38, 19008
    ds_read_b64_tr_b16 a[196:197], v245 offset:33792
    ds_read_b64_tr_b16 a[198:199], v245 offset:35904
    v_mfma_f32_16x16x32_bf16 v[88:91], a[204:207], v[160:163], v[88:91]
    s_mov_b32 s45, 129024
    buffer_load_dwordx4 v20, s[20:23], s45 offen lds
    v_mfma_f32_16x16x32_bf16 v[64:67], a[208:211], v[168:171], v[64:67]
    s_waitcnt lgkmcnt(6)
    ds_read_b64_tr_b16 a[200:201], v246 offset:33792
    ds_read_b64_tr_b16 a[202:203], v246 offset:35904
    v_mfma_f32_16x16x32_bf16 v[68:71], a[208:211], v[172:175], v[68:71]
    s_and_b32 s34, s93, 1
    v_mfma_f32_16x16x32_bf16 v[76:79], a[212:215], v[172:175], v[76:79]
    s_nop 0
    ds_read_b64_tr_b16 a[204:205], v247 offset:33792
    ds_read_b64_tr_b16 a[206:207], v247 offset:35904
    v_mfma_f32_16x16x32_bf16 v[72:75], a[212:215], v[168:171], v[72:75]
    s_add_u32 s32, s32, s34
    v_permlane32_swap_b32 v61, v63
    v_mfma_f32_16x16x32_bf16 v[80:83], a[216:219], v[168:171], v[80:83]
    s_waitcnt lgkmcnt(6)
    ds_read_b64_tr_b16 a[208:209], v244 offset:38016
    ds_read_b64_tr_b16 a[210:211], v244 offset:40128
    v_mfma_f32_16x16x32_bf16 v[84:87], a[216:219], v[172:175], v[84:87]
    s_mul_i32 s32, s32, 28672
    v_permlane16_swap_b32 v48, v50
    v_mfma_f32_16x16x32_bf16 v[92:95], a[220:223], v[172:175], v[92:95]
    s_add_u32 m0, s38, 20064
    ds_read_b64_tr_b16 a[212:213], v245 offset:38016
    ds_read_b64_tr_b16 a[214:215], v245 offset:40128
    v_mfma_f32_16x16x32_bf16 v[88:91], a[220:223], v[168:171], v[88:91]
    s_mov_b32 s45, 136192
    buffer_load_dwordx4 v20, s[20:23], s45 offen lds
    v_mfma_f32_16x16x32_bf16 v[64:67], a[192:195], v[176:179], v[64:67]
    s_waitcnt lgkmcnt(6)
    ds_read_b64_tr_b16 a[216:217], v246 offset:38016
    ds_read_b64_tr_b16 a[218:219], v246 offset:40128
    s_waitcnt vmcnt(24)
    v_mfma_f32_16x16x32_bf16 v[68:71], a[192:195], v[180:183], v[68:71]
    s_barrier
    v_mfma_f32_16x16x32_bf16 v[76:79], a[196:199], v[180:183], v[76:79]
    s_nop 0
    ds_read_b64_tr_b16 a[220:221], v247 offset:38016
    ds_read_b64_tr_b16 a[222:223], v247 offset:40128
    v_mfma_f32_16x16x32_bf16 v[72:75], a[196:199], v[176:179], v[72:75]
    s_and_b32 s34, s93, 3
    v_mfma_f32_16x16x32_bf16 v[80:83], a[200:203], v[176:179], v[80:83]
    s_waitcnt lgkmcnt(6)
    ds_read_b64_tr_b16 a[192:193], v244 offset:42240
    ds_read_b64_tr_b16 a[194:195], v244 offset:44352
    v_mfma_f32_16x16x32_bf16 v[84:87], a[200:203], v[180:183], v[84:87]
    s_lshl2_add_u32 s34, s3, s34
    v_permlane16_swap_b32 v49, v51
    v_mfma_f32_16x16x32_bf16 v[92:95], a[204:207], v[180:183], v[92:95]
    s_add_u32 m0, s38, 67584
    ds_read_b64_tr_b16 a[196:197], v245 offset:42240
    ds_read_b64_tr_b16 a[198:199], v245 offset:44352
    v_mfma_f32_16x16x32_bf16 v[88:91], a[204:207], v[176:179], v[88:91]
    s_mov_b32 s45, 0
    buffer_load_dwordx4 v19, s[16:19], s45 offen nt lds
    v_mfma_f32_16x16x32_bf16 v[64:67], a[208:211], v[184:187], v[64:67]
    s_waitcnt lgkmcnt(6)
    ds_read_b64_tr_b16 a[200:201], v246 offset:42240
    ds_read_b64_tr_b16 a[202:203], v246 offset:44352
    v_mfma_f32_16x16x32_bf16 v[68:71], a[208:211], v[188:191], v[68:71]
    s_lshl_b32 s44, s34, 10
    v_permlane16_swap_b32 v52, v54
    v_mfma_f32_16x16x32_bf16 v[76:79], a[212:215], v[188:191], v[76:79]
    s_nop 0
    ds_read_b64_tr_b16 a[204:205], v247 offset:42240
    ds_read_b64_tr_b16 a[206:207], v247 offset:44352
    v_mfma_f32_16x16x32_bf16 v[72:75], a[212:215], v[184:187], v[72:75]
    s_add_u32 s30, s30, s44
    v_mfma_f32_16x16x32_bf16 v[80:83], a[216:219], v[184:187], v[80:83]
    s_waitcnt lgkmcnt(6)
    ds_read_b64_tr_b16 a[208:209], v244 offset:46464
    ds_read_b64_tr_b16 a[210:211], v244 offset:48576
    v_mfma_f32_16x16x32_bf16 v[84:87], a[216:219], v[188:191], v[84:87]
    s_lshr_b32 s34, s34, 1
    v_permlane16_swap_b32 v53, v55
    v_mfma_f32_16x16x32_bf16 v[92:95], a[220:223], v[188:191], v[92:95]
    s_add_u32 m0, s38, 68128
    ds_read_b64_tr_b16 a[212:213], v245 offset:46464
    ds_read_b64_tr_b16 a[214:215], v245 offset:48576
    v_mfma_f32_16x16x32_bf16 v[88:91], a[220:223], v[184:187], v[88:91]
    s_lshl_b32 s34, s34, 6
    buffer_load_dwordx4 v19, s[16:19], s45 offen offset:512 nt lds
    v_mfma_f32_16x16x32_bf16 v[64:67], a[192:195], v[192:195], v[64:67]
    s_waitcnt lgkmcnt(6)
    ds_read_b64_tr_b16 a[216:217], v246 offset:46464
    ds_read_b64_tr_b16 a[218:219], v246 offset:48576
    v_mfma_f32_16x16x32_bf16 v[68:71], a[192:195], v[196:199], v[68:71]
    s_add_u32 s32, s32, s34
    v_mfma_f32_16x16x32_bf16 v[76:79], a[196:199], v[196:199], v[76:79]
    s_nop 0
    ds_read_b64_tr_b16 a[220:221], v247 offset:46464
    ds_read_b64_tr_b16 a[222:223], v247 offset:48576
    v_mfma_f32_16x16x32_bf16 v[72:75], a[196:199], v[192:195], v[72:75]
    s_add_u32 s32, s32, s46
    v_permlane16_swap_b32 v56, v58
    v_mfma_f32_16x16x32_bf16 v[80:83], a[200:203], v[192:195], v[80:83]
    s_waitcnt lgkmcnt(6)
    ds_read_b64_tr_b16 a[192:193], v248 offset:0
    ds_read_b64_tr_b16 a[194:195], v248 offset:2112
    v_mfma_f32_16x16x32_bf16 v[84:87], a[200:203], v[196:199], v[84:87]
    s_add_u32 s29, s3, 4
    v_permlane16_swap_b32 v57, v59
    v_mfma_f32_16x16x32_bf16 v[92:95], a[204:207], v[196:199], v[92:95]
    s_add_u32 m0, s38, 68672
    ds_read_b64_tr_b16 a[196:197], v249 offset:0
    ds_read_b64_tr_b16 a[198:199], v249 offset:2112
    v_mfma_f32_16x16x32_bf16 v[88:91], a[204:207], v[192:195], v[88:91]
    s_mov_b32 s28, s52
    buffer_load_dwordx4 v19, s[16:19], s45 offen offset:1024 nt lds
    v_mfma_f32_16x16x32_bf16 v[64:67], a[208:211], v[200:203], v[64:67]
    s_waitcnt lgkmcnt(6)
    ds_read_b64_tr_b16 a[200:201], v250 offset:0
    ds_read_b64_tr_b16 a[202:203], v250 offset:2112
    v_mfma_f32_16x16x32_bf16 v[68:71], a[208:211], v[204:207], v[68:71]
    s_lshr_b32 s34, s28, 2
    v_mfma_f32_16x16x32_bf16 v[76:79], a[212:215], v[204:207], v[76:79]
    s_nop 0
    ds_read_b64_tr_b16 a[204:205], v251 offset:0
    ds_read_b64_tr_b16 a[206:207], v251 offset:2112
    v_mfma_f32_16x16x32_bf16 v[72:75], a[212:215], v[200:203], v[72:75]
    s_mul_i32 s55, s34, 2048
    v_permlane16_swap_b32 v60, v62
    v_mfma_f32_16x16x32_bf16 v[80:83], a[216:219], v[200:203], v[80:83]
    s_waitcnt lgkmcnt(6)
    ds_read_b64_tr_b16 a[208:209], v248 offset:4224
    ds_read_b64_tr_b16 a[210:211], v248 offset:6336
    v_mfma_f32_16x16x32_bf16 v[84:87], a[216:219], v[204:207], v[84:87]
    s_mul_i32 s31, s34, 28672
    v_permlane16_swap_b32 v61, v63
    v_mfma_f32_16x16x32_bf16 v[92:95], a[220:223], v[204:207], v[92:95]
    s_add_u32 m0, s38, 69216
    ds_read_b64_tr_b16 a[212:213], v249 offset:4224
    ds_read_b64_tr_b16 a[214:215], v249 offset:6336
    v_mfma_f32_16x16x32_bf16 v[88:91], a[220:223], v[200:203], v[88:91]
    s_lshl_b32 s34, s34, 1
    buffer_load_dwordx4 v19, s[16:19], s45 offen offset:1536 nt lds
    v_mfma_f32_16x16x32_bf16 v[64:67], a[192:195], v[208:211], v[64:67]
    s_waitcnt lgkmcnt(6)
    ds_read_b64_tr_b16 a[216:217], v250 offset:4224
    ds_read_b64_tr_b16 a[218:219], v250 offset:6336
    s_waitcnt vmcnt(24)
    v_mfma_f32_16x16x32_bf16 v[68:71], a[192:195], v[212:215], v[68:71]
    s_barrier
    v_mfma_f32_16x16x32_bf16 v[76:79], a[196:199], v[212:215], v[76:79]
    s_nop 0
    ds_read_b64_tr_b16 a[220:221], v251 offset:4224
    ds_read_b64_tr_b16 a[222:223], v251 offset:6336
    v_mfma_f32_16x16x32_bf16 v[72:75], a[196:199], v[208:211], v[72:75]
    s_lshl_b32 s33, s51, 3
    v_accvgpr_write_b32 a160, v48
    v_mfma_f32_16x16x32_bf16 v[80:83], a[200:203], v[208:211], v[80:83]
    s_waitcnt lgkmcnt(6)
    ds_read_b64_tr_b16 a[192:193], v248 offset:8448
    ds_read_b64_tr_b16 a[194:195], v248 offset:10560
    v_mfma_f32_16x16x32_bf16 v[84:87], a[200:203], v[212:215], v[84:87]
    s_add_u32 s33, s33, s34
    v_accvgpr_write_b32 a161, v49
    v_mfma_f32_16x16x32_bf16 v[92:95], a[204:207], v[212:215], v[92:95]
    s_add_u32 m0, s39, 84480
    ds_read_b64_tr_b16 a[196:197], v249 offset:8448
    ds_read_b64_tr_b16 a[198:199], v249 offset:10560
    v_mfma_f32_16x16x32_bf16 v[88:91], a[204:207], v[208:211], v[88:91]
    s_add_u32 s45, s99, 65536
    buffer_load_dwordx4 v17, s[12:15], s45 offen nt lds
    v_mfma_f32_16x16x32_bf16 v[64:67], a[208:211], v[216:219], v[64:67]
    s_waitcnt lgkmcnt(6)
    ds_read_b64_tr_b16 a[200:201], v250 offset:8448
    ds_read_b64_tr_b16 a[202:203], v250 offset:10560
    v_mfma_f32_16x16x32_bf16 v[68:71], a[208:211], v[220:223], v[68:71]
    s_and_b32 s34, s28, 1
    v_accvgpr_write_b32 a162, v50
    v_mfma_f32_16x16x32_bf16 v[76:79], a[212:215], v[220:223], v[76:79]
    s_nop 0
    ds_read_b64_tr_b16 a[204:205], v251 offset:8448
    ds_read_b64_tr_b16 a[206:207], v251 offset:10560
    v_mfma_f32_16x16x32_bf16 v[72:75], a[212:215], v[216:219], v[72:75]
    s_add_u32 s33, s33, s34
    v_accvgpr_write_b32 a163, v51
    v_mfma_f32_16x16x32_bf16 v[80:83], a[216:219], v[216:219], v[80:83]
    s_waitcnt lgkmcnt(6)
    ds_read_b64_tr_b16 a[208:209], v248 offset:12672
    ds_read_b64_tr_b16 a[210:211], v248 offset:14784
    v_mfma_f32_16x16x32_bf16 v[84:87], a[216:219], v[220:223], v[84:87]
    s_mul_i32 s33, s33, 28672
    v_accvgpr_write_b32 a164, v52
    v_accvgpr_write_b32 a165, v53
    v_mfma_f32_16x16x32_bf16 v[92:95], a[220:223], v[220:223], v[92:95]
    s_add_u32 m0, s39, 85504
    ds_read_b64_tr_b16 a[212:213], v249 offset:12672
    ds_read_b64_tr_b16 a[214:215], v249 offset:14784
    v_mfma_f32_16x16x32_bf16 v[88:91], a[220:223], v[216:219], v[88:91]
    s_and_b32 s34, s28, 3
    buffer_load_dwordx4 v18, s[12:15], s45 offen nt lds
    v_mfma_f32_16x16x32_bf16 v[64:67], a[192:195], v[224:227], v[64:67]
    s_waitcnt lgkmcnt(6)
    ds_read_b64_tr_b16 a[216:217], v250 offset:12672
    ds_read_b64_tr_b16 a[218:219], v250 offset:14784
    v_mfma_f32_16x16x32_bf16 v[68:71], a[192:195], v[228:231], v[68:71]
    s_lshl2_add_u32 s34, s29, s34
    v_accvgpr_write_b32 a166, v54
    v_mfma_f32_16x16x32_bf16 v[76:79], a[196:199], v[228:231], v[76:79]
    s_nop 0
    ds_read_b64_tr_b16 a[220:221], v251 offset:12672
    ds_read_b64_tr_b16 a[222:223], v251 offset:14784
    v_mfma_f32_16x16x32_bf16 v[72:75], a[196:199], v[224:227], v[72:75]
    s_lshl_b32 s44, s34, 10
    v_accvgpr_write_b32 a167, v55
    v_mfma_f32_16x16x32_bf16 v[80:83], a[200:203], v[224:227], v[80:83]
    s_waitcnt lgkmcnt(6)
    ds_read_b128 a[192:195], v6 offset:16896
    ds_read_b128 a[196:199], v9 offset:16896
    v_mfma_f32_16x16x32_bf16 v[84:87], a[200:203], v[228:231], v[84:87]
    s_add_u32 s31, s31, s44
    v_accvgpr_write_b32 a168, v56
    v_accvgpr_write_b32 a169, v57
    v_mfma_f32_16x16x32_bf16 v[92:95], a[204:207], v[228:231], v[92:95]
    s_add_u32 m0, s39, 86528
    v_accvgpr_write_b32 a170, v58
    v_mfma_f32_16x16x32_bf16 v[88:91], a[204:207], v[224:227], v[88:91]
    s_add_u32 s45, s99, 73728
    buffer_load_dwordx4 v17, s[12:15], s45 offen nt lds
    v_mfma_f32_16x16x32_bf16 v[64:67], a[208:211], v[232:235], v[64:67]
    s_waitcnt lgkmcnt(4)
    ds_read_b128 a[200:203], v6 offset:18944
    ds_read_b128 a[204:207], v9 offset:18944
    v_mfma_f32_16x16x32_bf16 v[68:71], a[208:211], v[236:239], v[68:71]
    s_lshr_b32 s34, s34, 1
    v_accvgpr_write_b32 a171, v59
    v_mfma_f32_16x16x32_bf16 v[76:79], a[212:215], v[236:239], v[76:79]
    v_accvgpr_write_b32 a172, v60
    v_mfma_f32_16x16x32_bf16 v[72:75], a[212:215], v[232:235], v[72:75]
    s_lshl_b32 s34, s34, 6
    v_accvgpr_write_b32 a173, v61
    v_accvgpr_write_b32 a174, v62
    v_mfma_f32_16x16x32_bf16 v[80:83], a[216:219], v[232:235], v[80:83]
    s_waitcnt lgkmcnt(3)
    ds_read_b128 a[208:211], v6 offset:20992
    ds_read_b128 a[212:215], v9 offset:20992
    v_mfma_f32_16x16x32_bf16 v[84:87], a[216:219], v[236:239], v[84:87]
    s_add_u32 s33, s33, s34
    v_accvgpr_write_b32 a175, v63
    v_mfma_f32_16x16x32_bf16 v[92:95], a[220:223], v[236:239], v[92:95]
    s_add_u32 m0, s39, 87552
    v_mfma_f32_16x16x32_bf16 v[88:91], a[220:223], v[232:235], v[88:91]
    s_add_u32 s33, s33, s46
    buffer_load_dwordx4 v18, s[12:15], s45 offen nt lds
    v_mfma_f32_16x16x32_bf16 a[0:3], a[192:195], a[160:163], a[0:3]
    s_waitcnt lgkmcnt(3)
    ds_read_b128 a[216:219], v6 offset:23040
    ds_read_b128 a[220:223], v9 offset:23040
    s_waitcnt vmcnt(20)
    v_mfma_f32_16x16x32_bf16 a[8:11], a[192:195], a[164:167], a[8:11]
    s_barrier
    v_mfma_f32_16x16x32_bf16 a[8:11], a[196:199], a[172:175], a[8:11]
    v_mfma_f32_16x16x32_bf16 a[0:3], a[196:199], a[168:171], a[0:3]
    s_add_u32 s29, s29, 1
    v_mfma_f32_16x16x32_bf16 a[4:7], a[200:203], a[160:163], a[4:7]
    s_waitcnt lgkmcnt(3)
    ds_read_b128 a[192:195], v6 offset:25088
    ds_read_b128 a[196:199], v9 offset:25088
    v_mfma_f32_16x16x32_bf16 a[12:15], a[200:203], a[164:167], a[12:15]
    s_add_u32 s28, s3, 1
    v_mul_f32 v64, s36, v64
    v_mul_f32 v65, s36, v65
    v_mul_f32 v66, s36, v66
    v_mfma_f32_16x16x32_bf16 a[12:15], a[204:207], a[172:175], a[12:15]
    s_add_u32 m0, s38, 101376
    v_mul_f32 v67, s36, v67
    v_mul_f32 v68, s36, v68
    v_mfma_f32_16x16x32_bf16 a[4:7], a[204:207], a[168:171], a[4:7]
    s_mov_b32 s45, 131072
    buffer_load_dwordx4 v19, s[16:19], s45 offen nt lds
    v_mul_f32 v69, s36, v69
    v_mfma_f32_16x16x32_bf16 a[16:19], a[208:211], a[160:163], a[16:19]
    s_waitcnt lgkmcnt(3)
    ds_read_b128 a[200:203], v6 offset:27136
    ds_read_b128 a[204:207], v9 offset:27136
    v_mfma_f32_16x16x32_bf16 a[24:27], a[208:211], a[164:167], a[24:27]
    s_sub_u32 s55, s55, s54
    v_mul_f32 v70, s36, v70
    v_mul_f32 v71, s36, v71
    v_mul_f32 v72, s36, v72
    v_mfma_f32_16x16x32_bf16 a[24:27], a[212:215], a[172:175], a[24:27]
    v_mul_f32 v73, s36, v73
    v_mul_f32 v74, s36, v74
    v_mfma_f32_16x16x32_bf16 a[16:19], a[212:215], a[168:171], a[16:19]
    s_cmp_eq_u32 s3, 3
    s_cselect_b32 s31, 0x40000000, s31
    s_cselect_b32 s33, 0x40000000, s33
    s_cselect_b32 s29, 0, s29
    v_mul_f32 v75, s36, v75
    v_mul_f32 v76, s36, v76
    v_mul_f32 v77, s36, v77
    v_mfma_f32_16x16x32_bf16 a[20:23], a[216:219], a[160:163], a[20:23]
    s_waitcnt lgkmcnt(3)
    ds_read_b128 a[208:211], v6 offset:29184
    ds_read_b128 a[212:215], v9 offset:29184
    v_mfma_f32_16x16x32_bf16 a[28:31], a[216:219], a[164:167], a[28:31]
    v_mul_f32 v78, s36, v78
    v_mul_f32 v79, s36, v79
    v_mfma_f32_16x16x32_bf16 a[28:31], a[220:223], a[172:175], a[28:31]
    s_add_u32 m0, s38, 101920
    v_cvt_pk_bf16_f32 v48, v64, v65
    v_cvt_pk_bf16_f32 v49, v66, v67
    v_cvt_pk_bf16_f32 v50, v72, v73
    v_mfma_f32_16x16x32_bf16 a[20:23], a[220:223], a[168:171], a[20:23]
    s_nop 0
    buffer_load_dwordx4 v19, s[16:19], s45 offen offset:512 nt lds
    v_cvt_pk_bf16_f32 v51, v74, v75
    v_mfma_f32_16x16x32_bf16 a[32:35], a[192:195], a[160:163], a[32:35]
    s_waitcnt lgkmcnt(3)
    ds_read_b128 a[216:219], v6 offset:31232
    ds_read_b128 a[220:223], v9 offset:31232
    v_mfma_f32_16x16x32_bf16 a[40:43], a[192:195], a[164:167], a[40:43]
    v_cvt_pk_bf16_f32 v52, v68, v69
    v_cvt_pk_bf16_f32 v53, v70, v71
    v_mfma_f32_16x16x32_bf16 a[40:43], a[196:199], a[172:175], a[40:43]
    v_cvt_pk_bf16_f32 v54, v76, v77
    v_cvt_pk_bf16_f32 v55, v78, v79
    v_mul_f32 v80, s36, v80
    v_mfma_f32_16x16x32_bf16 a[32:35], a[196:199], a[168:171], a[32:35]
    v_mul_f32 v81, s36, v81
    v_mul_f32 v82, s36, v82
    v_mfma_f32_16x16x32_bf16 a[36:39], a[200:203], a[160:163], a[36:39]
    s_waitcnt lgkmcnt(3)
    ds_read_b128 a[192:195], v4 offset:0
    ds_read_b128 a[196:199], v7 offset:0
    v_mfma_f32_16x16x32_bf16 a[44:47], a[200:203], a[164:167], a[44:47]
    v_mul_f32 v83, s36, v83
    v_mul_f32 v84, s36, v84
    v_mul_f32 v85, s36, v85
    v_mfma_f32_16x16x32_bf16 a[44:47], a[204:207], a[172:175], a[44:47]
    s_add_u32 m0, s38, 102464
    v_mul_f32 v86, s36, v86
    v_mul_f32 v87, s36, v87
    v_mul_f32 v88, s36, v88
    v_mfma_f32_16x16x32_bf16 a[36:39], a[204:207], a[168:171], a[36:39]
    s_nop 0
    buffer_load_dwordx4 v19, s[16:19], s45 offen offset:1024 nt lds
    v_mul_f32 v89, s36, v89
    v_mfma_f32_16x16x32_bf16 a[48:51], a[208:211], a[160:163], a[48:51]
    s_waitcnt lgkmcnt(3)
    ds_read_b128 a[200:203], v4 offset:2048
    ds_read_b128 a[204:207], v7 offset:2048
    v_mfma_f32_16x16x32_bf16 a[56:59], a[208:211], a[164:167], a[56:59]
    v_mul_f32 v90, s36, v90
    v_mul_f32 v91, s36, v91
    v_mfma_f32_16x16x32_bf16 a[56:59], a[212:215], a[172:175], a[56:59]
    v_mul_f32 v92, s36, v92
    v_mul_f32 v93, s36, v93
    v_mul_f32 v94, s36, v94
    v_mfma_f32_16x16x32_bf16 a[48:51], a[212:215], a[168:171], a[48:51]
    v_mul_f32 v95, s36, v95
    v_cvt_pk_bf16_f32 v56, v80, v81
    v_mfma_f32_16x16x32_bf16 a[52:55], a[216:219], a[160:163], a[52:55]
    s_waitcnt lgkmcnt(3)
    ds_read_b128 a[208:211], v4 offset:4096
    ds_read_b128 a[212:215], v7 offset:4096
    v_mfma_f32_16x16x32_bf16 a[60:63], a[216:219], a[164:167], a[60:63]
    v_cvt_pk_bf16_f32 v57, v82, v83
    v_cvt_pk_bf16_f32 v58, v88, v89
    v_cvt_pk_bf16_f32 v59, v90, v91
    v_mfma_f32_16x16x32_bf16 a[60:63], a[220:223], a[172:175], a[60:63]
    s_add_u32 m0, s38, 103008
    v_cvt_pk_bf16_f32 v60, v84, v85
    v_cvt_pk_bf16_f32 v61, v86, v87
    v_mfma_f32_16x16x32_bf16 a[52:55], a[220:223], a[168:171], a[52:55]
    s_nop 0
    buffer_load_dwordx4 v19, s[16:19], s45 offen offset:1536 nt lds
    v_cvt_pk_bf16_f32 v62, v92, v93
    v_mfma_f32_16x16x32_bf16 a[64:67], a[192:195], a[160:163], a[64:67]
    s_waitcnt lgkmcnt(3)
    ds_read_b128 a[216:219], v4 offset:6144
    ds_read_b128 a[220:223], v7 offset:6144
    s_waitcnt vmcnt(20)
    v_mfma_f32_16x16x32_bf16 a[72:75], a[192:195], a[164:167], a[72:75]
    s_barrier
    v_mfma_f32_16x16x32_bf16 a[72:75], a[196:199], a[172:175], a[72:75]
    v_cvt_pk_bf16_f32 v63, v94, v95
    v_permlane32_swap_b32 v48, v50
    v_mfma_f32_16x16x32_bf16 a[64:67], a[196:199], a[168:171], a[64:67]
    v_permlane32_swap_b32 v49, v51
    v_mfma_f32_16x16x32_bf16 a[68:71], a[200:203], a[160:163], a[68:71]
    s_waitcnt lgkmcnt(3)
    ds_read_b128 a[192:195], v4 offset:8192
    ds_read_b128 a[196:199], v7 offset:8192
    v_mfma_f32_16x16x32_bf16 a[76:79], a[200:203], a[164:167], a[76:79]
    v_permlane32_swap_b32 v52, v54
    v_mfma_f32_16x16x32_bf16 a[76:79], a[204:207], a[172:175], a[76:79]
    s_add_u32 m0, s38, 118272
    v_permlane32_swap_b32 v53, v55
    v_permlane32_swap_b32 v56, v58
    v_mfma_f32_16x16x32_bf16 a[68:71], a[204:207], a[168:171], a[68:71]
    s_mov_b32 s45, 128
    buffer_load_dwordx4 v20, s[20:23], s45 offen lds
    v_mfma_f32_16x16x32_bf16 a[80:83], a[208:211], a[160:163], a[80:83]
    s_waitcnt lgkmcnt(3)
    ds_read_b128 a[200:203], v4 offset:10240
    ds_read_b128 a[204:207], v7 offset:10240
    v_mfma_f32_16x16x32_bf16 a[88:91], a[208:211], a[164:167], a[88:91]
    v_permlane32_swap_b32 v57, v59
    v_mfma_f32_16x16x32_bf16 a[88:91], a[212:215], a[172:175], a[88:91]
    v_permlane32_swap_b32 v60, v62
    v_permlane32_swap_b32 v61, v63
    v_mfma_f32_16x16x32_bf16 a[80:83], a[212:215], a[168:171], a[80:83]
    v_permlane16_swap_b32 v48, v50
    v_mfma_f32_16x16x32_bf16 a[84:87], a[216:219], a[160:163], a[84:87]
    s_waitcnt lgkmcnt(3)
    ds_read_b128 a[208:211], v4 offset:12288
    ds_read_b128 a[212:215], v7 offset:12288
    v_mfma_f32_16x16x32_bf16 a[92:95], a[216:219], a[164:167], a[92:95]
    v_permlane16_swap_b32 v49, v51
    v_mfma_f32_16x16x32_bf16 a[92:95], a[220:223], a[172:175], a[92:95]
    s_add_u32 m0, s38, 119328
    v_permlane16_swap_b32 v52, v54
    v_permlane16_swap_b32 v53, v55
    v_mfma_f32_16x16x32_bf16 a[84:87], a[220:223], a[168:171], a[84:87]
    s_mov_b32 s45, 7296
    buffer_load_dwordx4 v20, s[20:23], s45 offen lds
    v_mfma_f32_16x16x32_bf16 a[96:99], a[192:195], a[160:163], a[96:99]
    s_waitcnt lgkmcnt(3)
    ds_read_b128 a[216:219], v4 offset:14336
    ds_read_b128 a[220:223], v7 offset:14336
    v_mfma_f32_16x16x32_bf16 a[104:107], a[192:195], a[164:167], a[104:107]
    v_permlane16_swap_b32 v56, v58
    v_mfma_f32_16x16x32_bf16 a[104:107], a[196:199], a[172:175], a[104:107]
    v_permlane16_swap_b32 v57, v59
    v_permlane16_swap_b32 v60, v62
    v_mfma_f32_16x16x32_bf16 a[96:99], a[196:199], a[168:171], a[96:99]
    v_permlane16_swap_b32 v61, v63
    v_mfma_f32_16x16x32_bf16 a[100:103], a[200:203], a[160:163], a[100:103]
    s_waitcnt lgkmcnt(3)
    ds_read_b128 a[192:195], v4 offset:33792
    ds_read_b128 a[196:199], v7 offset:33792
    v_mfma_f32_16x16x32_bf16 a[108:111], a[200:203], a[164:167], a[108:111]
    v_accvgpr_write_b32 a176, v48
    v_accvgpr_write_b32 a177, v49
    v_mfma_f32_16x16x32_bf16 a[108:111], a[204:207], a[172:175], a[108:111]
    s_add_u32 m0, s38, 120384
    v_accvgpr_write_b32 a178, v50
    v_accvgpr_write_b32 a179, v51
    v_accvgpr_write_b32 a180, v52
    v_mfma_f32_16x16x32_bf16 a[100:103], a[204:207], a[168:171], a[100:103]
    s_mov_b32 s45, 14464
    buffer_load_dwordx4 v20, s[20:23], s45 offen lds
    v_accvgpr_write_b32 a181, v53
    v_mfma_f32_16x16x32_bf16 a[112:115], a[208:211], a[160:163], a[112:115]
    s_waitcnt lgkmcnt(3)
    ds_read_b128 a[200:203], v4 offset:35840
    ds_read_b128 a[204:207], v7 offset:35840
    v_mfma_f32_16x16x32_bf16 a[120:123], a[208:211], a[164:167], a[120:123]
    v_accvgpr_write_b32 a182, v54
    v_accvgpr_write_b32 a183, v55
    v_mfma_f32_16x16x32_bf16 a[120:123], a[212:215], a[172:175], a[120:123]
    v_accvgpr_write_b32 a184, v56
    v_accvgpr_write_b32 a185, v57
    v_accvgpr_write_b32 a186, v58
    v_mfma_f32_16x16x32_bf16 a[112:115], a[212:215], a[168:171], a[112:115]
    v_accvgpr_write_b32 a187, v59
    v_accvgpr_write_b32 a188, v60
    v_mfma_f32_16x16x32_bf16 a[116:119], a[216:219], a[160:163], a[116:119]
    s_waitcnt lgkmcnt(3)
    ds_read_b128 a[208:211], v4 offset:37888
    ds_read_b128 a[212:215], v7 offset:37888
    v_mfma_f32_16x16x32_bf16 a[124:127], a[216:219], a[164:167], a[124:127]
    v_accvgpr_write_b32 a189, v61
    v_accvgpr_write_b32 a190, v62
    v_accvgpr_write_b32 a191, v63
    v_mfma_f32_16x16x32_bf16 a[124:127], a[220:223], a[172:175], a[124:127]
    s_add_u32 m0, s38, 121440
    v_mfma_f32_16x16x32_bf16 a[116:119], a[220:223], a[168:171], a[116:119]
    s_mov_b32 s45, 21632
    buffer_load_dwordx4 v20, s[20:23], s45 offen lds
    v_mfma_f32_16x16x32_bf16 a[0:3], a[192:195], a[176:179], a[0:3]
    s_waitcnt lgkmcnt(3)
    ds_read_b128 a[216:219], v4 offset:39936
    ds_read_b128 a[220:223], v7 offset:39936
    s_waitcnt vmcnt(20)
    v_mfma_f32_16x16x32_bf16 a[8:11], a[192:195], a[180:183], a[8:11]
    s_barrier
    v_mfma_f32_16x16x32_bf16 a[8:11], a[196:199], a[188:191], a[8:11]
    v_mfma_f32_16x16x32_bf16 a[0:3], a[196:199], a[184:187], a[0:3]
    v_mfma_f32_16x16x32_bf16 a[4:7], a[200:203], a[176:179], a[4:7]
    s_waitcnt lgkmcnt(3)
    ds_read_b128 a[192:195], v4 offset:41984
    ds_read_b128 a[196:199], v7 offset:41984
    v_mfma_f32_16x16x32_bf16 a[12:15], a[200:203], a[180:183], a[12:15]
    v_mfma_f32_16x16x32_bf16 a[12:15], a[204:207], a[188:191], a[12:15]
    s_add_u32 m0, s38, 0
    v_mfma_f32_16x16x32_bf16 a[4:7], a[204:207], a[184:187], a[4:7]
    s_mov_b32 s45, 147456
    buffer_load_dwordx4 v14, s[12:15], s45 offen nt lds
    v_mfma_f32_16x16x32_bf16 a[16:19], a[208:211], a[176:179], a[16:19]
    s_waitcnt lgkmcnt(3)
    ds_read_b128 a[200:203], v4 offset:44032
    ds_read_b128 a[204:207], v7 offset:44032
    v_mfma_f32_16x16x32_bf16 a[24:27], a[208:211], a[180:183], a[24:27]
    v_mfma_f32_16x16x32_bf16 a[24:27], a[212:215], a[188:191], a[24:27]
    v_mfma_f32_16x16x32_bf16 a[16:19], a[212:215], a[184:187], a[16:19]
    v_mfma_f32_16x16x32_bf16 a[20:23], a[216:219], a[176:179], a[20:23]
    s_waitcnt lgkmcnt(3)
    ds_read_b128 a[208:211], v4 offset:46080
    ds_read_b128 a[212:215], v7 offset:46080
    v_mfma_f32_16x16x32_bf16 a[28:31], a[216:219], a[180:183], a[28:31]
    v_accvgpr_read_b32 v112, a0
    v_accvgpr_read_b32 v113, a1
    v_mfma_f32_16x16x32_bf16 a[28:31], a[220:223], a[188:191], a[28:31]
    s_add_u32 m0, s38, 544
    v_accvgpr_read_b32 v114, a2
    v_accvgpr_read_b32 v115, a3
    v_mfma_f32_16x16x32_bf16 a[20:23], a[220:223], a[184:187], a[20:23]
    s_nop 0
    buffer_load_dwordx4 v14, s[12:15], s45 offen offset:512 nt lds
    v_mfma_f32_16x16x32_bf16 a[32:35], a[192:195], a[176:179], a[32:35]
    s_waitcnt lgkmcnt(3)
    ds_read_b128 a[216:219], v4 offset:48128
    ds_read_b128 a[220:223], v7 offset:48128
    v_mfma_f32_16x16x32_bf16 a[40:43], a[192:195], a[180:183], a[40:43]
    v_exp_f32 v112, v112
    v_exp_f32 v113, v113
    v_mfma_f32_16x16x32_bf16 a[40:43], a[196:199], a[188:191], a[40:43]
    v_accvgpr_read_b32 v116, a4
    v_accvgpr_read_b32 v117, a5
    v_mfma_f32_16x16x32_bf16 a[32:35], a[196:199], a[184:187], a[32:35]
    v_exp_f32 v114, v114
    v_exp_f32 v115, v115
    v_mfma_f32_16x16x32_bf16 a[36:39], a[200:203], a[176:179], a[36:39]
    s_waitcnt lgkmcnt(3)
    ds_read_b128 a[192:195], v33 offset:0
    ds_read_b128 a[196:199], v33 offset:512
    v_mfma_f32_16x16x32_bf16 a[44:47], a[200:203], a[180:183], a[44:47]
    v_add_f32 v21, v23, v112
    v_cvt_pk_bf16_f32 v96, v112, v113
    v_mfma_f32_16x16x32_bf16 a[44:47], a[204:207], a[188:191], a[44:47]
    s_add_u32 m0, s38, 1088
    v_add_f32 v21, v21, v113
    v_accvgpr_read_b32 v118, a6
    v_mfma_f32_16x16x32_bf16 a[36:39], a[204:207], a[184:187], a[36:39]
    s_nop 0
    buffer_load_dwordx4 v14, s[12:15], s45 offen offset:1024 nt lds
    v_accvgpr_read_b32 v119, a7
    v_mfma_f32_16x16x32_bf16 a[48:51], a[208:211], a[176:179], a[48:51]
    s_waitcnt lgkmcnt(3)
    ds_read_b128 a[200:203], v33 offset:64
    ds_read_b128 a[204:207], v33 offset:576
    v_mfma_f32_16x16x32_bf16 a[56:59], a[208:211], a[180:183], a[56:59]
    v_exp_f32 v116, v116
    v_mfma_f32_16x16x32_bf16 a[56:59], a[212:215], a[188:191], a[56:59]
    v_exp_f32 v117, v117
    v_add_f32 v21, v21, v114
    v_mfma_f32_16x16x32_bf16 a[48:51], a[212:215], a[184:187], a[48:51]
    v_cvt_pk_bf16_f32 v97, v114, v115
    v_add_f32 v21, v21, v115
    v_accvgpr_read_b32 v120, a8
    v_mfma_f32_16x16x32_bf16 a[52:55], a[216:219], a[176:179], a[52:55]
    s_waitcnt lgkmcnt(3)
    ds_read_b128 a[208:211], v33 offset:128
    ds_read_b128 a[212:215], v33 offset:640
    v_mfma_f32_16x16x32_bf16 a[60:63], a[216:219], a[180:183], a[60:63]
    v_accvgpr_read_b32 v121, a9
    v_exp_f32 v118, v118
    v_mfma_f32_16x16x32_bf16 a[60:63], a[220:223], a[188:191], a[60:63]
    s_add_u32 m0, s38, 1632
    v_exp_f32 v119, v119
    v_mfma_f32_16x16x32_bf16 a[52:55], a[220:223], a[184:187], a[52:55]
    s_nop 0
    buffer_load_dwordx4 v14, s[12:15], s45 offen offset:1536 nt lds
    v_add_f32 v21, v21, v116
    v_mfma_f32_16x16x32_bf16 v[48:51], a[192:195], a[128:131], v[40:43]
    s_waitcnt lgkmcnt(3)
    ds_read_b128 a[216:219], v33 offset:192
    ds_read_b128 a[220:223], v33 offset:704
    s_waitcnt vmcnt(16)
    v_mfma_f32_16x16x32_bf16 v[56:59], a[192:195], a[132:135], v[44:47]
    s_barrier
    v_mfma_f32_16x16x32_bf16 v[60:63], a[196:199], a[132:135], v[44:47]
    v_cvt_pk_bf16_f32 v98, v116, v117
    v_add_f32 v21, v21, v117
    v_mfma_f32_16x16x32_bf16 v[52:55], a[196:199], a[128:131], v[40:43]
    v_accvgpr_read_b32 v122, a10
    v_accvgpr_read_b32 v123, a11
    v_mfma_f32_16x16x32_bf16 v[48:51], a[200:203], a[136:139], v[48:51]
    s_waitcnt lgkmcnt(3)
    ds_read_b128 a[192:195], v33 offset:256
    ds_read_b128 a[196:199], v33 offset:768
    v_mfma_f32_16x16x32_bf16 v[56:59], a[200:203], a[140:143], v[56:59]
    v_exp_f32 v120, v120
    v_exp_f32 v121, v121
    v_mfma_f32_16x16x32_bf16 v[60:63], a[204:207], a[140:143], v[60:63]
    s_add_u32 m0, s38, 33792
    v_add_f32 v21, v21, v118
    v_cvt_pk_bf16_f32 v99, v118, v119
    v_mfma_f32_16x16x32_bf16 v[52:55], a[204:207], a[136:139], v[52:55]
    s_mov_b32 s45, 16384
    buffer_load_dwordx4 v19, s[16:19], s45 offen nt lds
    v_add_f32 v21, v21, v119
    v_mfma_f32_16x16x32_bf16 v[48:51], a[208:211], a[144:147], v[48:51]
    s_waitcnt lgkmcnt(3)
    ds_read_b128 a[200:203], v33 offset:320
    ds_read_b128 a[204:207], v33 offset:832
    v_mfma_f32_16x16x32_bf16 v[56:59], a[208:211], a[148:151], v[56:59]
    v_accvgpr_read_b32 v124, a12
    v_accvgpr_read_b32 v125, a13
    v_mfma_f32_16x16x32_bf16 v[60:63], a[212:215], a[148:151], v[60:63]
    v_exp_f32 v122, v122
    v_mfma_f32_16x16x32_bf16 v[52:55], a[212:215], a[144:147], v[52:55]
    v_exp_f32 v123, v123
    v_add_f32 v22, v24, v120
    v_mfma_f32_16x16x32_bf16 v[48:51], a[216:219], a[152:155], v[48:51]
    s_waitcnt lgkmcnt(3)
    ds_read_b128 a[208:211], v33 offset:384
    ds_read_b128 a[212:215], v33 offset:896
    v_mfma_f32_16x16x32_bf16 v[56:59], a[216:219], a[156:159], v[56:59]
    v_cvt_pk_bf16_f32 v100, v120, v121
    v_add_f32 v22, v22, v121
    v_accvgpr_read_b32 v126, a14
    v_mfma_f32_16x16x32_bf16 v[60:63], a[220:223], a[156:159], v[60:63]
    s_add_u32 m0, s38, 34336
    v_accvgpr_read_b32 v127, a15
    v_exp_f32 v124, v124
    v_mfma_f32_16x16x32_bf16 v[52:55], a[220:223], a[152:155], v[52:55]
    s_nop 0
    buffer_load_dwordx4 v19, s[16:19], s45 offen offset:512 nt lds
    v_mfma_f32_16x16x32_bf16 v[48:51], a[192:195], a[160:163], v[48:51]
    s_waitcnt lgkmcnt(3)
    ds_read_b128 a[216:219], v33 offset:448
    ds_read_b128 a[220:223], v33 offset:960
    v_mfma_f32_16x16x32_bf16 v[56:59], a[192:195], a[164:167], v[56:59]
    v_exp_f32 v125, v125
    v_add_f32 v22, v22, v122
    v_mfma_f32_16x16x32_bf16 v[60:63], a[196:199], a[164:167], v[60:63]
    v_cvt_pk_bf16_f32 v101, v122, v123
    v_add_f32 v22, v22, v123
    v_mfma_f32_16x16x32_bf16 v[52:55], a[196:199], a[160:163], v[52:55]
    v_exp_f32 v126, v126
    v_mfma_f32_16x16x32_bf16 v[48:51], a[200:203], a[168:171], v[48:51]
    s_waitcnt lgkmcnt(3)
    ds_read_b64_tr_b16 a[192:193], v11 offset:16896
    ds_read_b64_tr_b16 a[194:195], v11 offset:17408
    v_mfma_f32_16x16x32_bf16 v[56:59], a[200:203], a[172:175], v[56:59]
    v_exp_f32 v127, v127
    v_add_f32 v22, v22, v124
    v_mfma_f32_16x16x32_bf16 v[60:63], a[204:207], a[172:175], v[60:63]
    s_add_u32 m0, s38, 34880
    ds_read_b64_tr_b16 a[196:197], v11 offset:16928
    ds_read_b64_tr_b16 a[198:199], v11 offset:17440
    v_mfma_f32_16x16x32_bf16 v[52:55], a[204:207], a[168:171], v[52:55]
    s_nop 0
    buffer_load_dwordx4 v19, s[16:19], s45 offen offset:1024 nt lds
    v_cvt_pk_bf16_f32 v102, v124, v125
    v_mfma_f32_16x16x32_bf16 v[48:51], a[208:211], a[176:179], v[48:51]
    s_waitcnt lgkmcnt(5)
    ds_read_b64_tr_b16 a[200:201], v11 offset:16960
    ds_read_b64_tr_b16 a[202:203], v11 offset:17472
    v_mfma_f32_16x16x32_bf16 v[56:59], a[208:211], a[180:183], v[56:59]
    v_add_f32 v22, v22, v125
    v_add_f32 v22, v22, v126
    v_cvt_pk_bf16_f32 v103, v126, v127
    v_mfma_f32_16x16x32_bf16 v[60:63], a[212:215], a[180:183], v[60:63]
    s_nop 0
    ds_read_b64_tr_b16 a[204:205], v11 offset:16992
    ds_read_b64_tr_b16 a[206:207], v11 offset:17504
    v_mfma_f32_16x16x32_bf16 v[52:55], a[212:215], a[176:179], v[52:55]
    v_add_f32 v22, v22, v127
    v_max_f32 v30, v21, v22
    v_mfma_f32_16x16x32_bf16 v[48:51], a[216:219], a[184:187], v[48:51]
    s_waitcnt lgkmcnt(6)
    ds_read_b64_tr_b16 a[208:209], v11 offset:17024
    ds_read_b64_tr_b16 a[210:211], v11 offset:17536
    v_mfma_f32_16x16x32_bf16 v[56:59], a[216:219], a[188:191], v[56:59]
    v_min_f32 v31, v21, v22
    v_cmp_nle_f32 s[86:87], s42, v31
    v_cmp_nge_f32 vcc, s35, v30
    v_mfma_f32_16x16x32_bf16 v[60:63], a[220:223], a[188:191], v[60:63]
    s_add_u32 m0, s38, 35424
    ds_read_b64_tr_b16 a[212:213], v11 offset:17056
    ds_read_b64_tr_b16 a[214:215], v11 offset:17568
    v_mfma_f32_16x16x32_bf16 v[52:55], a[220:223], a[184:187], v[52:55]
    s_nop 0
    buffer_load_dwordx4 v19, s[16:19], s45 offen offset:1536 nt lds
    s_or_b64 vcc, vcc, s[86:87]
    s_cbranch_scc1 T_c0
B_c0:
    v_mfma_f32_16x16x32_bf16 v[128:131], a[192:195], v[96:99], 0
    s_waitcnt lgkmcnt(6)
    ds_read_b64_tr_b16 a[216:217], v11 offset:17088
    ds_read_b64_tr_b16 a[218:219], v11 offset:17600
    s_waitcnt vmcnt(16)
    v_mfma_f32_16x16x32_bf16 v[132:135], a[192:195], v[100:103], 0
    s_barrier
    v_mfma_f32_16x16x32_bf16 v[140:143], a[196:199], v[100:103], 0
    s_nop 0
    ds_read_b64_tr_b16 a[220:221], v11 offset:17120
    ds_read_b64_tr_b16 a[222:223], v11 offset:17632
    v_mfma_f32_16x16x32_bf16 v[136:139], a[196:199], v[96:99], 0
    v_exp_f32 v112, v48
    v_mfma_f32_16x16x32_bf16 v[144:147], a[200:203], v[96:99], 0
    s_waitcnt lgkmcnt(6)
    ds_read_b64_tr_b16 a[192:193], v11 offset:17152
    ds_read_b64_tr_b16 a[194:195], v11 offset:17664
    v_mfma_f32_16x16x32_bf16 v[148:151], a[200:203], v[100:103], 0
    v_exp_f32 v113, v49
    v_mfma_f32_16x16x32_bf16 v[156:159], a[204:207], v[100:103], 0
    s_add_u32 m0, s38, 50688
    ds_read_b64_tr_b16 a[196:197], v11 offset:17184
    ds_read_b64_tr_b16 a[198:199], v11 offset:17696
    v_mfma_f32_16x16x32_bf16 v[152:155], a[204:207], v[96:99], 0
    s_mov_b32 s45, 147456
    buffer_load_dwordx4 v19, s[16:19], s45 offen nt lds
    v_mfma_f32_16x16x32_bf16 v[160:163], a[208:211], v[96:99], 0
    s_waitcnt lgkmcnt(6)
    ds_read_b64_tr_b16 a[200:201], v11 offset:17216
    ds_read_b64_tr_b16 a[202:203], v11 offset:17728
    v_mfma_f32_16x16x32_bf16 v[164:167], a[208:211], v[100:103], 0
    v_exp_f32 v114, v50
    v_mfma_f32_16x16x32_bf16 v[172:175], a[212:215], v[100:103], 0
    s_nop 0
    ds_read_b64_tr_b16 a[204:205], v11 offset:17248
    ds_read_b64_tr_b16 a[206:207], v11 offset:17760
    v_mfma_f32_16x16x32_bf16 v[168:171], a[212:215], v[96:99], 0
    v_exp_f32 v115, v51
    v_mfma_f32_16x16x32_bf16 v[176:179], a[216:219], v[96:99], 0
    s_waitcnt lgkmcnt(6)
    ds_read_b64_tr_b16 a[208:209], v11 offset:17280
    ds_read_b64_tr_b16 a[210:211], v11 offset:17792
    v_mfma_f32_16x16x32_bf16 v[180:183], a[216:219], v[100:103], 0
    v_add_f32 v23, v21, v112
    v_cvt_pk_bf16_f32 v104, v112, v113
    v_mfma_f32_16x16x32_bf16 v[188:191], a[220:223], v[100:103], 0
    s_add_u32 m0, s38, 51232
    ds_read_b64_tr_b16 a[212:213], v11 offset:17312
    ds_read_b64_tr_b16 a[214:215], v11 offset:17824
    v_mfma_f32_16x16x32_bf16 v[184:187], a[220:223], v[96:99], 0
    s_nop 0
    buffer_load_dwordx4 v19, s[16:19], s45 offen offset:512 nt lds
    v_mfma_f32_16x16x32_bf16 v[192:195], a[192:195], v[96:99], 0
    s_waitcnt lgkmcnt(6)
    ds_read_b64_tr_b16 a[216:217], v11 offset:17344
    ds_read_b64_tr_b16 a[218:219], v11 offset:17856
    v_mfma_f32_16x16x32_bf16 v[196:199], a[192:195], v[100:103], 0
    v_add_f32 v23, v23, v113
    v_mfma_f32_16x16x32_bf16 v[204:207], a[196:199], v[100:103], 0
    s_nop 0
    ds_read_b64_tr_b16 a[220:221], v11 offset:17376
    ds_read_b64_tr_b16 a[222:223], v11 offset:17888
    v_mfma_f32_16x16x32_bf16 v[200:203], a[196:199], v[96:99], 0
    v_exp_f32 v116, v52
    v_mfma_f32_16x16x32_bf16 v[208:211], a[200:203], v[96:99], 0
    s_waitcnt lgkmcnt(6)
    ds_read_b128 a[192:195], v5 offset:33792
    ds_read_b128 a[196:199], v8 offset:33792
    v_mfma_f32_16x16x32_bf16 v[212:215], a[200:203], v[100:103], 0
    v_exp_f32 v117, v53
    v_mfma_f32_16x16x32_bf16 v[220:223], a[204:207], v[100:103], 0
    s_add_u32 m0, s38, 51776
    v_add_f32 v23, v23, v114
    v_cvt_pk_bf16_f32 v105, v114, v115
    v_mfma_f32_16x16x32_bf16 v[216:219], a[204:207], v[96:99], 0
    s_nop 0
    buffer_load_dwordx4 v19, s[16:19], s45 offen offset:1024 nt lds
    v_mfma_f32_16x16x32_bf16 v[224:227], a[208:211], v[96:99], 0
    s_waitcnt lgkmcnt(4)
    ds_read_b128 a[200:203], v5 offset:35840
    ds_read_b128 a[204:207], v8 offset:35840
    v_mfma_f32_16x16x32_bf16 v[228:231], a[208:211], v[100:103], 0
    v_add_f32 v23, v23, v115
    v_exp_f32 v118, v54
    v_mfma_f32_16x16x32_bf16 v[236:239], a[212:215], v[100:103], 0
    v_exp_f32 v119, v55
    v_mfma_f32_16x16x32_bf16 v[232:235], a[212:215], v[96:99], 0
    v_add_f32 v23, v23, v116
    v_mfma_f32_16x16x32_bf16 v[240:243], a[216:219], v[96:99], 0
    s_waitcnt lgkmcnt(3)
    ds_read_b128 a[208:211], v5 offset:37888
    ds_read_b128 a[212:215], v8 offset:37888
    v_mfma_f32_16x16x32_bf16 v[244:247], a[216:219], v[100:103], 0
    v_cvt_pk_bf16_f32 v106, v116, v117
    v_add_f32 v23, v23, v117
    v_mfma_f32_16x16x32_bf16 v[252:255], a[220:223], v[100:103], 0
    s_add_u32 m0, s38, 52320
    v_exp_f32 v120, v56
    v_mfma_f32_16x16x32_bf16 v[248:251], a[220:223], v[96:99], 0
    s_nop 0
    buffer_load_dwordx4 v19, s[16:19], s45 offen offset:1536 nt lds
    v_mfma_f32_16x16x32_bf16 a[64:67], a[192:195], a[176:179], a[64:67]
    s_waitcnt lgkmcnt(3)
    ds_read_b128 a[216:219], v5 offset:39936
    ds_read_b128 a[220:223], v8 offset:39936
    s_waitcnt vmcnt(16)
    v_mfma_f32_16x16x32_bf16 a[72:75], a[192:195], a[180:183], a[72:75]
    s_barrier
    v_mfma_f32_16x16x32_bf16 a[72:75], a[196:199], a[188:191], a[72:75]
    v_exp_f32 v121, v57
    v_mfma_f32_16x16x32_bf16 a[64:67], a[196:199], a[184:187], a[64:67]
    v_add_f32 v23, v23, v118
    v_cvt_pk_bf16_f32 v107, v118, v119
    v_mfma_f32_16x16x32_bf16 a[68:71], a[200:203], a[176:179], a[68:71]
    s_waitcnt lgkmcnt(3)
    ds_read_b128 a[192:195], v5 offset:41984
    ds_read_b128 a[196:199], v8 offset:41984
    v_mfma_f32_16x16x32_bf16 a[76:79], a[200:203], a[180:183], a[76:79]
    v_add_f32 v23, v23, v119
    v_mfma_f32_16x16x32_bf16 a[76:79], a[204:207], a[188:191], a[76:79]
    s_add_u32 m0, s38, 67584
    v_exp_f32 v122, v58
    v_mfma_f32_16x16x32_bf16 a[68:71], a[204:207], a[184:187], a[68:71]
    s_mov_b32 s45, 163840
    buffer_load_dwordx4 v14, s[12:15], s45 offen nt lds
    v_mfma_f32_16x16x32_bf16 a[80:83], a[208:211], a[176:179], a[80:83]
    s_waitcnt lgkmcnt(3)
    ds_read_b128 a[200:203], v5 offset:44032
    ds_read_b128 a[204:207], v8 offset:44032
    v_mfma_f32_16x16x32_bf16 a[88:91], a[208:211], a[180:183], a[88:91]
    v_exp_f32 v123, v59
    v_add_f32 v24, v22, v120
    v_mfma_f32_16x16x32_bf16 a[88:91], a[212:215], a[188:191], a[88:91]
    v_cvt_pk_bf16_f32 v108, v120, v121
    v_add_f32 v24, v24, v121
    v_mfma_f32_16x16x32_bf16 a[80:83], a[212:215], a[184:187], a[80:83]
    v_exp_f32 v124, v60
    v_mfma_f32_16x16x32_bf16 a[84:87], a[216:219], a[176:179], a[84:87]
    s_waitcnt lgkmcnt(3)
    ds_read_b128 a[208:211], v5 offset:46080
    ds_read_b128 a[212:215], v8 offset:46080
    v_mfma_f32_16x16x32_bf16 a[92:95], a[216:219], a[180:183], a[92:95]
    v_exp_f32 v125, v61
    v_mfma_f32_16x16x32_bf16 a[92:95], a[220:223], a[188:191], a[92:95]
    s_add_u32 m0, s38, 68128
    v_add_f32 v24, v24, v122
    v_mfma_f32_16x16x32_bf16 a[84:87], a[220:223], a[184:187], a[84:87]
    s_nop 0
    buffer_load_dwordx4 v14, s[12:15], s45 offen offset:512 nt lds
    v_mfma_f32_16x16x32_bf16 a[96:99], a[192:195], a[176:179], a[96:99]
    s_waitcnt lgkmcnt(3)
    ds_read_b128 a[216:219], v5 offset:48128
    ds_read_b128 a[220:223], v8 offset:48128
    v_mfma_f32_16x16x32_bf16 a[104:107], a[192:195], a[180:183], a[104:107]
    v_cvt_pk_bf16_f32 v109, v122, v123
    v_add_f32 v24, v24, v123
    v_mfma_f32_16x16x32_bf16 a[104:107], a[196:199], a[188:191], a[104:107]
    v_exp_f32 v126, v62
    v_mfma_f32_16x16x32_bf16 a[96:99], a[196:199], a[184:187], a[96:99]
    v_exp_f32 v127, v63
    v_mfma_f32_16x16x32_bf16 a[100:103], a[200:203], a[176:179], a[100:103]
    s_waitcnt lgkmcnt(3)
    ds_read_b64_tr_b16 a[192:193], v12 offset:0
    ds_read_b64_tr_b16 a[194:195], v12 offset:512
    v_mfma_f32_16x16x32_bf16 a[108:111], a[200:203], a[180:183], a[108:111]
    v_add_f32 v24, v24, v124
    v_cvt_pk_bf16_f32 v110, v124, v125
    v_mfma_f32_16x16x32_bf16 a[108:111], a[204:207], a[188:191], a[108:111]
    s_add_u32 m0, s38, 68672
    ds_read_b64_tr_b16 a[196:197], v12 offset:32
    ds_read_b64_tr_b16 a[198:199], v12 offset:544
    v_mfma_f32_16x16x32_bf16 a[100:103], a[204:207], a[184:187], a[100:103]
    s_nop 0
    buffer_load_dwordx4 v14, s[12:15], s45 offen offset:1024 nt lds
    v_mfma_f32_16x16x32_bf16 a[112:115], a[208:211], a[176:179], a[112:115]
    s_waitcnt lgkmcnt(5)
    ds_read_b64_tr_b16 a[200:201], v12 offset:64
    ds_read_b64_tr_b16 a[202:203], v12 offset:576
    v_mfma_f32_16x16x32_bf16 a[120:123], a[208:211], a[180:183], a[120:123]
    v_add_f32 v24, v24, v125
    v_add_f32 v24, v24, v126
    v_mfma_f32_16x16x32_bf16 a[120:123], a[212:215], a[188:191], a[120:123]
    s_nop 0
    ds_read_b64_tr_b16 a[204:205], v12 offset:96
    ds_read_b64_tr_b16 a[206:207], v12 offset:608
    v_mfma_f32_16x16x32_bf16 a[112:115], a[212:215], a[184:187], a[112:115]
    v_cvt_pk_bf16_f32 v111, v126, v127
    v_add_f32 v24, v24, v127
    v_mfma_f32_16x16x32_bf16 a[116:119], a[216:219], a[176:179], a[116:119]
    s_waitcnt lgkmcnt(6)
    ds_read_b64_tr_b16 a[208:209], v12 offset:128
    ds_read_b64_tr_b16 a[210:211], v12 offset:640
    v_mfma_f32_16x16x32_bf16 a[124:127], a[216:219], a[180:183], a[124:127]
    v_max_f32 v30, v23, v24
    v_cmp_nge_f32 vcc, s35, v30
    v_mfma_f32_16x16x32_bf16 a[124:127], a[220:223], a[188:191], a[124:127]
    s_add_u32 m0, s38, 69216
    ds_read_b64_tr_b16 a[212:213], v12 offset:160
    ds_read_b64_tr_b16 a[214:215], v12 offset:672
    v_mfma_f32_16x16x32_bf16 a[116:119], a[220:223], a[184:187], a[116:119]
    s_nop 0
    buffer_load_dwordx4 v14, s[12:15], s45 offen offset:1536 nt lds
    s_cbranch_vccnz T_c1
B_c1:
    v_mfma_f32_16x16x32_bf16 v[128:131], a[192:195], v[104:107], v[128:131]
    s_waitcnt lgkmcnt(6)
    ds_read_b64_tr_b16 a[216:217], v12 offset:192
    ds_read_b64_tr_b16 a[218:219], v12 offset:704
    s_waitcnt vmcnt(12)
    v_mfma_f32_16x16x32_bf16 v[132:135], a[192:195], v[108:111], v[132:135]
    s_barrier
    v_mfma_f32_16x16x32_bf16 v[140:143], a[196:199], v[108:111], v[140:143]
    s_nop 0
    ds_read_b64_tr_b16 a[220:221], v12 offset:224
    ds_read_b64_tr_b16 a[222:223], v12 offset:736
    v_mfma_f32_16x16x32_bf16 v[136:139], a[196:199], v[104:107], v[136:139]
    v_lshrrev_b32 v26, 5, v1
    v_mul_u32_u24 v26, 1056, v26
    v_bfe_u32 v27, v1, 2, 3
    v_mfma_f32_16x16x32_bf16 v[144:147], a[200:203], v[104:107], v[144:147]
    s_waitcnt lgkmcnt(6)
    ds_read_b64_tr_b16 a[192:193], v12 offset:256
    ds_read_b64_tr_b16 a[194:195], v12 offset:768
    v_mfma_f32_16x16x32_bf16 v[148:151], a[200:203], v[108:111], v[148:151]
    v_lshl_add_u32 v26, v27, 7, v26
    v_and_b32 v28, 3, v1
    v_lshl_add_u32 v26, v28, 3, v26
    v_mfma_f32_16x16x32_bf16 v[156:159], a[204:207], v[108:111], v[156:159]
    s_add_u32 m0, s38, 84480
    ds_read_b64_tr_b16 a[196:197], v12 offset:288
    ds_read_b64_tr_b16 a[198:199], v12 offset:800
    v_mfma_f32_16x16x32_bf16 v[152:155], a[204:207], v[104:107], v[152:155]
    s_mov_b32 s45, 32768
    buffer_load_dwordx4 v19, s[16:19], s45 offen nt lds
    v_lshrrev_b32 v27, 1, v27
    v_mfma_f32_16x16x32_bf16 v[160:163], a[208:211], v[104:107], v[160:163]
    s_waitcnt lgkmcnt(6)
    ds_read_b64_tr_b16 a[200:201], v12 offset:320
    ds_read_b64_tr_b16 a[202:203], v12 offset:832
    v_mfma_f32_16x16x32_bf16 v[164:167], a[208:211], v[108:111], v[164:167]
    v_lshl_add_u32 v80, v27, 5, v26
    v_xor_b32 v28, 1, v27
    v_lshl_add_u32 v81, v28, 5, v26
    v_mfma_f32_16x16x32_bf16 v[172:175], a[212:215], v[108:111], v[172:175]
    s_nop 0
    ds_read_b64_tr_b16 a[204:205], v12 offset:352
    ds_read_b64_tr_b16 a[206:207], v12 offset:864
    v_mfma_f32_16x16x32_bf16 v[168:171], a[212:215], v[104:107], v[168:171]
    v_xor_b32 v28, 2, v27
    v_lshl_add_u32 v82, v28, 5, v26
    v_xor_b32 v28, 3, v27
    v_mfma_f32_16x16x32_bf16 v[176:179], a[216:219], v[104:107], v[176:179]
    s_waitcnt lgkmcnt(6)
    ds_read_b64_tr_b16 a[208:209], v12 offset:384
    ds_read_b64_tr_b16 a[210:211], v12 offset:896
    v_mfma_f32_16x16x32_bf16 v[180:183], a[216:219], v[108:111], v[180:183]
    v_lshl_add_u32 v83, v28, 5, v26
    v_add_u32 v84, 50688, v80
    v_add_u32 v85, 50688, v81
    v_mfma_f32_16x16x32_bf16 v[188:191], a[220:223], v[108:111], v[188:191]
    s_add_u32 m0, s38, 85024
    ds_read_b64_tr_b16 a[212:213], v12 offset:416
    ds_read_b64_tr_b16 a[214:215], v12 offset:928
    v_mfma_f32_16x16x32_bf16 v[184:187], a[220:223], v[104:107], v[184:187]
    s_nop 0
    buffer_load_dwordx4 v19, s[16:19], s45 offen offset:512 nt lds
    v_add_u32 v86, 50688, v82
    v_mfma_f32_16x16x32_bf16 v[192:195], a[192:195], v[104:107], v[192:195]
    s_waitcnt lgkmcnt(6)
    ds_read_b64_tr_b16 a[216:217], v12 offset:448
    ds_read_b64_tr_b16 a[218:219], v12 offset:960
    v_mfma_f32_16x16x32_bf16 v[196:199], a[192:195], v[108:111], v[196:199]
    v_add_u32 v87, 50688, v83
    v_add_u32 v88, 101376, v80
    v_add_u32 v89, 101376, v81
    v_mfma_f32_16x16x32_bf16 v[204:207], a[196:199], v[108:111], v[204:207]
    s_nop 0
    ds_read_b64_tr_b16 a[220:221], v12 offset:480
    ds_read_b64_tr_b16 a[222:223], v12 offset:992
    v_mfma_f32_16x16x32_bf16 v[200:203], a[196:199], v[104:107], v[200:203]
    v_add_u32 v90, 101376, v82
    v_add_u32 v91, 101376, v83
    v_accvgpr_read_b32 v112, a16
    v_mfma_f32_16x16x32_bf16 v[208:211], a[200:203], v[104:107], v[208:211]
    s_waitcnt lgkmcnt(6)
    ds_read_b128 a[192:195], v32 offset:0
    ds_read_b128 a[196:199], v32 offset:512
    v_mfma_f32_16x16x32_bf16 v[212:215], a[200:203], v[108:111], v[212:215]
    v_accvgpr_read_b32 v113, a17
    v_accvgpr_read_b32 v114, a18
    v_accvgpr_read_b32 v115, a19
    v_mfma_f32_16x16x32_bf16 v[220:223], a[204:207], v[108:111], v[220:223]
    s_add_u32 m0, s38, 85568
    v_exp_f32 v112, v112
    v_mfma_f32_16x16x32_bf16 v[216:219], a[204:207], v[104:107], v[216:219]
    s_nop 0
    buffer_load_dwordx4 v19, s[16:19], s45 offen offset:1024 nt lds
    v_mfma_f32_16x16x32_bf16 v[224:227], a[208:211], v[104:107], v[224:227]
    s_waitcnt lgkmcnt(4)
    ds_read_b128 a[200:203], v32 offset:64
    ds_read_b128 a[204:207], v32 offset:576
    v_mfma_f32_16x16x32_bf16 v[228:231], a[208:211], v[108:111], v[228:231]
    v_exp_f32 v113, v113
    v_accvgpr_read_b32 v116, a20
    v_accvgpr_read_b32 v117, a21
    v_mfma_f32_16x16x32_bf16 v[236:239], a[212:215], v[108:111], v[236:239]
    v_exp_f32 v114, v114
    v_exp_f32 v115, v115
    v_mfma_f32_16x16x32_bf16 v[232:235], a[212:215], v[104:107], v[232:235]
    v_add_f32 v21, v23, v112
    v_cvt_pk_bf16_f32 v96, v112, v113
    v_add_f32 v21, v21, v113
    v_mfma_f32_16x16x32_bf16 v[240:243], a[216:219], v[104:107], v[240:243]
    s_waitcnt lgkmcnt(3)
    ds_read_b128 a[208:211], v32 offset:128
    ds_read_b128 a[212:215], v32 offset:640
    v_mfma_f32_16x16x32_bf16 v[244:247], a[216:219], v[108:111], v[244:247]
    v_accvgpr_read_b32 v118, a22
    v_accvgpr_read_b32 v119, a23
    v_mfma_f32_16x16x32_bf16 v[252:255], a[220:223], v[108:111], v[252:255]
    s_add_u32 m0, s38, 86112
    v_exp_f32 v116, v116
    v_exp_f32 v117, v117
    v_mfma_f32_16x16x32_bf16 v[248:251], a[220:223], v[104:107], v[248:251]
    s_nop 0
    buffer_load_dwordx4 v19, s[16:19], s45 offen offset:1536 nt lds
    v_add_f32 v21, v21, v114
    v_mfma_f32_16x16x32_bf16 v[48:51], a[192:195], a[128:131], v[40:43]
    s_waitcnt lgkmcnt(3)
    ds_read_b128 a[216:219], v32 offset:192
    ds_read_b128 a[220:223], v32 offset:704
    s_waitcnt vmcnt(12)
    v_mfma_f32_16x16x32_bf16 v[56:59], a[192:195], a[132:135], v[44:47]
    s_barrier
    v_mfma_f32_16x16x32_bf16 v[60:63], a[196:199], a[132:135], v[44:47]
    v_cvt_pk_bf16_f32 v97, v114, v115
    v_add_f32 v21, v21, v115
    v_mfma_f32_16x16x32_bf16 v[52:55], a[196:199], a[128:131], v[40:43]
    v_accvgpr_read_b32 v120, a24
    v_accvgpr_read_b32 v121, a25
    v_exp_f32 v118, v118
    v_mfma_f32_16x16x32_bf16 v[48:51], a[200:203], a[136:139], v[48:51]
    s_waitcnt lgkmcnt(3)
    ds_read_b128 a[192:195], v32 offset:256
    ds_read_b128 a[196:199], v32 offset:768
    v_mfma_f32_16x16x32_bf16 v[56:59], a[200:203], a[140:143], v[56:59]
    v_exp_f32 v119, v119
    v_mfma_f32_16x16x32_bf16 v[60:63], a[204:207], a[140:143], v[60:63]
    s_add_u32 m0, s38, 101376
    v_add_f32 v21, v21, v116
    v_cvt_pk_bf16_f32 v98, v116, v117
    v_add_f32 v21, v21, v117
    v_mfma_f32_16x16x32_bf16 v[52:55], a[204:207], a[136:139], v[52:55]
    s_mov_b32 s45, 114816
    buffer_load_dwordx4 v20, s[20:23], s45 offen lds
    v_accvgpr_read_b32 v122, a26
    v_mfma_f32_16x16x32_bf16 v[48:51], a[208:211], a[144:147], v[48:51]
    s_waitcnt lgkmcnt(3)
    ds_read_b128 a[200:203], v32 offset:320
    ds_read_b128 a[204:207], v32 offset:832
    v_mfma_f32_16x16x32_bf16 v[56:59], a[208:211], a[148:151], v[56:59]
    v_accvgpr_read_b32 v123, a27
    v_exp_f32 v120, v120
    v_mfma_f32_16x16x32_bf16 v[60:63], a[212:215], a[148:151], v[60:63]
    v_exp_f32 v121, v121
    v_add_f32 v21, v21, v118
    v_mfma_f32_16x16x32_bf16 v[52:55], a[212:215], a[144:147], v[52:55]
    v_cvt_pk_bf16_f32 v99, v118, v119
    v_add_f32 v21, v21, v119
    v_accvgpr_read_b32 v124, a28
    v_mfma_f32_16x16x32_bf16 v[48:51], a[216:219], a[152:155], v[48:51]
    s_waitcnt lgkmcnt(3)
    ds_read_b128 a[208:211], v32 offset:384
    ds_read_b128 a[212:215], v32 offset:896
    v_mfma_f32_16x16x32_bf16 v[56:59], a[216:219], a[156:159], v[56:59]
    v_accvgpr_read_b32 v125, a29
    v_exp_f32 v122, v122
    v_mfma_f32_16x16x32_bf16 v[60:63], a[220:223], a[156:159], v[60:63]
    s_add_u32 m0, s38, 102432
    v_exp_f32 v123, v123
    v_add_f32 v22, v24, v120
    v_mfma_f32_16x16x32_bf16 v[52:55], a[220:223], a[152:155], v[52:55]
    s_mov_b32 s45, 121984
    buffer_load_dwordx4 v20, s[20:23], s45 offen lds
    v_cvt_pk_bf16_f32 v100, v120, v121
    v_mfma_f32_16x16x32_bf16 v[48:51], a[192:195], a[160:163], v[48:51]
    s_waitcnt lgkmcnt(3)
    ds_read_b128 a[216:219], v32 offset:448
    ds_read_b128 a[220:223], v32 offset:960
    v_mfma_f32_16x16x32_bf16 v[56:59], a[192:195], a[164:167], v[56:59]
    v_add_f32 v22, v22, v121
    v_accvgpr_read_b32 v126, a30
    v_accvgpr_read_b32 v127, a31
    v_mfma_f32_16x16x32_bf16 v[60:63], a[196:199], a[164:167], v[60:63]
    v_exp_f32 v124, v124
    v_exp_f32 v125, v125
    v_mfma_f32_16x16x32_bf16 v[52:55], a[196:199], a[160:163], v[52:55]
    v_add_f32 v22, v22, v122
    v_cvt_pk_bf16_f32 v101, v122, v123
    v_mfma_f32_16x16x32_bf16 v[48:51], a[200:203], a[168:171], v[48:51]
    s_waitcnt lgkmcnt(3)
    ds_read_b64_tr_b16 a[192:193], v10 offset:33792
    ds_read_b64_tr_b16 a[194:195], v10 offset:34304
    v_mfma_f32_16x16x32_bf16 v[56:59], a[200:203], a[172:175], v[56:59]
    v_add_f32 v22, v22, v123
    v_exp_f32 v126, v126
    v_mfma_f32_16x16x32_bf16 v[60:63], a[204:207], a[172:175], v[60:63]
    s_add_u32 m0, s38, 103488
    ds_read_b64_tr_b16 a[196:197], v10 offset:33824
    ds_read_b64_tr_b16 a[198:199], v10 offset:34336
    v_mfma_f32_16x16x32_bf16 v[52:55], a[204:207], a[168:171], v[52:55]
    s_mov_b32 s45, 129152
    buffer_load_dwordx4 v20, s[20:23], s45 offen lds
    v_mfma_f32_16x16x32_bf16 v[48:51], a[208:211], a[176:179], v[48:51]
    s_waitcnt lgkmcnt(5)
    ds_read_b64_tr_b16 a[200:201], v10 offset:33856
    ds_read_b64_tr_b16 a[202:203], v10 offset:34368
    v_mfma_f32_16x16x32_bf16 v[56:59], a[208:211], a[180:183], v[56:59]
    v_exp_f32 v127, v127
    v_add_f32 v22, v22, v124
    v_cvt_pk_bf16_f32 v102, v124, v125
    v_mfma_f32_16x16x32_bf16 v[60:63], a[212:215], a[180:183], v[60:63]
    s_nop 0
    ds_read_b64_tr_b16 a[204:205], v10 offset:33888
    ds_read_b64_tr_b16 a[206:207], v10 offset:34400
    v_mfma_f32_16x16x32_bf16 v[52:55], a[212:215], a[176:179], v[52:55]
    v_add_f32 v22, v22, v125
    v_add_f32 v22, v22, v126
    v_cvt_pk_bf16_f32 v103, v126, v127
    v_mfma_f32_16x16x32_bf16 v[48:51], a[216:219], a[184:187], v[48:51]
    s_waitcnt lgkmcnt(6)
    ds_read_b64_tr_b16 a[208:209], v10 offset:33920
    ds_read_b64_tr_b16 a[210:211], v10 offset:34432
    v_mfma_f32_16x16x32_bf16 v[56:59], a[216:219], a[188:191], v[56:59]
    v_add_f32 v22, v22, v127
    v_max_f32 v30, v21, v22
    v_cmp_nge_f32 vcc, s35, v30
    v_mfma_f32_16x16x32_bf16 v[60:63], a[220:223], a[188:191], v[60:63]
    s_add_u32 m0, s38, 104544
    ds_read_b64_tr_b16 a[212:213], v10 offset:33952
    ds_read_b64_tr_b16 a[214:215], v10 offset:34464
    v_mfma_f32_16x16x32_bf16 v[52:55], a[220:223], a[184:187], v[52:55]
    s_mov_b32 s45, 136320
    buffer_load_dwordx4 v20, s[20:23], s45 offen lds
    s_cbranch_vccnz T_c2
B_c2:
    v_mfma_f32_16x16x32_bf16 v[128:131], a[192:195], v[96:99], v[128:131]
    s_waitcnt lgkmcnt(6)
    ds_read_b64_tr_b16 a[216:217], v10 offset:33984
    ds_read_b64_tr_b16 a[218:219], v10 offset:34496
    s_waitcnt vmcnt(12)
    v_mfma_f32_16x16x32_bf16 v[132:135], a[192:195], v[100:103], v[132:135]
    s_barrier
    v_mfma_f32_16x16x32_bf16 v[140:143], a[196:199], v[100:103], v[140:143]
    s_nop 0
    ds_read_b64_tr_b16 a[220:221], v10 offset:34016
    ds_read_b64_tr_b16 a[222:223], v10 offset:34528
    v_mfma_f32_16x16x32_bf16 v[136:139], a[196:199], v[96:99], v[136:139]
    v_exp_f32 v112, v48
    v_exp_f32 v113, v49
    v_mfma_f32_16x16x32_bf16 v[144:147], a[200:203], v[96:99], v[144:147]
    s_waitcnt lgkmcnt(6)
    ds_read_b64_tr_b16 a[192:193], v10 offset:34048
    ds_read_b64_tr_b16 a[194:195], v10 offset:34560
    v_mfma_f32_16x16x32_bf16 v[148:151], a[200:203], v[100:103], v[148:151]
    v_exp_f32 v114, v50
    v_exp_f32 v115, v51
    v_add_f32 v23, v21, v112
    v_cvt_pk_bf16_f32 v104, v112, v113
    v_mfma_f32_16x16x32_bf16 v[156:159], a[204:207], v[100:103], v[156:159]
    s_add_u32 m0, s38, 0
    ds_read_b64_tr_b16 a[196:197], v10 offset:34080
    ds_read_b64_tr_b16 a[198:199], v10 offset:34592
    v_mfma_f32_16x16x32_bf16 v[152:155], a[204:207], v[96:99], v[152:155]
    s_mov_b32 s45, 163840
    buffer_load_dwordx4 v19, s[16:19], s45 offen nt lds
    v_add_f32 v23, v23, v113
    v_mfma_f32_16x16x32_bf16 v[160:163], a[208:211], v[96:99], v[160:163]
    s_waitcnt lgkmcnt(6)
    ds_read_b64_tr_b16 a[200:201], v10 offset:34112
    ds_read_b64_tr_b16 a[202:203], v10 offset:34624
    v_mfma_f32_16x16x32_bf16 v[164:167], a[208:211], v[100:103], v[164:167]
    v_exp_f32 v116, v52
    v_exp_f32 v117, v53
    v_add_f32 v23, v23, v114
    v_mfma_f32_16x16x32_bf16 v[172:175], a[212:215], v[100:103], v[172:175]
    s_nop 0
    ds_read_b64_tr_b16 a[204:205], v10 offset:34144
    ds_read_b64_tr_b16 a[206:207], v10 offset:34656
    v_mfma_f32_16x16x32_bf16 v[168:171], a[212:215], v[96:99], v[168:171]
    v_cvt_pk_bf16_f32 v105, v114, v115
    v_add_f32 v23, v23, v115
    v_exp_f32 v118, v54
    v_mfma_f32_16x16x32_bf16 v[176:179], a[216:219], v[96:99], v[176:179]
    s_waitcnt lgkmcnt(6)
    ds_read_b64_tr_b16 a[208:209], v10 offset:34176
    ds_read_b64_tr_b16 a[210:211], v10 offset:34688
    v_mfma_f32_16x16x32_bf16 v[180:183], a[216:219], v[100:103], v[180:183]
    v_exp_f32 v119, v55
    v_add_f32 v23, v23, v116
    v_cvt_pk_bf16_f32 v106, v116, v117
    v_add_f32 v23, v23, v117
    v_mfma_f32_16x16x32_bf16 v[188:191], a[220:223], v[100:103], v[188:191]
    s_add_u32 m0, s38, 544
    ds_read_b64_tr_b16 a[212:213], v10 offset:34208
    ds_read_b64_tr_b16 a[214:215], v10 offset:34720
    v_mfma_f32_16x16x32_bf16 v[184:187], a[220:223], v[96:99], v[184:187]
    s_nop 0
    buffer_load_dwordx4 v19, s[16:19], s45 offen offset:512 nt lds
    v_mfma_f32_16x16x32_bf16 v[192:195], a[192:195], v[96:99], v[192:195]
    s_waitcnt lgkmcnt(6)
    ds_read_b64_tr_b16 a[216:217], v10 offset:34240
    ds_read_b64_tr_b16 a[218:219], v10 offset:34752
    v_mfma_f32_16x16x32_bf16 v[196:199], a[192:195], v[100:103], v[196:199]
    v_exp_f32 v120, v56
    v_exp_f32 v121, v57
    v_add_f32 v23, v23, v118
    v_cvt_pk_bf16_f32 v107, v118, v119
    v_add_f32 v23, v23, v119
    v_mfma_f32_16x16x32_bf16 v[204:207], a[196:199], v[100:103], v[204:207]
    s_nop 0
    ds_read_b64_tr_b16 a[220:221], v10 offset:34272
    ds_read_b64_tr_b16 a[222:223], v10 offset:34784
    v_mfma_f32_16x16x32_bf16 v[200:203], a[196:199], v[96:99], v[200:203]
    v_exp_f32 v122, v58
    v_exp_f32 v123, v59
    v_add_f32 v24, v22, v120
    v_mfma_f32_16x16x32_bf16 v[208:211], a[200:203], v[96:99], v[208:211]
    s_waitcnt lgkmcnt(6)
    ds_read_b64_tr_b16 a[192:193], v11 offset:0
    ds_read_b64_tr_b16 a[194:195], v11 offset:512
    v_mfma_f32_16x16x32_bf16 v[212:215], a[200:203], v[100:103], v[212:215]
    v_cvt_pk_bf16_f32 v108, v120, v121
    v_add_f32 v24, v24, v121
    v_exp_f32 v124, v60
    v_mfma_f32_16x16x32_bf16 v[220:223], a[204:207], v[100:103], v[220:223]
    s_add_u32 m0, s38, 1088
    ds_read_b64_tr_b16 a[196:197], v11 offset:32
    ds_read_b64_tr_b16 a[198:199], v11 offset:544
    v_mfma_f32_16x16x32_bf16 v[216:219], a[204:207], v[96:99], v[216:219]
    s_nop 0
    buffer_load_dwordx4 v19, s[16:19], s45 offen offset:1024 nt lds
    v_mfma_f32_16x16x32_bf16 v[224:227], a[208:211], v[96:99], v[224:227]
    s_waitcnt lgkmcnt(6)
    ds_read_b64_tr_b16 a[200:201], v11 offset:64
    ds_read_b64_tr_b16 a[202:203], v11 offset:576
    v_mfma_f32_16x16x32_bf16 v[228:231], a[208:211], v[100:103], v[228:231]
    v_exp_f32 v125, v61
    v_add_f32 v24, v24, v122
    v_cvt_pk_bf16_f32 v109, v122, v123
    v_add_f32 v24, v24, v123
    v_exp_f32 v126, v62
    v_mfma_f32_16x16x32_bf16 v[236:239], a[212:215], v[100:103], v[236:239]
    s_nop 0
    ds_read_b64_tr_b16 a[204:205], v11 offset:96
    ds_read_b64_tr_b16 a[206:207], v11 offset:608
    v_mfma_f32_16x16x32_bf16 v[232:235], a[212:215], v[96:99], v[232:235]
    v_exp_f32 v127, v63
    v_add_f32 v24, v24, v124
    v_cvt_pk_bf16_f32 v110, v124, v125
    v_add_f32 v24, v24, v125
    v_mfma_f32_16x16x32_bf16 v[240:243], a[216:219], v[96:99], v[240:243]
    s_waitcnt lgkmcnt(6)
    ds_read_b64_tr_b16 a[208:209], v11 offset:128
    ds_read_b64_tr_b16 a[210:211], v11 offset:640
    v_mfma_f32_16x16x32_bf16 v[244:247], a[216:219], v[100:103], v[244:247]
    v_add_f32 v24, v24, v126
    v_cvt_pk_bf16_f32 v111, v126, v127
    v_add_f32 v24, v24, v127
    v_max_f32 v30, v23, v24
    v_cmp_nge_f32 vcc, s35, v30
    v_mfma_f32_16x16x32_bf16 v[252:255], a[220:223], v[100:103], v[252:255]
    s_add_u32 m0, s38, 1632
    ds_read_b64_tr_b16 a[212:213], v11 offset:160
    ds_read_b64_tr_b16 a[214:215], v11 offset:672
    v_mfma_f32_16x16x32_bf16 v[248:251], a[220:223], v[96:99], v[248:251]
    s_nop 0
    buffer_load_dwordx4 v19, s[16:19], s45 offen offset:1536 nt lds
    s_cbranch_vccnz T_c3
B_c3:
    v_mfma_f32_16x16x32_bf16 v[128:131], a[192:195], v[104:107], v[128:131]
    s_waitcnt lgkmcnt(6)
    ds_read_b64_tr_b16 a[216:217], v11 offset:192
    ds_read_b64_tr_b16 a[218:219], v11 offset:704
    s_waitcnt vmcnt(12)
    v_mfma_f32_16x16x32_bf16 v[132:135], a[192:195], v[108:111], v[132:135]
    s_barrier
    v_mfma_f32_16x16x32_bf16 v[140:143], a[196:199], v[108:111], v[140:143]
    s_nop 0
    ds_read_b64_tr_b16 a[220:221], v11 offset:224
    ds_read_b64_tr_b16 a[222:223], v11 offset:736
    v_mfma_f32_16x16x32_bf16 v[136:139], a[196:199], v[104:107], v[136:139]
    v_accvgpr_read_b32 v112, a32
    v_accvgpr_read_b32 v113, a33
    v_mfma_f32_16x16x32_bf16 v[144:147], a[200:203], v[104:107], v[144:147]
    s_waitcnt lgkmcnt(6)
    ds_read_b64_tr_b16 a[192:193], v11 offset:256
    ds_read_b64_tr_b16 a[194:195], v11 offset:768
    v_mfma_f32_16x16x32_bf16 v[148:151], a[200:203], v[108:111], v[148:151]
    v_accvgpr_read_b32 v114, a34
    v_accvgpr_read_b32 v115, a35
    v_mfma_f32_16x16x32_bf16 v[156:159], a[204:207], v[108:111], v[156:159]
    s_add_u32 m0, s38, 33792
    ds_read_b64_tr_b16 a[196:197], v11 offset:288
    ds_read_b64_tr_b16 a[198:199], v11 offset:800
    v_mfma_f32_16x16x32_bf16 v[152:155], a[204:207], v[104:107], v[152:155]
    s_mov_b32 s45, 180224
    buffer_load_dwordx4 v14, s[12:15], s45 offen nt lds
    v_mfma_f32_16x16x32_bf16 v[160:163], a[208:211], v[104:107], v[160:163]
    s_waitcnt lgkmcnt(6)
    ds_read_b64_tr_b16 a[200:201], v11 offset:320
    ds_read_b64_tr_b16 a[202:203], v11 offset:832
    v_mfma_f32_16x16x32_bf16 v[164:167], a[208:211], v[108:111], v[164:167]
    v_exp_f32 v112, v112
    v_exp_f32 v113, v113
    v_mfma_f32_16x16x32_bf16 v[172:175], a[212:215], v[108:111], v[172:175]
    s_nop 0
    ds_read_b64_tr_b16 a[204:205], v11 offset:352
    ds_read_b64_tr_b16 a[206:207], v11 offset:864
    v_mfma_f32_16x16x32_bf16 v[168:171], a[212:215], v[104:107], v[168:171]
    v_accvgpr_read_b32 v116, a36
    v_accvgpr_read_b32 v117, a37
    v_mfma_f32_16x16x32_bf16 v[176:179], a[216:219], v[104:107], v[176:179]
    s_waitcnt lgkmcnt(6)
    ds_read_b64_tr_b16 a[208:209], v11 offset:384
    ds_read_b64_tr_b16 a[210:211], v11 offset:896
    v_mfma_f32_16x16x32_bf16 v[180:183], a[216:219], v[108:111], v[180:183]
    v_exp_f32 v114, v114
    v_mfma_f32_16x16x32_bf16 v[188:191], a[220:223], v[108:111], v[188:191]
    s_add_u32 m0, s38, 34336
    ds_read_b64_tr_b16 a[212:213], v11 offset:416
    ds_read_b64_tr_b16 a[214:215], v11 offset:928
    v_mfma_f32_16x16x32_bf16 v[184:187], a[220:223], v[104:107], v[184:187]
    s_nop 0
    buffer_load_dwordx4 v14, s[12:15], s45 offen offset:512 nt lds
    v_mfma_f32_16x16x32_bf16 v[192:195], a[192:195], v[104:107], v[192:195]
    s_waitcnt lgkmcnt(6)
    ds_read_b64_tr_b16 a[216:217], v11 offset:448
    ds_read_b64_tr_b16 a[218:219], v11 offset:960
    v_mfma_f32_16x16x32_bf16 v[196:199], a[192:195], v[108:111], v[196:199]
    v_exp_f32 v115, v115
    v_add_f32 v21, v23, v112
    v_mfma_f32_16x16x32_bf16 v[204:207], a[196:199], v[108:111], v[204:207]
    s_nop 0
    ds_read_b64_tr_b16 a[220:221], v11 offset:480
    ds_read_b64_tr_b16 a[222:223], v11 offset:992
    v_mfma_f32_16x16x32_bf16 v[200:203], a[196:199], v[104:107], v[200:203]
    v_cvt_pk_bf16_f32 v96, v112, v113
    v_add_f32 v21, v21, v113
    v_accvgpr_read_b32 v118, a38
    v_mfma_f32_16x16x32_bf16 v[208:211], a[200:203], v[104:107], v[208:211]
    s_waitcnt lgkmcnt(6)
    ds_read_b128 a[192:195], v33 offset:16896
    ds_read_b128 a[196:199], v33 offset:17408
    v_mfma_f32_16x16x32_bf16 v[212:215], a[200:203], v[108:111], v[212:215]
    v_accvgpr_read_b32 v119, a39
    v_mfma_f32_16x16x32_bf16 v[220:223], a[204:207], v[108:111], v[220:223]
    s_add_u32 m0, s38, 34880
    v_exp_f32 v116, v116
    v_exp_f32 v117, v117
    v_mfma_f32_16x16x32_bf16 v[216:219], a[204:207], v[104:107], v[216:219]
    s_nop 0
    buffer_load_dwordx4 v14, s[12:15], s45 offen offset:1024 nt lds
    v_mfma_f32_16x16x32_bf16 v[224:227], a[208:211], v[104:107], v[224:227]
    s_waitcnt lgkmcnt(4)
    ds_read_b128 a[200:203], v33 offset:16960
    ds_read_b128 a[204:207], v33 offset:17472
    v_mfma_f32_16x16x32_bf16 v[228:231], a[208:211], v[108:111], v[228:231]
    v_add_f32 v21, v21, v114
    v_cvt_pk_bf16_f32 v97, v114, v115
    v_mfma_f32_16x16x32_bf16 v[236:239], a[212:215], v[108:111], v[236:239]
    v_add_f32 v21, v21, v115
    v_accvgpr_read_b32 v120, a40
    v_accvgpr_read_b32 v121, a41
    v_mfma_f32_16x16x32_bf16 v[232:235], a[212:215], v[104:107], v[232:235]
    v_exp_f32 v118, v118
    v_mfma_f32_16x16x32_bf16 v[240:243], a[216:219], v[104:107], v[240:243]
    s_waitcnt lgkmcnt(3)
    ds_read_b128 a[208:211], v33 offset:17024
    ds_read_b128 a[212:215], v33 offset:17536
    v_mfma_f32_16x16x32_bf16 v[244:247], a[216:219], v[108:111], v[244:247]
    v_exp_f32 v119, v119
    v_mfma_f32_16x16x32_bf16 v[252:255], a[220:223], v[108:111], v[252:255]
    s_add_u32 m0, s38, 35424
    v_add_f32 v21, v21, v116
    v_cvt_pk_bf16_f32 v98, v116, v117
    v_mfma_f32_16x16x32_bf16 v[248:251], a[220:223], v[104:107], v[248:251]
    s_nop 0
    buffer_load_dwordx4 v14, s[12:15], s45 offen offset:1536 nt lds
    v_add_f32 v21, v21, v117
    v_mfma_f32_16x16x32_bf16 v[48:51], a[192:195], a[128:131], v[40:43]
    s_waitcnt lgkmcnt(3)
    ds_read_b128 a[216:219], v33 offset:17088
    ds_read_b128 a[220:223], v33 offset:17600
    s_waitcnt vmcnt(12)
    v_mfma_f32_16x16x32_bf16 v[56:59], a[192:195], a[132:135], v[44:47]
    s_barrier
    v_mfma_f32_16x16x32_bf16 v[60:63], a[196:199], a[132:135], v[44:47]
    v_accvgpr_read_b32 v122, a42
    v_accvgpr_read_b32 v123, a43
    v_mfma_f32_16x16x32_bf16 v[52:55], a[196:199], a[128:131], v[40:43]
    v_exp_f32 v120, v120
    v_mfma_f32_16x16x32_bf16 v[48:51], a[200:203], a[136:139], v[48:51]
    s_waitcnt lgkmcnt(3)
    ds_read_b128 a[192:195], v33 offset:17152
    ds_read_b128 a[196:199], v33 offset:17664
    v_mfma_f32_16x16x32_bf16 v[56:59], a[200:203], a[140:143], v[56:59]
    v_exp_f32 v121, v121
    v_add_f32 v21, v21, v118
    v_mfma_f32_16x16x32_bf16 v[60:63], a[204:207], a[140:143], v[60:63]
    s_add_u32 m0, s38, 50688
    v_cvt_pk_bf16_f32 v99, v118, v119
    v_add_f32 v21, v21, v119
    v_mfma_f32_16x16x32_bf16 v[52:55], a[204:207], a[136:139], v[52:55]
    s_mov_b32 s45, 49152
    buffer_load_dwordx4 v19, s[16:19], s45 offen nt lds
    v_accvgpr_read_b32 v124, a44
    v_mfma_f32_16x16x32_bf16 v[48:51], a[208:211], a[144:147], v[48:51]
    s_waitcnt lgkmcnt(3)
    ds_read_b128 a[200:203], v33 offset:17216
    ds_read_b128 a[204:207], v33 offset:17728
    v_mfma_f32_16x16x32_bf16 v[56:59], a[208:211], a[148:151], v[56:59]
    v_accvgpr_read_b32 v125, a45
    v_exp_f32 v122, v122
    v_mfma_f32_16x16x32_bf16 v[60:63], a[212:215], a[148:151], v[60:63]
    v_exp_f32 v123, v123
    v_mfma_f32_16x16x32_bf16 v[52:55], a[212:215], a[144:147], v[52:55]
    v_add_f32 v22, v24, v120
    v_cvt_pk_bf16_f32 v100, v120, v121
    v_mfma_f32_16x16x32_bf16 v[48:51], a[216:219], a[152:155], v[48:51]
    s_waitcnt lgkmcnt(3)
    ds_read_b128 a[208:211], v33 offset:17280
    ds_read_b128 a[212:215], v33 offset:17792
    v_mfma_f32_16x16x32_bf16 v[56:59], a[216:219], a[156:159], v[56:59]
    v_add_f32 v22, v22, v121
    v_accvgpr_read_b32 v126, a46
    v_mfma_f32_16x16x32_bf16 v[60:63], a[220:223], a[156:159], v[60:63]
    s_add_u32 m0, s38, 51232
    v_accvgpr_read_b32 v127, a47
    v_exp_f32 v124, v124
    v_mfma_f32_16x16x32_bf16 v[52:55], a[220:223], a[152:155], v[52:55]
    s_nop 0
    buffer_load_dwordx4 v19, s[16:19], s45 offen offset:512 nt lds
    v_mfma_f32_16x16x32_bf16 v[48:51], a[192:195], a[160:163], v[48:51]
    s_waitcnt lgkmcnt(3)
    ds_read_b128 a[216:219], v33 offset:17344
    ds_read_b128 a[220:223], v33 offset:17856
    v_mfma_f32_16x16x32_bf16 v[56:59], a[192:195], a[164:167], v[56:59]
    v_exp_f32 v125, v125
    v_add_f32 v22, v22, v122
    v_mfma_f32_16x16x32_bf16 v[60:63], a[196:199], a[164:167], v[60:63]
    v_cvt_pk_bf16_f32 v101, v122, v123
    v_add_f32 v22, v22, v123
    v_mfma_f32_16x16x32_bf16 v[52:55], a[196:199], a[160:163], v[52:55]
    v_exp_f32 v126, v126
    v_mfma_f32_16x16x32_bf16 v[48:51], a[200:203], a[168:171], v[48:51]
    s_waitcnt lgkmcnt(3)
    ds_read_b64_tr_b16 a[192:193], v11 offset:33792
    ds_read_b64_tr_b16 a[194:195], v11 offset:34304
    v_mfma_f32_16x16x32_bf16 v[56:59], a[200:203], a[172:175], v[56:59]
    v_exp_f32 v127, v127
    v_mfma_f32_16x16x32_bf16 v[60:63], a[204:207], a[172:175], v[60:63]
    s_add_u32 m0, s38, 51776
    ds_read_b64_tr_b16 a[196:197], v11 offset:33824
    ds_read_b64_tr_b16 a[198:199], v11 offset:34336
    v_mfma_f32_16x16x32_bf16 v[52:55], a[204:207], a[168:171], v[52:55]
    s_nop 0
    buffer_load_dwordx4 v19, s[16:19], s45 offen offset:1024 nt lds
    v_add_f32 v22, v22, v124
    v_mfma_f32_16x16x32_bf16 v[48:51], a[208:211], a[176:179], v[48:51]
    s_waitcnt lgkmcnt(5)
    ds_read_b64_tr_b16 a[200:201], v11 offset:33856
    ds_read_b64_tr_b16 a[202:203], v11 offset:34368
    v_mfma_f32_16x16x32_bf16 v[56:59], a[208:211], a[180:183], v[56:59]
    v_cvt_pk_bf16_f32 v102, v124, v125
    v_add_f32 v22, v22, v125
    v_add_f32 v22, v22, v126
    v_mfma_f32_16x16x32_bf16 v[60:63], a[212:215], a[180:183], v[60:63]
    s_nop 0
    ds_read_b64_tr_b16 a[204:205], v11 offset:33888
    ds_read_b64_tr_b16 a[206:207], v11 offset:34400
    v_mfma_f32_16x16x32_bf16 v[52:55], a[212:215], a[176:179], v[52:55]
    v_cvt_pk_bf16_f32 v103, v126, v127
    v_add_f32 v22, v22, v127
    v_mfma_f32_16x16x32_bf16 v[48:51], a[216:219], a[184:187], v[48:51]
    s_waitcnt lgkmcnt(6)
    ds_read_b64_tr_b16 a[208:209], v11 offset:33920
    ds_read_b64_tr_b16 a[210:211], v11 offset:34432
    v_mfma_f32_16x16x32_bf16 v[56:59], a[216:219], a[188:191], v[56:59]
    v_max_f32 v30, v21, v22
    v_cmp_nge_f32 vcc, s35, v30
    v_mfma_f32_16x16x32_bf16 v[60:63], a[220:223], a[188:191], v[60:63]
    s_add_u32 m0, s38, 52320
    ds_read_b64_tr_b16 a[212:213], v11 offset:33952
    ds_read_b64_tr_b16 a[214:215], v11 offset:34464
    v_mfma_f32_16x16x32_bf16 v[52:55], a[220:223], a[184:187], v[52:55]
    s_nop 0
    buffer_load_dwordx4 v19, s[16:19], s45 offen offset:1536 nt lds
    s_cbranch_vccnz T_c4
B_c4:
    v_mov_b32 v95, 16
    s_cmp_lg_u32 s3, 0
    s_cbranch_scc1 L_nock
    global_load_dword v95, v3, s[82:83] sc1
L_nock:
    v_mfma_f32_16x16x32_bf16 v[128:131], a[192:195], v[96:99], v[128:131]
    s_waitcnt lgkmcnt(6)
    ds_read_b64_tr_b16 a[216:217], v11 offset:33984
    ds_read_b64_tr_b16 a[218:219], v11 offset:34496
    s_waitcnt vmcnt(8)
    v_mfma_f32_16x16x32_bf16 v[132:135], a[192:195], v[100:103], v[132:135]
    s_barrier
    v_mfma_f32_16x16x32_bf16 v[140:143], a[196:199], v[100:103], v[140:143]
    s_nop 0
    ds_read_b64_tr_b16 a[220:221], v11 offset:34016
    ds_read_b64_tr_b16 a[222:223], v11 offset:34528
    v_mfma_f32_16x16x32_bf16 v[136:139], a[196:199], v[96:99], v[136:139]
    v_exp_f32 v112, v48
    v_exp_f32 v113, v49
    v_mfma_f32_16x16x32_bf16 v[144:147], a[200:203], v[96:99], v[144:147]
    s_waitcnt lgkmcnt(6)
    ds_read_b64_tr_b16 a[192:193], v11 offset:34048
    ds_read_b64_tr_b16 a[194:195], v11 offset:34560
    v_mfma_f32_16x16x32_bf16 v[148:151], a[200:203], v[100:103], v[148:151]
    v_exp_f32 v114, v50
    v_exp_f32 v115, v51
    v_add_f32 v23, v21, v112
    v_cvt_pk_bf16_f32 v104, v112, v113
    v_mfma_f32_16x16x32_bf16 v[156:159], a[204:207], v[100:103], v[156:159]
    s_add_u32 m0, s38, 67584
    ds_read_b64_tr_b16 a[196:197], v11 offset:34080
    ds_read_b64_tr_b16 a[198:199], v11 offset:34592
    v_mfma_f32_16x16x32_bf16 v[152:155], a[204:207], v[96:99], v[152:155]
    s_mov_b32 s45, 180224
    buffer_load_dwordx4 v19, s[16:19], s45 offen nt lds
    v_add_f32 v23, v23, v113
    v_mfma_f32_16x16x32_bf16 v[160:163], a[208:211], v[96:99], v[160:163]
    s_waitcnt lgkmcnt(6)
    ds_read_b64_tr_b16 a[200:201], v11 offset:34112
    ds_read_b64_tr_b16 a[202:203], v11 offset:34624
    v_mfma_f32_16x16x32_bf16 v[164:167], a[208:211], v[100:103], v[164:167]
    v_exp_f32 v116, v52
    v_exp_f32 v117, v53
    v_add_f32 v23, v23, v114
    v_mfma_f32_16x16x32_bf16 v[172:175], a[212:215], v[100:103], v[172:175]
    s_nop 0
    ds_read_b64_tr_b16 a[204:205], v11 offset:34144
    ds_read_b64_tr_b16 a[206:207], v11 offset:34656
    v_mfma_f32_16x16x32_bf16 v[168:171], a[212:215], v[96:99], v[168:171]
    v_cvt_pk_bf16_f32 v105, v114, v115
    v_add_f32 v23, v23, v115
    v_exp_f32 v118, v54
    v_mfma_f32_16x16x32_bf16 v[176:179], a[216:219], v[96:99], v[176:179]
    s_waitcnt lgkmcnt(6)
    ds_read_b64_tr_b16 a[208:209], v11 offset:34176
    ds_read_b64_tr_b16 a[210:211], v11 offset:34688
    v_mfma_f32_16x16x32_bf16 v[180:183], a[216:219], v[100:103], v[180:183]
    v_exp_f32 v119, v55
    v_add_f32 v23, v23, v116
    v_cvt_pk_bf16_f32 v106, v116, v117
    v_add_f32 v23, v23, v117
    v_mfma_f32_16x16x32_bf16 v[188:191], a[220:223], v[100:103], v[188:191]
    s_add_u32 m0, s38, 68128
    ds_read_b64_tr_b16 a[212:213], v11 offset:34208
    ds_read_b64_tr_b16 a[214:215], v11 offset:34720
    v_mfma_f32_16x16x32_bf16 v[184:187], a[220:223], v[96:99], v[184:187]
    s_nop 0
    buffer_load_dwordx4 v19, s[16:19], s45 offen offset:512 nt lds
    v_mfma_f32_16x16x32_bf16 v[192:195], a[192:195], v[96:99], v[192:195]
    s_waitcnt lgkmcnt(6)
    ds_read_b64_tr_b16 a[216:217], v11 offset:34240
    ds_read_b64_tr_b16 a[218:219], v11 offset:34752
    v_mfma_f32_16x16x32_bf16 v[196:199], a[192:195], v[100:103], v[196:199]
    v_exp_f32 v120, v56
    v_exp_f32 v121, v57
    v_add_f32 v23, v23, v118
    v_cvt_pk_bf16_f32 v107, v118, v119
    v_add_f32 v23, v23, v119
    v_mfma_f32_16x16x32_bf16 v[204:207], a[196:199], v[100:103], v[204:207]
    s_nop 0
    ds_read_b64_tr_b16 a[220:221], v11 offset:34272
    ds_read_b64_tr_b16 a[222:223], v11 offset:34784
    v_mfma_f32_16x16x32_bf16 v[200:203], a[196:199], v[96:99], v[200:203]
    v_exp_f32 v122, v58
    v_exp_f32 v123, v59
    v_add_f32 v24, v22, v120
    v_mfma_f32_16x16x32_bf16 v[208:211], a[200:203], v[96:99], v[208:211]
    s_waitcnt lgkmcnt(6)
    ds_read_b64_tr_b16 a[192:193], v10 offset:0
    ds_read_b64_tr_b16 a[194:195], v10 offset:512
    v_mfma_f32_16x16x32_bf16 v[212:215], a[200:203], v[100:103], v[212:215]
    v_cvt_pk_bf16_f32 v108, v120, v121
    v_add_f32 v24, v24, v121
    v_exp_f32 v124, v60
    v_mfma_f32_16x16x32_bf16 v[220:223], a[204:207], v[100:103], v[220:223]
    s_add_u32 m0, s38, 68672
    ds_read_b64_tr_b16 a[196:197], v10 offset:32
    ds_read_b64_tr_b16 a[198:199], v10 offset:544
    v_mfma_f32_16x16x32_bf16 v[216:219], a[204:207], v[96:99], v[216:219]
    s_nop 0
    buffer_load_dwordx4 v19, s[16:19], s45 offen offset:1024 nt lds
    v_mfma_f32_16x16x32_bf16 v[224:227], a[208:211], v[96:99], v[224:227]
    s_waitcnt lgkmcnt(6)
    ds_read_b64_tr_b16 a[200:201], v10 offset:64
    ds_read_b64_tr_b16 a[202:203], v10 offset:576
    v_mfma_f32_16x16x32_bf16 v[228:231], a[208:211], v[100:103], v[228:231]
    v_exp_f32 v125, v61
    v_add_f32 v24, v24, v122
    v_cvt_pk_bf16_f32 v109, v122, v123
    v_add_f32 v24, v24, v123
    v_exp_f32 v126, v62
    v_mfma_f32_16x16x32_bf16 v[236:239], a[212:215], v[100:103], v[236:239]
    s_nop 0
    ds_read_b64_tr_b16 a[204:205], v10 offset:96
    ds_read_b64_tr_b16 a[206:207], v10 offset:608
    v_mfma_f32_16x16x32_bf16 v[232:235], a[212:215], v[96:99], v[232:235]
    v_exp_f32 v127, v63
    v_add_f32 v24, v24, v124
    v_cvt_pk_bf16_f32 v110, v124, v125
    v_add_f32 v24, v24, v125
    v_mfma_f32_16x16x32_bf16 v[240:243], a[216:219], v[96:99], v[240:243]
    s_waitcnt lgkmcnt(6)
    ds_read_b64_tr_b16 a[208:209], v10 offset:128
    ds_read_b64_tr_b16 a[210:211], v10 offset:640
    v_mfma_f32_16x16x32_bf16 v[244:247], a[216:219], v[100:103], v[244:247]
    v_add_f32 v24, v24, v126
    v_cvt_pk_bf16_f32 v111, v126, v127
    v_add_f32 v24, v24, v127
    v_max_f32 v30, v23, v24
    v_cmp_nge_f32 vcc, s35, v30
    v_mfma_f32_16x16x32_bf16 v[252:255], a[220:223], v[100:103], v[252:255]
    s_add_u32 m0, s38, 69216
    ds_read_b64_tr_b16 a[212:213], v10 offset:160
    ds_read_b64_tr_b16 a[214:215], v10 offset:672
    v_mfma_f32_16x16x32_bf16 v[248:251], a[220:223], v[96:99], v[248:251]
    s_nop 0
    buffer_load_dwordx4 v19, s[16:19], s45 offen offset:1536 nt lds
    s_cbranch_vccnz T_c5
B_c5:
    v_mfma_f32_16x16x32_bf16 v[128:131], a[192:195], v[104:107], v[128:131]
    s_waitcnt lgkmcnt(6)
    ds_read_b64_tr_b16 a[216:217], v10 offset:192
    ds_read_b64_tr_b16 a[218:219], v10 offset:704
    s_waitcnt vmcnt(8)
    v_mfma_f32_16x16x32_bf16 v[132:135], a[192:195], v[108:111], v[132:135]
    s_barrier
    v_mfma_f32_16x16x32_bf16 v[140:143], a[196:199], v[108:111], v[140:143]
    s_nop 0
    ds_read_b64_tr_b16 a[220:221], v10 offset:224
    ds_read_b64_tr_b16 a[222:223], v10 offset:736
    v_mfma_f32_16x16x32_bf16 v[136:139], a[196:199], v[104:107], v[136:139]
    v_accvgpr_read_b32 v112, a48
    v_accvgpr_read_b32 v113, a49
    v_mfma_f32_16x16x32_bf16 v[144:147], a[200:203], v[104:107], v[144:147]
    s_waitcnt lgkmcnt(6)
    ds_read_b64_tr_b16 a[192:193], v10 offset:256
    ds_read_b64_tr_b16 a[194:195], v10 offset:768
    v_mfma_f32_16x16x32_bf16 v[148:151], a[200:203], v[108:111], v[148:151]
    v_accvgpr_read_b32 v114, a50
    v_accvgpr_read_b32 v115, a51
    v_mfma_f32_16x16x32_bf16 v[156:159], a[204:207], v[108:111], v[156:159]
    s_add_u32 m0, s38, 84480
    ds_read_b64_tr_b16 a[196:197], v10 offset:288
    ds_read_b64_tr_b16 a[198:199], v10 offset:800
    v_mfma_f32_16x16x32_bf16 v[152:155], a[204:207], v[104:107], v[152:155]
    s_mov_b32 s45, 196608
    buffer_load_dwordx4 v14, s[12:15], s45 offen nt lds
    v_mfma_f32_16x16x32_bf16 v[160:163], a[208:211], v[104:107], v[160:163]
    s_waitcnt lgkmcnt(6)
    ds_read_b64_tr_b16 a[200:201], v10 offset:320
    ds_read_b64_tr_b16 a[202:203], v10 offset:832
    v_mfma_f32_16x16x32_bf16 v[164:167], a[208:211], v[108:111], v[164:167]
    v_exp_f32 v112, v112
    v_exp_f32 v113, v113
    v_mfma_f32_16x16x32_bf16 v[172:175], a[212:215], v[108:111], v[172:175]
    s_nop 0
    ds_read_b64_tr_b16 a[204:205], v10 offset:352
    ds_read_b64_tr_b16 a[206:207], v10 offset:864
    v_mfma_f32_16x16x32_bf16 v[168:171], a[212:215], v[104:107], v[168:171]
    v_accvgpr_read_b32 v116, a52
    v_accvgpr_read_b32 v117, a53
    v_mfma_f32_16x16x32_bf16 v[176:179], a[216:219], v[104:107], v[176:179]
    s_waitcnt lgkmcnt(6)
    ds_read_b64_tr_b16 a[208:209], v10 offset:384
    ds_read_b64_tr_b16 a[210:211], v10 offset:896
    v_mfma_f32_16x16x32_bf16 v[180:183], a[216:219], v[108:111], v[180:183]
    v_exp_f32 v114, v114
    v_mfma_f32_16x16x32_bf16 v[188:191], a[220:223], v[108:111], v[188:191]
    s_add_u32 m0, s38, 85024
    ds_read_b64_tr_b16 a[212:213], v10 offset:416
    ds_read_b64_tr_b16 a[214:215], v10 offset:928
    v_mfma_f32_16x16x32_bf16 v[184:187], a[220:223], v[104:107], v[184:187]
    s_nop 0
    buffer_load_dwordx4 v14, s[12:15], s45 offen offset:512 nt lds
    v_mfma_f32_16x16x32_bf16 v[192:195], a[192:195], v[104:107], v[192:195]
    s_waitcnt lgkmcnt(6)
    ds_read_b64_tr_b16 a[216:217], v10 offset:448
    ds_read_b64_tr_b16 a[218:219], v10 offset:960
    v_mfma_f32_16x16x32_bf16 v[196:199], a[192:195], v[108:111], v[196:199]
    v_exp_f32 v115, v115
    v_add_f32 v21, v23, v112
    v_cvt_pk_bf16_f32 v96, v112, v113
    v_mfma_f32_16x16x32_bf16 v[204:207], a[196:199], v[108:111], v[204:207]
    s_nop 0
    ds_read_b64_tr_b16 a[220:221], v10 offset:480
    ds_read_b64_tr_b16 a[222:223], v10 offset:992
    v_mfma_f32_16x16x32_bf16 v[200:203], a[196:199], v[104:107], v[200:203]
    v_add_f32 v21, v21, v113
    v_accvgpr_read_b32 v118, a54
    v_mfma_f32_16x16x32_bf16 v[208:211], a[200:203], v[104:107], v[208:211]
    s_waitcnt lgkmcnt(6)
    ds_read_b128 a[192:195], v32 offset:33792
    ds_read_b128 a[196:199], v32 offset:34304
    v_mfma_f32_16x16x32_bf16 v[212:215], a[200:203], v[108:111], v[212:215]
    v_accvgpr_read_b32 v119, a55
    v_exp_f32 v116, v116
    v_mfma_f32_16x16x32_bf16 v[220:223], a[204:207], v[108:111], v[220:223]
    s_add_u32 m0, s38, 85568
    v_exp_f32 v117, v117
    v_mfma_f32_16x16x32_bf16 v[216:219], a[204:207], v[104:107], v[216:219]
    s_nop 0
    buffer_load_dwordx4 v14, s[12:15], s45 offen offset:1024 nt lds
    v_add_f32 v21, v21, v114
    v_mfma_f32_16x16x32_bf16 v[224:227], a[208:211], v[104:107], v[224:227]
    s_waitcnt lgkmcnt(4)
    ds_read_b128 a[200:203], v32 offset:33856
    ds_read_b128 a[204:207], v32 offset:34368
    v_mfma_f32_16x16x32_bf16 v[228:231], a[208:211], v[108:111], v[228:231]
    v_cvt_pk_bf16_f32 v97, v114, v115
    v_add_f32 v21, v21, v115
    v_mfma_f32_16x16x32_bf16 v[236:239], a[212:215], v[108:111], v[236:239]
    v_accvgpr_read_b32 v120, a56
    v_accvgpr_read_b32 v121, a57
    v_mfma_f32_16x16x32_bf16 v[232:235], a[212:215], v[104:107], v[232:235]
    v_exp_f32 v118, v118
    v_mfma_f32_16x16x32_bf16 v[240:243], a[216:219], v[104:107], v[240:243]
    s_waitcnt lgkmcnt(3)
    ds_read_b128 a[208:211], v32 offset:33920
    ds_read_b128 a[212:215], v32 offset:34432
    v_mfma_f32_16x16x32_bf16 v[244:247], a[216:219], v[108:111], v[244:247]
    v_exp_f32 v119, v119
    v_add_f32 v21, v21, v116
    v_mfma_f32_16x16x32_bf16 v[252:255], a[220:223], v[108:111], v[252:255]
    s_add_u32 m0, s38, 86112
    v_cvt_pk_bf16_f32 v98, v116, v117
    v_add_f32 v21, v21, v117
    v_mfma_f32_16x16x32_bf16 v[248:251], a[220:223], v[104:107], v[248:251]
    s_nop 0
    buffer_load_dwordx4 v14, s[12:15], s45 offen offset:1536 nt lds
    v_accvgpr_read_b32 v122, a58
    v_mfma_f32_16x16x32_bf16 v[48:51], a[192:195], a[128:131], v[40:43]
    s_waitcnt lgkmcnt(3)
    ds_read_b128 a[216:219], v32 offset:33984
    ds_read_b128 a[220:223], v32 offset:34496
    s_waitcnt vmcnt(8)
    v_mfma_f32_16x16x32_bf16 v[56:59], a[192:195], a[132:135], v[44:47]
    s_barrier
    v_mfma_f32_16x16x32_bf16 v[60:63], a[196:199], a[132:135], v[44:47]
    v_accvgpr_read_b32 v123, a59
    v_exp_f32 v120, v120
    v_mfma_f32_16x16x32_bf16 v[52:55], a[196:199], a[128:131], v[40:43]
    v_exp_f32 v121, v121
    v_mfma_f32_16x16x32_bf16 v[48:51], a[200:203], a[136:139], v[48:51]
    s_waitcnt lgkmcnt(3)
    ds_read_b128 a[192:195], v32 offset:34048
    ds_read_b128 a[196:199], v32 offset:34560
    v_mfma_f32_16x16x32_bf16 v[56:59], a[200:203], a[140:143], v[56:59]
    v_add_f32 v21, v21, v118
    v_cvt_pk_bf16_f32 v99, v118, v119
    v_mfma_f32_16x16x32_bf16 v[60:63], a[204:207], a[140:143], v[60:63]
    s_add_u32 m0, s38, 0
    v_add_f32 v21, v21, v119
    v_accvgpr_read_b32 v124, a60
    v_accvgpr_read_b32 v125, a61
    v_mfma_f32_16x16x32_bf16 v[52:55], a[204:207], a[136:139], v[52:55]
    s_mov_b32 s45, 65536
    buffer_load_dwordx4 v19, s[16:19], s45 offen nt lds
    v_mfma_f32_16x16x32_bf16 v[48:51], a[208:211], a[144:147], v[48:51]
    s_waitcnt lgkmcnt(3)
    ds_read_b128 a[200:203], v32 offset:34112
    ds_read_b128 a[204:207], v32 offset:34624
    v_mfma_f32_16x16x32_bf16 v[56:59], a[208:211], a[148:151], v[56:59]
    v_exp_f32 v122, v122
    v_mfma_f32_16x16x32_bf16 v[60:63], a[212:215], a[148:151], v[60:63]
    v_exp_f32 v123, v123
    v_add_f32 v22, v24, v120
    v_mfma_f32_16x16x32_bf16 v[52:55], a[212:215], a[144:147], v[52:55]
    v_cvt_pk_bf16_f32 v100, v120, v121
    v_add_f32 v22, v22, v121
    v_accvgpr_read_b32 v126, a62
    v_mfma_f32_16x16x32_bf16 v[48:51], a[216:219], a[152:155], v[48:51]
    s_waitcnt lgkmcnt(3)
    ds_read_b128 a[208:211], v32 offset:34176
    ds_read_b128 a[212:215], v32 offset:34688
    v_mfma_f32_16x16x32_bf16 v[56:59], a[216:219], a[156:159], v[56:59]
    s_nop 0
    buffer_load_dword v37, v36, s[20:23], s49 offen offset:256
    v_mfma_f32_16x16x32_bf16 v[60:63], a[220:223], a[156:159], v[60:63]
    s_add_u32 m0, s38, 544
    v_accvgpr_read_b32 v127, a63
    v_mfma_f32_16x16x32_bf16 v[52:55], a[220:223], a[152:155], v[52:55]
    s_nop 0
    buffer_load_dwordx4 v19, s[16:19], s45 offen offset:512 nt lds
    v_mfma_f32_16x16x32_bf16 v[48:51], a[192:195], a[160:163], v[48:51]
    s_waitcnt lgkmcnt(3)
    ds_read_b128 a[216:219], v32 offset:34240
    ds_read_b128 a[220:223], v32 offset:34752
    v_mfma_f32_16x16x32_bf16 v[56:59], a[192:195], a[164:167], v[56:59]
    v_exp_f32 v124, v124
    v_exp_f32 v125, v125
    v_mfma_f32_16x16x32_bf16 v[60:63], a[196:199], a[164:167], v[60:63]
    v_add_f32 v22, v22, v122
    v_cvt_pk_bf16_f32 v101, v122, v123
    v_mfma_f32_16x16x32_bf16 v[52:55], a[196:199], a[160:163], v[52:55]
    v_add_f32 v22, v22, v123
    v_exp_f32 v126, v126
    v_mfma_f32_16x16x32_bf16 v[48:51], a[200:203], a[168:171], v[48:51]
    s_waitcnt lgkmcnt(3)
    ds_read_b64_tr_b16 a[192:193], v11 offset:0
    ds_read_b64_tr_b16 a[194:195], v11 offset:512
    v_mfma_f32_16x16x32_bf16 v[56:59], a[200:203], a[172:175], v[56:59]
    v_exp_f32 v127, v127
    v_mfma_f32_16x16x32_bf16 v[60:63], a[204:207], a[172:175], v[60:63]
    s_add_u32 m0, s38, 1088
    ds_read_b64_tr_b16 a[196:197], v11 offset:32
    ds_read_b64_tr_b16 a[198:199], v11 offset:544
    v_mfma_f32_16x16x32_bf16 v[52:55], a[204:207], a[168:171], v[52:55]
    s_nop 0
    buffer_load_dwordx4 v19, s[16:19], s45 offen offset:1024 nt lds
    v_add_f32 v22, v22, v124
    v_mfma_f32_16x16x32_bf16 v[48:51], a[208:211], a[176:179], v[48:51]
    s_waitcnt lgkmcnt(5)
    ds_read_b64_tr_b16 a[200:201], v11 offset:64
    ds_read_b64_tr_b16 a[202:203], v11 offset:576
    v_mfma_f32_16x16x32_bf16 v[56:59], a[208:211], a[180:183], v[56:59]
    v_cvt_pk_bf16_f32 v102, v124, v125
    v_add_f32 v22, v22, v125
    v_mfma_f32_16x16x32_bf16 v[60:63], a[212:215], a[180:183], v[60:63]
    s_nop 0
    ds_read_b64_tr_b16 a[204:205], v11 offset:96
    ds_read_b64_tr_b16 a[206:207], v11 offset:608
    v_mfma_f32_16x16x32_bf16 v[52:55], a[212:215], a[176:179], v[52:55]
    v_add_f32 v22, v22, v126
    v_cvt_pk_bf16_f32 v103, v126, v127
    v_add_f32 v22, v22, v127
    v_mfma_f32_16x16x32_bf16 v[48:51], a[216:219], a[184:187], v[48:51]
    s_waitcnt lgkmcnt(6)
    ds_read_b64_tr_b16 a[208:209], v11 offset:128
    ds_read_b64_tr_b16 a[210:211], v11 offset:640
    v_mfma_f32_16x16x32_bf16 v[56:59], a[216:219], a[188:191], v[56:59]
    v_max_f32 v30, v21, v22
    v_cmp_nge_f32 vcc, s35, v30
    v_mfma_f32_16x16x32_bf16 v[60:63], a[220:223], a[188:191], v[60:63]
    s_add_u32 m0, s38, 1632
    ds_read_b64_tr_b16 a[212:213], v11 offset:160
    ds_read_b64_tr_b16 a[214:215], v11 offset:672
    v_mfma_f32_16x16x32_bf16 v[52:55], a[220:223], a[184:187], v[52:55]
    s_nop 0
    buffer_load_dwordx4 v19, s[16:19], s45 offen offset:1536 nt lds
    s_cbranch_vccnz T_c6
B_c6:
    v_mfma_f32_16x16x32_bf16 v[128:131], a[192:195], v[96:99], v[128:131]
    s_waitcnt lgkmcnt(6)
    ds_read_b64_tr_b16 a[216:217], v11 offset:192
    ds_read_b64_tr_b16 a[218:219], v11 offset:704
    s_waitcnt vmcnt(9)
    v_mfma_f32_16x16x32_bf16 v[132:135], a[192:195], v[100:103], v[132:135]
    s_barrier
    v_mfma_f32_16x16x32_bf16 v[140:143], a[196:199], v[100:103], v[140:143]
    s_nop 0
    ds_read_b64_tr_b16 a[220:221], v11 offset:224
    ds_read_b64_tr_b16 a[222:223], v11 offset:736
    v_mfma_f32_16x16x32_bf16 v[136:139], a[196:199], v[96:99], v[136:139]
    v_exp_f32 v112, v48
    v_exp_f32 v113, v49
    v_mfma_f32_16x16x32_bf16 v[144:147], a[200:203], v[96:99], v[144:147]
    s_waitcnt lgkmcnt(6)
    ds_read_b64_tr_b16 a[192:193], v11 offset:256
    ds_read_b64_tr_b16 a[194:195], v11 offset:768
    v_mfma_f32_16x16x32_bf16 v[148:151], a[200:203], v[100:103], v[148:151]
    v_exp_f32 v114, v50
    v_exp_f32 v115, v51
    v_add_f32 v23, v21, v112
    v_cvt_pk_bf16_f32 v104, v112, v113
    v_mfma_f32_16x16x32_bf16 v[156:159], a[204:207], v[100:103], v[156:159]
    s_add_u32 m0, s38, 33792
    ds_read_b64_tr_b16 a[196:197], v11 offset:288
    ds_read_b64_tr_b16 a[198:199], v11 offset:800
    v_mfma_f32_16x16x32_bf16 v[152:155], a[204:207], v[96:99], v[152:155]
    s_mov_b32 s45, 196608
    buffer_load_dwordx4 v19, s[16:19], s45 offen nt lds
    v_add_f32 v23, v23, v113
    v_mfma_f32_16x16x32_bf16 v[160:163], a[208:211], v[96:99], v[160:163]
    s_waitcnt lgkmcnt(6)
    ds_read_b64_tr_b16 a[200:201], v11 offset:320
    ds_read_b64_tr_b16 a[202:203], v11 offset:832
    v_mfma_f32_16x16x32_bf16 v[164:167], a[208:211], v[100:103], v[164:167]
    v_exp_f32 v116, v52
    v_exp_f32 v117, v53
    v_add_f32 v23, v23, v114
    v_mfma_f32_16x16x32_bf16 v[172:175], a[212:215], v[100:103], v[172:175]
    s_nop 0
    ds_read_b64_tr_b16 a[204:205], v11 offset:352
    ds_read_b64_tr_b16 a[206:207], v11 offset:864
    v_mfma_f32_16x16x32_bf16 v[168:171], a[212:215], v[96:99], v[168:171]
    v_cvt_pk_bf16_f32 v105, v114, v115
    v_add_f32 v23, v23, v115
    v_exp_f32 v118, v54
    v_mfma_f32_16x16x32_bf16 v[176:179], a[216:219], v[96:99], v[176:179]
    s_waitcnt lgkmcnt(6)
    ds_read_b64_tr_b16 a[208:209], v11 offset:384
    ds_read_b64_tr_b16 a[210:211], v11 offset:896
    v_mfma_f32_16x16x32_bf16 v[180:183], a[216:219], v[100:103], v[180:183]
    v_exp_f32 v119, v55
    v_add_f32 v23, v23, v116
    v_cvt_pk_bf16_f32 v106, v116, v117
    v_add_f32 v23, v23, v117
    v_mfma_f32_16x16x32_bf16 v[188:191], a[220:223], v[100:103], v[188:191]
    s_add_u32 m0, s38, 34336
    ds_read_b64_tr_b16 a[212:213], v11 offset:416
    ds_read_b64_tr_b16 a[214:215], v11 offset:928
    v_mfma_f32_16x16x32_bf16 v[184:187], a[220:223], v[96:99], v[184:187]
    s_nop 0
    buffer_load_dwordx4 v19, s[16:19], s45 offen offset:512 nt lds
    v_mfma_f32_16x16x32_bf16 v[192:195], a[192:195], v[96:99], v[192:195]
    s_waitcnt lgkmcnt(6)
    ds_read_b64_tr_b16 a[216:217], v11 offset:448
    ds_read_b64_tr_b16 a[218:219], v11 offset:960
    v_mfma_f32_16x16x32_bf16 v[196:199], a[192:195], v[100:103], v[196:199]
    v_exp_f32 v120, v56
    v_exp_f32 v121, v57
    v_add_f32 v23, v23, v118
    v_cvt_pk_bf16_f32 v107, v118, v119
    v_add_f32 v23, v23, v119
    v_mfma_f32_16x16x32_bf16 v[204:207], a[196:199], v[100:103], v[204:207]
    s_nop 0
    ds_read_b64_tr_b16 a[220:221], v11 offset:480
    ds_read_b64_tr_b16 a[222:223], v11 offset:992
    v_mfma_f32_16x16x32_bf16 v[200:203], a[196:199], v[96:99], v[200:203]
    v_exp_f32 v122, v58
    v_exp_f32 v123, v59
    v_add_f32 v24, v22, v120
    v_mfma_f32_16x16x32_bf16 v[208:211], a[200:203], v[96:99], v[208:211]
    s_waitcnt lgkmcnt(6)
    ds_read_b64_tr_b16 a[192:193], v11 offset:16896
    ds_read_b64_tr_b16 a[194:195], v11 offset:17408
    v_mfma_f32_16x16x32_bf16 v[212:215], a[200:203], v[100:103], v[212:215]
    v_cvt_pk_bf16_f32 v108, v120, v121
    v_add_f32 v24, v24, v121
    v_exp_f32 v124, v60
    v_mfma_f32_16x16x32_bf16 v[220:223], a[204:207], v[100:103], v[220:223]
    s_add_u32 m0, s38, 34880
    ds_read_b64_tr_b16 a[196:197], v11 offset:16928
    ds_read_b64_tr_b16 a[198:199], v11 offset:17440
    v_mfma_f32_16x16x32_bf16 v[216:219], a[204:207], v[96:99], v[216:219]
    s_nop 0
    buffer_load_dwordx4 v19, s[16:19], s45 offen offset:1024 nt lds
    v_mfma_f32_16x16x32_bf16 v[224:227], a[208:211], v[96:99], v[224:227]
    s_waitcnt lgkmcnt(6)
    ds_read_b64_tr_b16 a[200:201], v11 offset:16960
    ds_read_b64_tr_b16 a[202:203], v11 offset:17472
    v_mfma_f32_16x16x32_bf16 v[228:231], a[208:211], v[100:103], v[228:231]
    v_exp_f32 v125, v61
    v_add_f32 v24, v24, v122
    v_cvt_pk_bf16_f32 v109, v122, v123
    v_add_f32 v24, v24, v123
    v_exp_f32 v126, v62
    v_mfma_f32_16x16x32_bf16 v[236:239], a[212:215], v[100:103], v[236:239]
    s_nop 0
    ds_read_b64_tr_b16 a[204:205], v11 offset:16992
    ds_read_b64_tr_b16 a[206:207], v11 offset:17504
    v_mfma_f32_16x16x32_bf16 v[232:235], a[212:215], v[96:99], v[232:235]
    v_exp_f32 v127, v63
    v_add_f32 v24, v24, v124
    v_cvt_pk_bf16_f32 v110, v124, v125
    v_add_f32 v24, v24, v125
    v_mfma_f32_16x16x32_bf16 v[240:243], a[216:219], v[96:99], v[240:243]
    s_waitcnt lgkmcnt(6)
    ds_read_b64_tr_b16 a[208:209], v11 offset:17024
    ds_read_b64_tr_b16 a[210:211], v11 offset:17536
    v_mfma_f32_16x16x32_bf16 v[244:247], a[216:219], v[100:103], v[244:247]
    v_add_f32 v24, v24, v126
    v_cvt_pk_bf16_f32 v111, v126, v127
    v_add_f32 v24, v24, v127
    v_max_f32 v30, v23, v24
    v_cmp_nge_f32 vcc, s35, v30
    v_mfma_f32_16x16x32_bf16 v[252:255], a[220:223], v[100:103], v[252:255]
    s_add_u32 m0, s38, 35424
    ds_read_b64_tr_b16 a[212:213], v11 offset:17056
    ds_read_b64_tr_b16 a[214:215], v11 offset:17568
    v_mfma_f32_16x16x32_bf16 v[248:251], a[220:223], v[96:99], v[248:251]
    s_nop 0
    buffer_load_dwordx4 v19, s[16:19], s45 offen offset:1536 nt lds
    s_cbranch_vccnz T_c7
B_c7:
    v_mfma_f32_16x16x32_bf16 v[128:131], a[192:195], v[104:107], v[128:131]
    s_waitcnt lgkmcnt(6)
    ds_read_b64_tr_b16 a[216:217], v11 offset:17088
    ds_read_b64_tr_b16 a[218:219], v11 offset:17600
    s_waitcnt vmcnt(9)
    v_mfma_f32_16x16x32_bf16 v[132:135], a[192:195], v[108:111], v[132:135]
    s_barrier
    v_mfma_f32_16x16x32_bf16 v[140:143], a[196:199], v[108:111], v[140:143]
    s_nop 0
    ds_read_b64_tr_b16 a[220:221], v11 offset:17120
    ds_read_b64_tr_b16 a[222:223], v11 offset:17632
    v_mfma_f32_16x16x32_bf16 v[136:139], a[196:199], v[104:107], v[136:139]
    v_accvgpr_read_b32 v112, a64
    v_accvgpr_read_b32 v113, a65
    v_mfma_f32_16x16x32_bf16 v[144:147], a[200:203], v[104:107], v[144:147]
    s_waitcnt lgkmcnt(6)
    ds_read_b64_tr_b16 a[192:193], v11 offset:17152
    ds_read_b64_tr_b16 a[194:195], v11 offset:17664
    v_mfma_f32_16x16x32_bf16 v[148:151], a[200:203], v[108:111], v[148:151]
    v_accvgpr_read_b32 v114, a66
    v_accvgpr_read_b32 v115, a67
    v_mfma_f32_16x16x32_bf16 v[156:159], a[204:207], v[108:111], v[156:159]
    s_add_u32 m0, s38, 50688
    ds_read_b64_tr_b16 a[196:197], v11 offset:17184
    ds_read_b64_tr_b16 a[198:199], v11 offset:17696
    v_mfma_f32_16x16x32_bf16 v[152:155], a[204:207], v[104:107], v[152:155]
    s_mov_b32 s45, 212992
    buffer_load_dwordx4 v14, s[12:15], s45 offen nt lds
    v_mfma_f32_16x16x32_bf16 v[160:163], a[208:211], v[104:107], v[160:163]
    s_waitcnt lgkmcnt(6)
    ds_read_b64_tr_b16 a[200:201], v11 offset:17216
    ds_read_b64_tr_b16 a[202:203], v11 offset:17728
    v_mfma_f32_16x16x32_bf16 v[164:167], a[208:211], v[108:111], v[164:167]
    v_exp_f32 v112, v112
    v_exp_f32 v113, v113
    v_mfma_f32_16x16x32_bf16 v[172:175], a[212:215], v[108:111], v[172:175]
    s_nop 0
    ds_read_b64_tr_b16 a[204:205], v11 offset:17248
    ds_read_b64_tr_b16 a[206:207], v11 offset:17760
    v_mfma_f32_16x16x32_bf16 v[168:171], a[212:215], v[104:107], v[168:171]
    v_accvgpr_read_b32 v116, a68
    v_accvgpr_read_b32 v117, a69
    v_mfma_f32_16x16x32_bf16 v[176:179], a[216:219], v[104:107], v[176:179]
    s_waitcnt lgkmcnt(6)
    ds_read_b64_tr_b16 a[208:209], v11 offset:17280
    ds_read_b64_tr_b16 a[210:211], v11 offset:17792
    v_mfma_f32_16x16x32_bf16 v[180:183], a[216:219], v[108:111], v[180:183]
    v_exp_f32 v114, v114
    v_mfma_f32_16x16x32_bf16 v[188:191], a[220:223], v[108:111], v[188:191]
    s_add_u32 m0, s38, 51232
    ds_read_b64_tr_b16 a[212:213], v11 offset:17312
    ds_read_b64_tr_b16 a[214:215], v11 offset:17824
    v_mfma_f32_16x16x32_bf16 v[184:187], a[220:223], v[104:107], v[184:187]
    s_nop 0
    buffer_load_dwordx4 v14, s[12:15], s45 offen offset:512 nt lds
    v_mfma_f32_16x16x32_bf16 v[192:195], a[192:195], v[104:107], v[192:195]
    s_waitcnt lgkmcnt(6)
    ds_read_b64_tr_b16 a[216:217], v11 offset:17344
    ds_read_b64_tr_b16 a[218:219], v11 offset:17856
    v_mfma_f32_16x16x32_bf16 v[196:199], a[192:195], v[108:111], v[196:199]
    v_exp_f32 v115, v115
    v_add_f32 v21, v23, v112
    v_cvt_pk_bf16_f32 v96, v112, v113
    v_mfma_f32_16x16x32_bf16 v[204:207], a[196:199], v[108:111], v[204:207]
    s_nop 0
    ds_read_b64_tr_b16 a[220:221], v11 offset:17376
    ds_read_b64_tr_b16 a[222:223], v11 offset:17888
    v_mfma_f32_16x16x32_bf16 v[200:203], a[196:199], v[104:107], v[200:203]
    v_add_f32 v21, v21, v113
    v_accvgpr_read_b32 v118, a70
    v_mfma_f32_16x16x32_bf16 v[208:211], a[200:203], v[104:107], v[208:211]
    s_waitcnt lgkmcnt(6)
    ds_read_b128 a[192:195], v33 offset:33792
    ds_read_b128 a[196:199], v33 offset:34304
    v_mfma_f32_16x16x32_bf16 v[212:215], a[200:203], v[108:111], v[212:215]
    v_accvgpr_read_b32 v119, a71
    v_exp_f32 v116, v116
    v_mfma_f32_16x16x32_bf16 v[220:223], a[204:207], v[108:111], v[220:223]
    s_add_u32 m0, s38, 51776
    v_exp_f32 v117, v117
    v_mfma_f32_16x16x32_bf16 v[216:219], a[204:207], v[104:107], v[216:219]
    s_nop 0
    buffer_load_dwordx4 v14, s[12:15], s45 offen offset:1024 nt lds
    v_add_f32 v21, v21, v114
    v_mfma_f32_16x16x32_bf16 v[224:227], a[208:211], v[104:107], v[224:227]
    s_waitcnt lgkmcnt(4)
    ds_read_b128 a[200:203], v33 offset:33856
    ds_read_b128 a[204:207], v33 offset:34368
    v_mfma_f32_16x16x32_bf16 v[228:231], a[208:211], v[108:111], v[228:231]
    v_cvt_pk_bf16_f32 v97, v114, v115
    v_add_f32 v21, v21, v115
    v_mfma_f32_16x16x32_bf16 v[236:239], a[212:215], v[108:111], v[236:239]
    v_accvgpr_read_b32 v120, a72
    v_accvgpr_read_b32 v121, a73
    v_mfma_f32_16x16x32_bf16 v[232:235], a[212:215], v[104:107], v[232:235]
    v_exp_f32 v118, v118
    v_mfma_f32_16x16x32_bf16 v[240:243], a[216:219], v[104:107], v[240:243]
    s_waitcnt lgkmcnt(3)
    ds_read_b128 a[208:211], v33 offset:33920
    ds_read_b128 a[212:215], v33 offset:34432
    v_mfma_f32_16x16x32_bf16 v[244:247], a[216:219], v[108:111], v[244:247]
    v_exp_f32 v119, v119
    v_add_f32 v21, v21, v116
    v_mfma_f32_16x16x32_bf16 v[252:255], a[220:223], v[108:111], v[252:255]
    s_add_u32 m0, s38, 52320
    v_cvt_pk_bf16_f32 v98, v116, v117
    v_add_f32 v21, v21, v117
    v_mfma_f32_16x16x32_bf16 v[248:251], a[220:223], v[104:107], v[248:251]
    s_nop 0
    buffer_load_dwordx4 v14, s[12:15], s45 offen offset:1536 nt lds
    v_accvgpr_read_b32 v122, a74
    v_mfma_f32_16x16x32_bf16 v[48:51], a[192:195], a[128:131], v[40:43]
    s_waitcnt lgkmcnt(3)
    ds_read_b128 a[216:219], v33 offset:33984
    ds_read_b128 a[220:223], v33 offset:34496
    s_waitcnt vmcnt(8)
    v_mfma_f32_16x16x32_bf16 v[56:59], a[192:195], a[132:135], v[44:47]
    s_barrier
    v_mfma_f32_16x16x32_bf16 v[60:63], a[196:199], a[132:135], v[44:47]
    v_accvgpr_read_b32 v123, a75
    v_exp_f32 v120, v120
    v_mfma_f32_16x16x32_bf16 v[52:55], a[196:199], a[128:131], v[40:43]
    v_exp_f32 v121, v121
    v_mfma_f32_16x16x32_bf16 v[48:51], a[200:203], a[136:139], v[48:51]
    s_waitcnt lgkmcnt(3)
    ds_read_b128 a[192:195], v33 offset:34048
    ds_read_b128 a[196:199], v33 offset:34560
    v_mfma_f32_16x16x32_bf16 v[56:59], a[200:203], a[140:143], v[56:59]
    v_add_f32 v21, v21, v118
    v_cvt_pk_bf16_f32 v99, v118, v119
    v_mfma_f32_16x16x32_bf16 v[60:63], a[204:207], a[140:143], v[60:63]
    s_add_u32 m0, s38, 67584
    v_add_f32 v21, v21, v119
    v_accvgpr_read_b32 v124, a76
    v_accvgpr_read_b32 v125, a77
    v_mfma_f32_16x16x32_bf16 v[52:55], a[204:207], a[136:139], v[52:55]
    s_mov_b32 s45, 81920
    buffer_load_dwordx4 v19, s[16:19], s45 offen nt lds
    v_mfma_f32_16x16x32_bf16 v[48:51], a[208:211], a[144:147], v[48:51]
    s_waitcnt lgkmcnt(3)
    ds_read_b128 a[200:203], v33 offset:34112
    ds_read_b128 a[204:207], v33 offset:34624
    v_mfma_f32_16x16x32_bf16 v[56:59], a[208:211], a[148:151], v[56:59]
    v_exp_f32 v122, v122
    v_mfma_f32_16x16x32_bf16 v[60:63], a[212:215], a[148:151], v[60:63]
    v_exp_f32 v123, v123
    v_add_f32 v22, v24, v120
    v_mfma_f32_16x16x32_bf16 v[52:55], a[212:215], a[144:147], v[52:55]
    v_cvt_pk_bf16_f32 v100, v120, v121
    v_add_f32 v22, v22, v121
    v_accvgpr_read_b32 v126, a78
    v_mfma_f32_16x16x32_bf16 v[48:51], a[216:219], a[152:155], v[48:51]
    s_waitcnt lgkmcnt(3)
    ds_read_b128 a[208:211], v33 offset:34176
    ds_read_b128 a[212:215], v33 offset:34688
    v_mfma_f32_16x16x32_bf16 v[56:59], a[216:219], a[156:159], v[56:59]
    s_nop 0
    buffer_load_dword v37, v36, s[20:23], s49 offen offset:384
    v_mfma_f32_16x16x32_bf16 v[60:63], a[220:223], a[156:159], v[60:63]
    s_add_u32 m0, s38, 68128
    v_accvgpr_read_b32 v127, a79
    v_mfma_f32_16x16x32_bf16 v[52:55], a[220:223], a[152:155], v[52:55]
    s_nop 0
    buffer_load_dwordx4 v19, s[16:19], s45 offen offset:512 nt lds
    v_mfma_f32_16x16x32_bf16 v[48:51], a[192:195], a[160:163], v[48:51]
    s_waitcnt lgkmcnt(3)
    ds_read_b128 a[216:219], v33 offset:34240
    ds_read_b128 a[220:223], v33 offset:34752
    v_mfma_f32_16x16x32_bf16 v[56:59], a[192:195], a[164:167], v[56:59]
    v_exp_f32 v124, v124
    v_exp_f32 v125, v125
    v_mfma_f32_16x16x32_bf16 v[60:63], a[196:199], a[164:167], v[60:63]
    v_add_f32 v22, v22, v122
    v_cvt_pk_bf16_f32 v101, v122, v123
    v_mfma_f32_16x16x32_bf16 v[52:55], a[196:199], a[160:163], v[52:55]
    v_add_f32 v22, v22, v123
    v_exp_f32 v126, v126
    v_mfma_f32_16x16x32_bf16 v[48:51], a[200:203], a[168:171], v[48:51]
    s_waitcnt lgkmcnt(3)
    ds_read_b64_tr_b16 a[192:193], v10 offset:0
    ds_read_b64_tr_b16 a[194:195], v10 offset:512
    v_mfma_f32_16x16x32_bf16 v[56:59], a[200:203], a[172:175], v[56:59]
    v_exp_f32 v127, v127
    v_mfma_f32_16x16x32_bf16 v[60:63], a[204:207], a[172:175], v[60:63]
    s_add_u32 m0, s38, 68672
    ds_read_b64_tr_b16 a[196:197], v10 offset:32
    ds_read_b64_tr_b16 a[198:199], v10 offset:544
    v_mfma_f32_16x16x32_bf16 v[52:55], a[204:207], a[168:171], v[52:55]
    s_nop 0
    buffer_load_dwordx4 v19, s[16:19], s45 offen offset:1024 nt lds
    v_add_f32 v22, v22, v124
    v_mfma_f32_16x16x32_bf16 v[48:51], a[208:211], a[176:179], v[48:51]
    s_waitcnt lgkmcnt(5)
    ds_read_b64_tr_b16 a[200:201], v10 offset:64
    ds_read_b64_tr_b16 a[202:203], v10 offset:576
    v_mfma_f32_16x16x32_bf16 v[56:59], a[208:211], a[180:183], v[56:59]
    v_cvt_pk_bf16_f32 v102, v124, v125
    v_add_f32 v22, v22, v125
    v_mfma_f32_16x16x32_bf16 v[60:63], a[212:215], a[180:183], v[60:63]
    s_nop 0
    ds_read_b64_tr_b16 a[204:205], v10 offset:96
    ds_read_b64_tr_b16 a[206:207], v10 offset:608
    v_mfma_f32_16x16x32_bf16 v[52:55], a[212:215], a[176:179], v[52:55]
    v_add_f32 v22, v22, v126
    v_cvt_pk_bf16_f32 v103, v126, v127
    v_add_f32 v22, v22, v127
    v_mfma_f32_16x16x32_bf16 v[48:51], a[216:219], a[184:187], v[48:51]
    s_waitcnt lgkmcnt(6)
    ds_read_b64_tr_b16 a[208:209], v10 offset:128
    ds_read_b64_tr_b16 a[210:211], v10 offset:640
    v_mfma_f32_16x16x32_bf16 v[56:59], a[216:219], a[188:191], v[56:59]
    v_max_f32 v30, v21, v22
    v_cmp_nge_f32 vcc, s35, v30
    v_mfma_f32_16x16x32_bf16 v[60:63], a[220:223], a[188:191], v[60:63]
    s_add_u32 m0, s38, 69216
    ds_read_b64_tr_b16 a[212:213], v10 offset:160
    ds_read_b64_tr_b16 a[214:215], v10 offset:672
    v_mfma_f32_16x16x32_bf16 v[52:55], a[220:223], a[184:187], v[52:55]
    s_nop 0
    buffer_load_dwordx4 v19, s[16:19], s45 offen offset:1536 nt lds
    s_cbranch_vccnz T_c8
B_c8:
    v_mfma_f32_16x16x32_bf16 v[128:131], a[192:195], v[96:99], v[128:131]
    s_waitcnt lgkmcnt(6)
    ds_read_b64_tr_b16 a[216:217], v10 offset:192
    ds_read_b64_tr_b16 a[218:219], v10 offset:704
    s_waitcnt vmcnt(9)
    v_mfma_f32_16x16x32_bf16 v[132:135], a[192:195], v[100:103], v[132:135]
    s_barrier
    v_mfma_f32_16x16x32_bf16 v[140:143], a[196:199], v[100:103], v[140:143]
    s_nop 0
    ds_read_b64_tr_b16 a[220:221], v10 offset:224
    ds_read_b64_tr_b16 a[222:223], v10 offset:736
    v_mfma_f32_16x16x32_bf16 v[136:139], a[196:199], v[96:99], v[136:139]
    v_exp_f32 v112, v48
    v_exp_f32 v113, v49
    v_mfma_f32_16x16x32_bf16 v[144:147], a[200:203], v[96:99], v[144:147]
    s_waitcnt lgkmcnt(6)
    ds_read_b64_tr_b16 a[192:193], v10 offset:256
    ds_read_b64_tr_b16 a[194:195], v10 offset:768
    v_mfma_f32_16x16x32_bf16 v[148:151], a[200:203], v[100:103], v[148:151]
    v_exp_f32 v114, v50
    v_exp_f32 v115, v51
    v_add_f32 v23, v21, v112
    v_cvt_pk_bf16_f32 v104, v112, v113
    v_mfma_f32_16x16x32_bf16 v[156:159], a[204:207], v[100:103], v[156:159]
    s_add_u32 m0, s38, 84480
    ds_read_b64_tr_b16 a[196:197], v10 offset:288
    ds_read_b64_tr_b16 a[198:199], v10 offset:800
    v_mfma_f32_16x16x32_bf16 v[152:155], a[204:207], v[96:99], v[152:155]
    s_mov_b32 s45, 212992
    buffer_load_dwordx4 v19, s[16:19], s45 offen nt lds
    v_add_f32 v23, v23, v113
    v_mfma_f32_16x16x32_bf16 v[160:163], a[208:211], v[96:99], v[160:163]
    s_waitcnt lgkmcnt(6)
    ds_read_b64_tr_b16 a[200:201], v10 offset:320
    ds_read_b64_tr_b16 a[202:203], v10 offset:832
    v_mfma_f32_16x16x32_bf16 v[164:167], a[208:211], v[100:103], v[164:167]
    v_exp_f32 v116, v52
    v_exp_f32 v117, v53
    v_add_f32 v23, v23, v114
    v_mfma_f32_16x16x32_bf16 v[172:175], a[212:215], v[100:103], v[172:175]
    s_nop 0
    ds_read_b64_tr_b16 a[204:205], v10 offset:352
    ds_read_b64_tr_b16 a[206:207], v10 offset:864
    v_mfma_f32_16x16x32_bf16 v[168:171], a[212:215], v[96:99], v[168:171]
    v_cvt_pk_bf16_f32 v105, v114, v115
    v_add_f32 v23, v23, v115
    v_exp_f32 v118, v54
    v_mfma_f32_16x16x32_bf16 v[176:179], a[216:219], v[96:99], v[176:179]
    s_waitcnt lgkmcnt(6)
    ds_read_b64_tr_b16 a[208:209], v10 offset:384
    ds_read_b64_tr_b16 a[210:211], v10 offset:896
    v_mfma_f32_16x16x32_bf16 v[180:183], a[216:219], v[100:103], v[180:183]
    v_exp_f32 v119, v55
    v_add_f32 v23, v23, v116
    v_cvt_pk_bf16_f32 v106, v116, v117
    v_add_f32 v23, v23, v117
    v_mfma_f32_16x16x32_bf16 v[188:191], a[220:223], v[100:103], v[188:191]
    s_add_u32 m0, s38, 85024
    ds_read_b64_tr_b16 a[212:213], v10 offset:416
    ds_read_b64_tr_b16 a[214:215], v10 offset:928
    v_mfma_f32_16x16x32_bf16 v[184:187], a[220:223], v[96:99], v[184:187]
    s_nop 0
    buffer_load_dwordx4 v19, s[16:19], s45 offen offset:512 nt lds
    v_mfma_f32_16x16x32_bf16 v[192:195], a[192:195], v[96:99], v[192:195]
    s_waitcnt lgkmcnt(6)
    ds_read_b64_tr_b16 a[216:217], v10 offset:448
    ds_read_b64_tr_b16 a[218:219], v10 offset:960
    v_mfma_f32_16x16x32_bf16 v[196:199], a[192:195], v[100:103], v[196:199]
    v_exp_f32 v120, v56
    v_exp_f32 v121, v57
    v_add_f32 v23, v23, v118
    v_cvt_pk_bf16_f32 v107, v118, v119
    v_add_f32 v23, v23, v119
    v_mfma_f32_16x16x32_bf16 v[204:207], a[196:199], v[100:103], v[204:207]
    s_nop 0
    ds_read_b64_tr_b16 a[220:221], v10 offset:480
    ds_read_b64_tr_b16 a[222:223], v10 offset:992
    v_mfma_f32_16x16x32_bf16 v[200:203], a[196:199], v[96:99], v[200:203]
    v_exp_f32 v122, v58
    v_exp_f32 v123, v59
    v_add_f32 v24, v22, v120
    v_mfma_f32_16x16x32_bf16 v[208:211], a[200:203], v[96:99], v[208:211]
    s_waitcnt lgkmcnt(6)
    ds_read_b64_tr_b16 a[192:193], v10 offset:33792
    ds_read_b64_tr_b16 a[194:195], v10 offset:34304
    v_mfma_f32_16x16x32_bf16 v[212:215], a[200:203], v[100:103], v[212:215]
    v_cvt_pk_bf16_f32 v108, v120, v121
    v_add_f32 v24, v24, v121
    v_exp_f32 v124, v60
    v_mfma_f32_16x16x32_bf16 v[220:223], a[204:207], v[100:103], v[220:223]
    s_add_u32 m0, s38, 85568
    ds_read_b64_tr_b16 a[196:197], v10 offset:33824
    ds_read_b64_tr_b16 a[198:199], v10 offset:34336
    v_mfma_f32_16x16x32_bf16 v[216:219], a[204:207], v[96:99], v[216:219]
    s_nop 0
    buffer_load_dwordx4 v19, s[16:19], s45 offen offset:1024 nt lds
    v_mfma_f32_16x16x32_bf16 v[224:227], a[208:211], v[96:99], v[224:227]
    s_waitcnt lgkmcnt(6)
    ds_read_b64_tr_b16 a[200:201], v10 offset:33856
    ds_read_b64_tr_b16 a[202:203], v10 offset:34368
    v_mfma_f32_16x16x32_bf16 v[228:231], a[208:211], v[100:103], v[228:231]
    v_exp_f32 v125, v61
    v_add_f32 v24, v24, v122
    v_cvt_pk_bf16_f32 v109, v122, v123
    v_add_f32 v24, v24, v123
    v_exp_f32 v126, v62
    v_mfma_f32_16x16x32_bf16 v[236:239], a[212:215], v[100:103], v[236:239]
    s_nop 0
    ds_read_b64_tr_b16 a[204:205], v10 offset:33888
    ds_read_b64_tr_b16 a[206:207], v10 offset:34400
    v_mfma_f32_16x16x32_bf16 v[232:235], a[212:215], v[96:99], v[232:235]
    v_exp_f32 v127, v63
    v_add_f32 v24, v24, v124
    v_cvt_pk_bf16_f32 v110, v124, v125
    v_add_f32 v24, v24, v125
    v_mfma_f32_16x16x32_bf16 v[240:243], a[216:219], v[96:99], v[240:243]
    s_waitcnt lgkmcnt(6)
    ds_read_b64_tr_b16 a[208:209], v10 offset:33920
    ds_read_b64_tr_b16 a[210:211], v10 offset:34432
    v_mfma_f32_16x16x32_bf16 v[244:247], a[216:219], v[100:103], v[244:247]
    v_add_f32 v24, v24, v126
    v_cvt_pk_bf16_f32 v111, v126, v127
    v_add_f32 v24, v24, v127
    v_max_f32 v30, v23, v24
    v_cmp_nge_f32 vcc, s35, v30
    v_mfma_f32_16x16x32_bf16 v[252:255], a[220:223], v[100:103], v[252:255]
    s_add_u32 m0, s38, 86112
    ds_read_b64_tr_b16 a[212:213], v10 offset:33952
    ds_read_b64_tr_b16 a[214:215], v10 offset:34464
    v_mfma_f32_16x16x32_bf16 v[248:251], a[220:223], v[96:99], v[248:251]
    s_nop 0
    buffer_load_dwordx4 v19, s[16:19], s45 offen offset:1536 nt lds
    s_cbranch_vccnz T_c9
B_c9:
    v_mfma_f32_16x16x32_bf16 v[128:131], a[192:195], v[104:107], v[128:131]
    s_waitcnt lgkmcnt(6)
    ds_read_b64_tr_b16 a[216:217], v10 offset:33984
    ds_read_b64_tr_b16 a[218:219], v10 offset:34496
    s_waitcnt vmcnt(9)
    v_mfma_f32_16x16x32_bf16 v[132:135], a[192:195], v[108:111], v[132:135]
    s_barrier
    v_mfma_f32_16x16x32_bf16 v[140:143], a[196:199], v[108:111], v[140:143]
    s_nop 0
    ds_read_b64_tr_b16 a[220:221], v10 offset:34016
    ds_read_b64_tr_b16 a[222:223], v10 offset:34528
    v_mfma_f32_16x16x32_bf16 v[136:139], a[196:199], v[104:107], v[136:139]
    v_accvgpr_read_b32 v112, a80
    v_accvgpr_read_b32 v113, a81
    v_mfma_f32_16x16x32_bf16 v[144:147], a[200:203], v[104:107], v[144:147]
    s_waitcnt lgkmcnt(6)
    ds_read_b64_tr_b16 a[192:193], v10 offset:34048
    ds_read_b64_tr_b16 a[194:195], v10 offset:34560
    v_mfma_f32_16x16x32_bf16 v[148:151], a[200:203], v[108:111], v[148:151]
    v_accvgpr_read_b32 v114, a82
    v_accvgpr_read_b32 v115, a83
    v_mfma_f32_16x16x32_bf16 v[156:159], a[204:207], v[108:111], v[156:159]
    s_add_u32 m0, s38, 0
    ds_read_b64_tr_b16 a[196:197], v10 offset:34080
    ds_read_b64_tr_b16 a[198:199], v10 offset:34592
    v_mfma_f32_16x16x32_bf16 v[152:155], a[204:207], v[104:107], v[152:155]
    s_mov_b32 s45, 229376
    buffer_load_dwordx4 v14, s[12:15], s45 offen nt lds
    v_mfma_f32_16x16x32_bf16 v[160:163], a[208:211], v[104:107], v[160:163]
    s_waitcnt lgkmcnt(6)
    ds_read_b64_tr_b16 a[200:201], v10 offset:34112
    ds_read_b64_tr_b16 a[202:203], v10 offset:34624
    v_mfma_f32_16x16x32_bf16 v[164:167], a[208:211], v[108:111], v[164:167]
    v_exp_f32 v112, v112
    v_exp_f32 v113, v113
    v_mfma_f32_16x16x32_bf16 v[172:175], a[212:215], v[108:111], v[172:175]
    s_nop 0
    ds_read_b64_tr_b16 a[204:205], v10 offset:34144
    ds_read_b64_tr_b16 a[206:207], v10 offset:34656
    v_mfma_f32_16x16x32_bf16 v[168:171], a[212:215], v[104:107], v[168:171]
    v_accvgpr_read_b32 v116, a84
    v_accvgpr_read_b32 v117, a85
    v_mfma_f32_16x16x32_bf16 v[176:179], a[216:219], v[104:107], v[176:179]
    s_waitcnt lgkmcnt(6)
    ds_read_b64_tr_b16 a[208:209], v10 offset:34176
    ds_read_b64_tr_b16 a[210:211], v10 offset:34688
    v_mfma_f32_16x16x32_bf16 v[180:183], a[216:219], v[108:111], v[180:183]
    v_exp_f32 v114, v114
    v_mfma_f32_16x16x32_bf16 v[188:191], a[220:223], v[108:111], v[188:191]
    s_add_u32 m0, s38, 544
    ds_read_b64_tr_b16 a[212:213], v10 offset:34208
    ds_read_b64_tr_b16 a[214:215], v10 offset:34720
    v_mfma_f32_16x16x32_bf16 v[184:187], a[220:223], v[104:107], v[184:187]
    s_nop 0
    buffer_load_dwordx4 v14, s[12:15], s45 offen offset:512 nt lds
    v_mfma_f32_16x16x32_bf16 v[192:195], a[192:195], v[104:107], v[192:195]
    s_waitcnt lgkmcnt(6)
    ds_read_b64_tr_b16 a[216:217], v10 offset:34240
    ds_read_b64_tr_b16 a[218:219], v10 offset:34752
    v_mfma_f32_16x16x32_bf16 v[196:199], a[192:195], v[108:111], v[196:199]
    v_exp_f32 v115, v115
    v_add_f32 v21, v23, v112
    v_cvt_pk_bf16_f32 v96, v112, v113
    v_mfma_f32_16x16x32_bf16 v[204:207], a[196:199], v[108:111], v[204:207]
    s_nop 0
    ds_read_b64_tr_b16 a[220:221], v10 offset:34272
    ds_read_b64_tr_b16 a[222:223], v10 offset:34784
    v_mfma_f32_16x16x32_bf16 v[200:203], a[196:199], v[104:107], v[200:203]
    v_add_f32 v21, v21, v113
    v_accvgpr_read_b32 v118, a86
    v_mfma_f32_16x16x32_bf16 v[208:211], a[200:203], v[104:107], v[208:211]
    s_waitcnt lgkmcnt(6)
    ds_read_b128 a[192:195], v33 offset:0
    ds_read_b128 a[196:199], v33 offset:512
    v_mfma_f32_16x16x32_bf16 v[212:215], a[200:203], v[108:111], v[212:215]
    v_accvgpr_read_b32 v119, a87
    v_exp_f32 v116, v116
    v_mfma_f32_16x16x32_bf16 v[220:223], a[204:207], v[108:111], v[220:223]
    s_add_u32 m0, s38, 1088
    v_exp_f32 v117, v117
    v_mfma_f32_16x16x32_bf16 v[216:219], a[204:207], v[104:107], v[216:219]
    s_nop 0
    buffer_load_dwordx4 v14, s[12:15], s45 offen offset:1024 nt lds
    v_add_f32 v21, v21, v114
    v_mfma_f32_16x16x32_bf16 v[224:227], a[208:211], v[104:107], v[224:227]
    s_waitcnt lgkmcnt(4)
    ds_read_b128 a[200:203], v33 offset:64
    ds_read_b128 a[204:207], v33 offset:576
    v_mfma_f32_16x16x32_bf16 v[228:231], a[208:211], v[108:111], v[228:231]
    v_cvt_pk_bf16_f32 v97, v114, v115
    v_add_f32 v21, v21, v115
    v_mfma_f32_16x16x32_bf16 v[236:239], a[212:215], v[108:111], v[236:239]
    v_accvgpr_read_b32 v120, a88
    v_accvgpr_read_b32 v121, a89
    v_mfma_f32_16x16x32_bf16 v[232:235], a[212:215], v[104:107], v[232:235]
    v_exp_f32 v118, v118
    v_mfma_f32_16x16x32_bf16 v[240:243], a[216:219], v[104:107], v[240:243]
    s_waitcnt lgkmcnt(3)
    ds_read_b128 a[208:211], v33 offset:128
    ds_read_b128 a[212:215], v33 offset:640
    v_mfma_f32_16x16x32_bf16 v[244:247], a[216:219], v[108:111], v[244:247]
    v_exp_f32 v119, v119
    v_add_f32 v21, v21, v116
    v_mfma_f32_16x16x32_bf16 v[252:255], a[220:223], v[108:111], v[252:255]
    s_add_u32 m0, s38, 1632
    v_cvt_pk_bf16_f32 v98, v116, v117
    v_add_f32 v21, v21, v117
    v_mfma_f32_16x16x32_bf16 v[248:251], a[220:223], v[104:107], v[248:251]
    s_nop 0
    buffer_load_dwordx4 v14, s[12:15], s45 offen offset:1536 nt lds
    v_accvgpr_read_b32 v122, a90
    v_mfma_f32_16x16x32_bf16 v[48:51], a[192:195], a[128:131], v[40:43]
    s_waitcnt lgkmcnt(3)
    ds_read_b128 a[216:219], v33 offset:192
    ds_read_b128 a[220:223], v33 offset:704
    s_waitcnt vmcnt(8)
    v_mfma_f32_16x16x32_bf16 v[56:59], a[192:195], a[132:135], v[44:47]
    s_barrier
    v_mfma_f32_16x16x32_bf16 v[60:63], a[196:199], a[132:135], v[44:47]
    v_accvgpr_read_b32 v123, a91
    v_exp_f32 v120, v120
    v_mfma_f32_16x16x32_bf16 v[52:55], a[196:199], a[128:131], v[40:43]
    v_exp_f32 v121, v121
    v_mfma_f32_16x16x32_bf16 v[48:51], a[200:203], a[136:139], v[48:51]
    s_waitcnt lgkmcnt(3)
    ds_read_b128 a[192:195], v33 offset:256
    ds_read_b128 a[196:199], v33 offset:768
    v_mfma_f32_16x16x32_bf16 v[56:59], a[200:203], a[140:143], v[56:59]
    v_add_f32 v21, v21, v118
    v_cvt_pk_bf16_f32 v99, v118, v119
    v_mfma_f32_16x16x32_bf16 v[60:63], a[204:207], a[140:143], v[60:63]
    s_add_u32 m0, s38, 33792
    v_add_f32 v21, v21, v119
    v_accvgpr_read_b32 v124, a92
    v_accvgpr_read_b32 v125, a93
    v_mfma_f32_16x16x32_bf16 v[52:55], a[204:207], a[136:139], v[52:55]
    s_mov_b32 s45, 98304
    buffer_load_dwordx4 v19, s[16:19], s45 offen nt lds
    v_mfma_f32_16x16x32_bf16 v[48:51], a[208:211], a[144:147], v[48:51]
    s_waitcnt lgkmcnt(3)
    ds_read_b128 a[200:203], v33 offset:320
    ds_read_b128 a[204:207], v33 offset:832
    v_mfma_f32_16x16x32_bf16 v[56:59], a[208:211], a[148:151], v[56:59]
    v_exp_f32 v122, v122
    v_mfma_f32_16x16x32_bf16 v[60:63], a[212:215], a[148:151], v[60:63]
    v_exp_f32 v123, v123
    v_add_f32 v22, v24, v120
    v_mfma_f32_16x16x32_bf16 v[52:55], a[212:215], a[144:147], v[52:55]
    v_cvt_pk_bf16_f32 v100, v120, v121
    v_add_f32 v22, v22, v121
    v_accvgpr_read_b32 v126, a94
    v_mfma_f32_16x16x32_bf16 v[48:51], a[216:219], a[152:155], v[48:51]
    s_waitcnt lgkmcnt(3)
    ds_read_b128 a[208:211], v33 offset:384
    ds_read_b128 a[212:215], v33 offset:896
    v_mfma_f32_16x16x32_bf16 v[56:59], a[216:219], a[156:159], v[56:59]
    s_nop 0
    buffer_load_dword v37, v36, s[20:23], s49 offen offset:512
    v_mfma_f32_16x16x32_bf16 v[60:63], a[220:223], a[156:159], v[60:63]
    s_add_u32 m0, s38, 34336
    v_accvgpr_read_b32 v127, a95
    v_mfma_f32_16x16x32_bf16 v[52:55], a[220:223], a[152:155], v[52:55]
    s_nop 0
    buffer_load_dwordx4 v19, s[16:19], s45 offen offset:512 nt lds
    v_mfma_f32_16x16x32_bf16 v[48:51], a[192:195], a[160:163], v[48:51]
    s_waitcnt lgkmcnt(3)
    ds_read_b128 a[216:219], v33 offset:448
    ds_read_b128 a[220:223], v33 offset:960
    v_mfma_f32_16x16x32_bf16 v[56:59], a[192:195], a[164:167], v[56:59]
    v_exp_f32 v124, v124
    v_exp_f32 v125, v125
    v_mfma_f32_16x16x32_bf16 v[60:63], a[196:199], a[164:167], v[60:63]
    v_add_f32 v22, v22, v122
    v_cvt_pk_bf16_f32 v101, v122, v123
    v_mfma_f32_16x16x32_bf16 v[52:55], a[196:199], a[160:163], v[52:55]
    v_add_f32 v22, v22, v123
    v_exp_f32 v126, v126
    v_mfma_f32_16x16x32_bf16 v[48:51], a[200:203], a[168:171], v[48:51]
    s_waitcnt lgkmcnt(3)
    ds_read_b64_tr_b16 a[192:193], v11 offset:16896
    ds_read_b64_tr_b16 a[194:195], v11 offset:17408
    v_mfma_f32_16x16x32_bf16 v[56:59], a[200:203], a[172:175], v[56:59]
    v_exp_f32 v127, v127
    v_mfma_f32_16x16x32_bf16 v[60:63], a[204:207], a[172:175], v[60:63]
    s_add_u32 m0, s38, 34880
    ds_read_b64_tr_b16 a[196:197], v11 offset:16928
    ds_read_b64_tr_b16 a[198:199], v11 offset:17440
    v_mfma_f32_16x16x32_bf16 v[52:55], a[204:207], a[168:171], v[52:55]
    s_nop 0
    buffer_load_dwordx4 v19, s[16:19], s45 offen offset:1024 nt lds
    v_add_f32 v22, v22, v124
    v_mfma_f32_16x16x32_bf16 v[48:51], a[208:211], a[176:179], v[48:51]
    s_waitcnt lgkmcnt(5)
    ds_read_b64_tr_b16 a[200:201], v11 offset:16960
    ds_read_b64_tr_b16 a[202:203], v11 offset:17472
    v_mfma_f32_16x16x32_bf16 v[56:59], a[208:211], a[180:183], v[56:59]
    v_cvt_pk_bf16_f32 v102, v124, v125
    v_add_f32 v22, v22, v125
    v_mfma_f32_16x16x32_bf16 v[60:63], a[212:215], a[180:183], v[60:63]
    s_nop 0
    ds_read_b64_tr_b16 a[204:205], v11 offset:16992
    ds_read_b64_tr_b16 a[206:207], v11 offset:17504
    v_mfma_f32_16x16x32_bf16 v[52:55], a[212:215], a[176:179], v[52:55]
    v_add_f32 v22, v22, v126
    v_cvt_pk_bf16_f32 v103, v126, v127
    v_add_f32 v22, v22, v127
    v_mfma_f32_16x16x32_bf16 v[48:51], a[216:219], a[184:187], v[48:51]
    s_waitcnt lgkmcnt(6)
    ds_read_b64_tr_b16 a[208:209], v11 offset:17024
    ds_read_b64_tr_b16 a[210:211], v11 offset:17536
    v_mfma_f32_16x16x32_bf16 v[56:59], a[216:219], a[188:191], v[56:59]
    v_max_f32 v30, v21, v22
    v_cmp_nge_f32 vcc, s35, v30
    v_mfma_f32_16x16x32_bf16 v[60:63], a[220:223], a[188:191], v[60:63]
    s_add_u32 m0, s38, 35424
    ds_read_b64_tr_b16 a[212:213], v11 offset:17056
    ds_read_b64_tr_b16 a[214:215], v11 offset:17568
    v_mfma_f32_16x16x32_bf16 v[52:55], a[220:223], a[184:187], v[52:55]
    s_nop 0
    buffer_load_dwordx4 v19, s[16:19], s45 offen offset:1536 nt lds
    s_cbranch_vccnz T_c10
B_c10:
    v_mfma_f32_16x16x32_bf16 v[128:131], a[192:195], v[96:99], v[128:131]
    s_waitcnt lgkmcnt(6)
    ds_read_b64_tr_b16 a[216:217], v11 offset:17088
    ds_read_b64_tr_b16 a[218:219], v11 offset:17600
    s_waitcnt vmcnt(9)
    v_mfma_f32_16x16x32_bf16 v[132:135], a[192:195], v[100:103], v[132:135]
    s_barrier
    v_mfma_f32_16x16x32_bf16 v[140:143], a[196:199], v[100:103], v[140:143]
    s_nop 0
    ds_read_b64_tr_b16 a[220:221], v11 offset:17120
    ds_read_b64_tr_b16 a[222:223], v11 offset:17632
    v_mfma_f32_16x16x32_bf16 v[136:139], a[196:199], v[96:99], v[136:139]
    v_exp_f32 v112, v48
    v_exp_f32 v113, v49
    v_mfma_f32_16x16x32_bf16 v[144:147], a[200:203], v[96:99], v[144:147]
    s_waitcnt lgkmcnt(6)
    ds_read_b64_tr_b16 a[192:193], v11 offset:17152
    ds_read_b64_tr_b16 a[194:195], v11 offset:17664
    v_mfma_f32_16x16x32_bf16 v[148:151], a[200:203], v[100:103], v[148:151]
    v_exp_f32 v114, v50
    v_exp_f32 v115, v51
    v_add_f32 v23, v21, v112
    v_cvt_pk_bf16_f32 v104, v112, v113
    v_mfma_f32_16x16x32_bf16 v[156:159], a[204:207], v[100:103], v[156:159]
    s_add_u32 m0, s38, 50688
    ds_read_b64_tr_b16 a[196:197], v11 offset:17184
    ds_read_b64_tr_b16 a[198:199], v11 offset:17696
    v_mfma_f32_16x16x32_bf16 v[152:155], a[204:207], v[96:99], v[152:155]
    s_mov_b32 s45, 229376
    buffer_load_dwordx4 v19, s[16:19], s45 offen nt lds
    v_add_f32 v23, v23, v113
    v_mfma_f32_16x16x32_bf16 v[160:163], a[208:211], v[96:99], v[160:163]
    s_waitcnt lgkmcnt(6)
    ds_read_b64_tr_b16 a[200:201], v11 offset:17216
    ds_read_b64_tr_b16 a[202:203], v11 offset:17728
    v_mfma_f32_16x16x32_bf16 v[164:167], a[208:211], v[100:103], v[164:167]
    v_exp_f32 v116, v52
    v_exp_f32 v117, v53
    v_add_f32 v23, v23, v114
    v_mfma_f32_16x16x32_bf16 v[172:175], a[212:215], v[100:103], v[172:175]
    s_nop 0
    ds_read_b64_tr_b16 a[204:205], v11 offset:17248
    ds_read_b64_tr_b16 a[206:207], v11 offset:17760
    v_mfma_f32_16x16x32_bf16 v[168:171], a[212:215], v[96:99], v[168:171]
    v_cvt_pk_bf16_f32 v105, v114, v115
    v_add_f32 v23, v23, v115
    v_exp_f32 v118, v54
    v_mfma_f32_16x16x32_bf16 v[176:179], a[216:219], v[96:99], v[176:179]
    s_waitcnt lgkmcnt(6)
    ds_read_b64_tr_b16 a[208:209], v11 offset:17280
    ds_read_b64_tr_b16 a[210:211], v11 offset:17792
    v_mfma_f32_16x16x32_bf16 v[180:183], a[216:219], v[100:103], v[180:183]
    v_exp_f32 v119, v55
    v_add_f32 v23, v23, v116
    v_cvt_pk_bf16_f32 v106, v116, v117
    v_add_f32 v23, v23, v117
    v_mfma_f32_16x16x32_bf16 v[188:191], a[220:223], v[100:103], v[188:191]
    s_add_u32 m0, s38, 51232
    ds_read_b64_tr_b16 a[212:213], v11 offset:17312
    ds_read_b64_tr_b16 a[214:215], v11 offset:17824
    v_mfma_f32_16x16x32_bf16 v[184:187], a[220:223], v[96:99], v[184:187]
    s_nop 0
    buffer_load_dwordx4 v19, s[16:19], s45 offen offset:512 nt lds
    v_mfma_f32_16x16x32_bf16 v[192:195], a[192:195], v[96:99], v[192:195]
    s_waitcnt lgkmcnt(6)
    ds_read_b64_tr_b16 a[216:217], v11 offset:17344
    ds_read_b64_tr_b16 a[218:219], v11 offset:17856
    v_mfma_f32_16x16x32_bf16 v[196:199], a[192:195], v[100:103], v[196:199]
    v_exp_f32 v120, v56
    v_exp_f32 v121, v57
    v_add_f32 v23, v23, v118
    v_cvt_pk_bf16_f32 v107, v118, v119
    v_add_f32 v23, v23, v119
    v_mfma_f32_16x16x32_bf16 v[204:207], a[196:199], v[100:103], v[204:207]
    s_nop 0
    ds_read_b64_tr_b16 a[220:221], v11 offset:17376
    ds_read_b64_tr_b16 a[222:223], v11 offset:17888
    v_mfma_f32_16x16x32_bf16 v[200:203], a[196:199], v[96:99], v[200:203]
    v_exp_f32 v122, v58
    v_exp_f32 v123, v59
    v_add_f32 v24, v22, v120
    v_mfma_f32_16x16x32_bf16 v[208:211], a[200:203], v[96:99], v[208:211]
    s_waitcnt lgkmcnt(6)
    ds_read_b64_tr_b16 a[192:193], v11 offset:33792
    ds_read_b64_tr_b16 a[194:195], v11 offset:34304
    v_mfma_f32_16x16x32_bf16 v[212:215], a[200:203], v[100:103], v[212:215]
    v_cvt_pk_bf16_f32 v108, v120, v121
    v_add_f32 v24, v24, v121
    v_exp_f32 v124, v60
    v_mfma_f32_16x16x32_bf16 v[220:223], a[204:207], v[100:103], v[220:223]
    s_add_u32 m0, s38, 51776
    ds_read_b64_tr_b16 a[196:197], v11 offset:33824
    ds_read_b64_tr_b16 a[198:199], v11 offset:34336
    v_mfma_f32_16x16x32_bf16 v[216:219], a[204:207], v[96:99], v[216:219]
    s_nop 0
    buffer_load_dwordx4 v19, s[16:19], s45 offen offset:1024 nt lds
    v_mfma_f32_16x16x32_bf16 v[224:227], a[208:211], v[96:99], v[224:227]
    s_waitcnt lgkmcnt(6)
    ds_read_b64_tr_b16 a[200:201], v11 offset:33856
    ds_read_b64_tr_b16 a[202:203], v11 offset:34368
    v_mfma_f32_16x16x32_bf16 v[228:231], a[208:211], v[100:103], v[228:231]
    v_exp_f32 v125, v61
    v_add_f32 v24, v24, v122
    v_cvt_pk_bf16_f32 v109, v122, v123
    v_add_f32 v24, v24, v123
    v_exp_f32 v126, v62
    v_mfma_f32_16x16x32_bf16 v[236:239], a[212:215], v[100:103], v[236:239]
    s_nop 0
    ds_read_b64_tr_b16 a[204:205], v11 offset:33888
    ds_read_b64_tr_b16 a[206:207], v11 offset:34400
    v_mfma_f32_16x16x32_bf16 v[232:235], a[212:215], v[96:99], v[232:235]
    v_exp_f32 v127, v63
    v_add_f32 v24, v24, v124
    v_cvt_pk_bf16_f32 v110, v124, v125
    v_add_f32 v24, v24, v125
    v_mfma_f32_16x16x32_bf16 v[240:243], a[216:219], v[96:99], v[240:243]
    s_waitcnt lgkmcnt(6)
    ds_read_b64_tr_b16 a[208:209], v11 offset:33920
    ds_read_b64_tr_b16 a[210:211], v11 offset:34432
    v_mfma_f32_16x16x32_bf16 v[244:247], a[216:219], v[100:103], v[244:247]
    v_add_f32 v24, v24, v126
    v_cvt_pk_bf16_f32 v111, v126, v127
    v_add_f32 v24, v24, v127
    v_max_f32 v30, v23, v24
    v_cmp_nge_f32 vcc, s35, v30
    v_mfma_f32_16x16x32_bf16 v[252:255], a[220:223], v[100:103], v[252:255]
    s_add_u32 m0, s38, 52320
    ds_read_b64_tr_b16 a[212:213], v11 offset:33952
    ds_read_b64_tr_b16 a[214:215], v11 offset:34464
    v_mfma_f32_16x16x32_bf16 v[248:251], a[220:223], v[96:99], v[248:251]
    s_nop 0
    buffer_load_dwordx4 v19, s[16:19], s45 offen offset:1536 nt lds
    s_cbranch_vccnz T_c11
B_c11:
    v_mfma_f32_16x16x32_bf16 v[128:131], a[192:195], v[104:107], v[128:131]
    s_waitcnt lgkmcnt(6)
    ds_read_b64_tr_b16 a[216:217], v11 offset:33984
    ds_read_b64_tr_b16 a[218:219], v11 offset:34496
    s_waitcnt vmcnt(9)
    v_mfma_f32_16x16x32_bf16 v[132:135], a[192:195], v[108:111], v[132:135]
    s_barrier
    v_mfma_f32_16x16x32_bf16 v[140:143], a[196:199], v[108:111], v[140:143]
    s_nop 0
    ds_read_b64_tr_b16 a[220:221], v11 offset:34016
    ds_read_b64_tr_b16 a[222:223], v11 offset:34528
    v_mfma_f32_16x16x32_bf16 v[136:139], a[196:199], v[104:107], v[136:139]
    v_accvgpr_read_b32 v112, a96
    v_accvgpr_read_b32 v113, a97
    v_mfma_f32_16x16x32_bf16 v[144:147], a[200:203], v[104:107], v[144:147]
    s_waitcnt lgkmcnt(6)
    ds_read_b64_tr_b16 a[192:193], v11 offset:34048
    ds_read_b64_tr_b16 a[194:195], v11 offset:34560
    v_mfma_f32_16x16x32_bf16 v[148:151], a[200:203], v[108:111], v[148:151]
    v_accvgpr_read_b32 v114, a98
    v_accvgpr_read_b32 v115, a99
    v_mfma_f32_16x16x32_bf16 v[156:159], a[204:207], v[108:111], v[156:159]
    s_add_u32 m0, s38, 67584
    ds_read_b64_tr_b16 a[196:197], v11 offset:34080
    ds_read_b64_tr_b16 a[198:199], v11 offset:34592
    v_mfma_f32_16x16x32_bf16 v[152:155], a[204:207], v[104:107], v[152:155]
    s_mov_b32 s45, 245760
    buffer_load_dwordx4 v14, s[12:15], s45 offen nt lds
    v_mfma_f32_16x16x32_bf16 v[160:163], a[208:211], v[104:107], v[160:163]
    s_waitcnt lgkmcnt(6)
    ds_read_b64_tr_b16 a[200:201], v11 offset:34112
    ds_read_b64_tr_b16 a[202:203], v11 offset:34624
    v_mfma_f32_16x16x32_bf16 v[164:167], a[208:211], v[108:111], v[164:167]
    v_exp_f32 v112, v112
    v_exp_f32 v113, v113
    v_mfma_f32_16x16x32_bf16 v[172:175], a[212:215], v[108:111], v[172:175]
    s_nop 0
    ds_read_b64_tr_b16 a[204:205], v11 offset:34144
    ds_read_b64_tr_b16 a[206:207], v11 offset:34656
    v_mfma_f32_16x16x32_bf16 v[168:171], a[212:215], v[104:107], v[168:171]
    v_accvgpr_read_b32 v116, a100
    v_accvgpr_read_b32 v117, a101
    v_mfma_f32_16x16x32_bf16 v[176:179], a[216:219], v[104:107], v[176:179]
    s_waitcnt lgkmcnt(6)
    ds_read_b64_tr_b16 a[208:209], v11 offset:34176
    ds_read_b64_tr_b16 a[210:211], v11 offset:34688
    v_mfma_f32_16x16x32_bf16 v[180:183], a[216:219], v[108:111], v[180:183]
    v_exp_f32 v114, v114
    v_mfma_f32_16x16x32_bf16 v[188:191], a[220:223], v[108:111], v[188:191]
    s_add_u32 m0, s38, 68128
    ds_read_b64_tr_b16 a[212:213], v11 offset:34208
    ds_read_b64_tr_b16 a[214:215], v11 offset:34720
    v_mfma_f32_16x16x32_bf16 v[184:187], a[220:223], v[104:107], v[184:187]
    s_nop 0
    buffer_load_dwordx4 v14, s[12:15], s45 offen offset:512 nt lds
    v_mfma_f32_16x16x32_bf16 v[192:195], a[192:195], v[104:107], v[192:195]
    s_waitcnt lgkmcnt(6)
    ds_read_b64_tr_b16 a[216:217], v11 offset:34240
    ds_read_b64_tr_b16 a[218:219], v11 offset:34752
    v_mfma_f32_16x16x32_bf16 v[196:199], a[192:195], v[108:111], v[196:199]
    v_exp_f32 v115, v115
    v_add_f32 v21, v23, v112
    v_cvt_pk_bf16_f32 v96, v112, v113
    v_mfma_f32_16x16x32_bf16 v[204:207], a[196:199], v[108:111], v[204:207]
    s_nop 0
    ds_read_b64_tr_b16 a[220:221], v11 offset:34272
    ds_read_b64_tr_b16 a[222:223], v11 offset:34784
    v_mfma_f32_16x16x32_bf16 v[200:203], a[196:199], v[104:107], v[200:203]
    v_add_f32 v21, v21, v113
    v_accvgpr_read_b32 v118, a102
    v_mfma_f32_16x16x32_bf16 v[208:211], a[200:203], v[104:107], v[208:211]
    s_waitcnt lgkmcnt(6)
    ds_read_b128 a[192:195], v32 offset:0
    ds_read_b128 a[196:199], v32 offset:512
    v_mfma_f32_16x16x32_bf16 v[212:215], a[200:203], v[108:111], v[212:215]
    v_accvgpr_read_b32 v119, a103
    v_exp_f32 v116, v116
    v_mfma_f32_16x16x32_bf16 v[220:223], a[204:207], v[108:111], v[220:223]
    s_add_u32 m0, s38, 68672
    v_exp_f32 v117, v117
    v_mfma_f32_16x16x32_bf16 v[216:219], a[204:207], v[104:107], v[216:219]
    s_nop 0
    buffer_load_dwordx4 v14, s[12:15], s45 offen offset:1024 nt lds
    v_add_f32 v21, v21, v114
    v_mfma_f32_16x16x32_bf16 v[224:227], a[208:211], v[104:107], v[224:227]
    s_waitcnt lgkmcnt(4)
    ds_read_b128 a[200:203], v32 offset:64
    ds_read_b128 a[204:207], v32 offset:576
    v_mfma_f32_16x16x32_bf16 v[228:231], a[208:211], v[108:111], v[228:231]
    v_cvt_pk_bf16_f32 v97, v114, v115
    v_add_f32 v21, v21, v115
    v_mfma_f32_16x16x32_bf16 v[236:239], a[212:215], v[108:111], v[236:239]
    v_accvgpr_read_b32 v120, a104
    v_accvgpr_read_b32 v121, a105
    v_mfma_f32_16x16x32_bf16 v[232:235], a[212:215], v[104:107], v[232:235]
    v_exp_f32 v118, v118
    v_mfma_f32_16x16x32_bf16 v[240:243], a[216:219], v[104:107], v[240:243]
    s_waitcnt lgkmcnt(3)
    ds_read_b128 a[208:211], v32 offset:128
    ds_read_b128 a[212:215], v32 offset:640
    v_mfma_f32_16x16x32_bf16 v[244:247], a[216:219], v[108:111], v[244:247]
    v_exp_f32 v119, v119
    v_add_f32 v21, v21, v116
    v_mfma_f32_16x16x32_bf16 v[252:255], a[220:223], v[108:111], v[252:255]
    s_add_u32 m0, s38, 69216
    v_cvt_pk_bf16_f32 v98, v116, v117
    v_add_f32 v21, v21, v117
    v_mfma_f32_16x16x32_bf16 v[248:251], a[220:223], v[104:107], v[248:251]
    s_nop 0
    buffer_load_dwordx4 v14, s[12:15], s45 offen offset:1536 nt lds
    v_accvgpr_read_b32 v122, a106
    v_mfma_f32_16x16x32_bf16 v[48:51], a[192:195], a[128:131], v[40:43]
    s_waitcnt lgkmcnt(3)
    ds_read_b128 a[216:219], v32 offset:192
    ds_read_b128 a[220:223], v32 offset:704
    s_waitcnt vmcnt(8)
    v_mfma_f32_16x16x32_bf16 v[56:59], a[192:195], a[132:135], v[44:47]
    s_barrier
    v_mfma_f32_16x16x32_bf16 v[60:63], a[196:199], a[132:135], v[44:47]
    v_accvgpr_read_b32 v123, a107
    v_exp_f32 v120, v120
    v_mfma_f32_16x16x32_bf16 v[52:55], a[196:199], a[128:131], v[40:43]
    v_exp_f32 v121, v121
    v_mfma_f32_16x16x32_bf16 v[48:51], a[200:203], a[136:139], v[48:51]
    s_waitcnt lgkmcnt(3)
    ds_read_b128 a[192:195], v32 offset:256
    ds_read_b128 a[196:199], v32 offset:768
    v_mfma_f32_16x16x32_bf16 v[56:59], a[200:203], a[140:143], v[56:59]
    v_add_f32 v21, v21, v118
    v_cvt_pk_bf16_f32 v99, v118, v119
    v_mfma_f32_16x16x32_bf16 v[60:63], a[204:207], a[140:143], v[60:63]
    s_add_u32 m0, s38, 84480
    v_add_f32 v21, v21, v119
    v_accvgpr_read_b32 v124, a108
    v_accvgpr_read_b32 v125, a109
    v_mfma_f32_16x16x32_bf16 v[52:55], a[204:207], a[136:139], v[52:55]
    s_mov_b32 s45, 114688
    buffer_load_dwordx4 v19, s[16:19], s45 offen nt lds
    v_mfma_f32_16x16x32_bf16 v[48:51], a[208:211], a[144:147], v[48:51]
    s_waitcnt lgkmcnt(3)
    ds_read_b128 a[200:203], v32 offset:320
    ds_read_b128 a[204:207], v32 offset:832
    v_mfma_f32_16x16x32_bf16 v[56:59], a[208:211], a[148:151], v[56:59]
    v_exp_f32 v122, v122
    v_mfma_f32_16x16x32_bf16 v[60:63], a[212:215], a[148:151], v[60:63]
    v_exp_f32 v123, v123
    v_add_f32 v22, v24, v120
    v_mfma_f32_16x16x32_bf16 v[52:55], a[212:215], a[144:147], v[52:55]
    v_cvt_pk_bf16_f32 v100, v120, v121
    v_add_f32 v22, v22, v121
    v_accvgpr_read_b32 v126, a110
    v_mfma_f32_16x16x32_bf16 v[48:51], a[216:219], a[152:155], v[48:51]
    s_waitcnt lgkmcnt(3)
    ds_read_b128 a[208:211], v32 offset:384
    ds_read_b128 a[212:215], v32 offset:896
    v_mfma_f32_16x16x32_bf16 v[56:59], a[216:219], a[156:159], v[56:59]
    s_nop 0
    buffer_load_dword v37, v36, s[20:23], s49 offen offset:640
    v_mfma_f32_16x16x32_bf16 v[60:63], a[220:223], a[156:159], v[60:63]
    s_add_u32 m0, s38, 85024
    v_accvgpr_read_b32 v127, a111
    v_mfma_f32_16x16x32_bf16 v[52:55], a[220:223], a[152:155], v[52:55]
    s_nop 0
    buffer_load_dwordx4 v19, s[16:19], s45 offen offset:512 nt lds
    v_mfma_f32_16x16x32_bf16 v[48:51], a[192:195], a[160:163], v[48:51]
    s_waitcnt lgkmcnt(3)
    ds_read_b128 a[216:219], v32 offset:448
    ds_read_b128 a[220:223], v32 offset:960
    v_mfma_f32_16x16x32_bf16 v[56:59], a[192:195], a[164:167], v[56:59]
    v_exp_f32 v124, v124
    v_exp_f32 v125, v125
    v_mfma_f32_16x16x32_bf16 v[60:63], a[196:199], a[164:167], v[60:63]
    v_add_f32 v22, v22, v122
    v_cvt_pk_bf16_f32 v101, v122, v123
    v_mfma_f32_16x16x32_bf16 v[52:55], a[196:199], a[160:163], v[52:55]
    v_add_f32 v22, v22, v123
    v_exp_f32 v126, v126
    v_mfma_f32_16x16x32_bf16 v[48:51], a[200:203], a[168:171], v[48:51]
    s_waitcnt lgkmcnt(3)
    ds_read_b64_tr_b16 a[192:193], v10 offset:33792
    ds_read_b64_tr_b16 a[194:195], v10 offset:34304
    v_mfma_f32_16x16x32_bf16 v[56:59], a[200:203], a[172:175], v[56:59]
    v_exp_f32 v127, v127
    v_mfma_f32_16x16x32_bf16 v[60:63], a[204:207], a[172:175], v[60:63]
    s_add_u32 m0, s38, 85568
    ds_read_b64_tr_b16 a[196:197], v10 offset:33824
    ds_read_b64_tr_b16 a[198:199], v10 offset:34336
    v_mfma_f32_16x16x32_bf16 v[52:55], a[204:207], a[168:171], v[52:55]
    s_nop 0
    buffer_load_dwordx4 v19, s[16:19], s45 offen offset:1024 nt lds
    v_add_f32 v22, v22, v124
    v_mfma_f32_16x16x32_bf16 v[48:51], a[208:211], a[176:179], v[48:51]
    s_waitcnt lgkmcnt(5)
    ds_read_b64_tr_b16 a[200:201], v10 offset:33856
    ds_read_b64_tr_b16 a[202:203], v10 offset:34368
    v_mfma_f32_16x16x32_bf16 v[56:59], a[208:211], a[180:183], v[56:59]
    v_cvt_pk_bf16_f32 v102, v124, v125
    v_add_f32 v22, v22, v125
    v_mfma_f32_16x16x32_bf16 v[60:63], a[212:215], a[180:183], v[60:63]
    s_nop 0
    ds_read_b64_tr_b16 a[204:205], v10 offset:33888
    ds_read_b64_tr_b16 a[206:207], v10 offset:34400
    v_mfma_f32_16x16x32_bf16 v[52:55], a[212:215], a[176:179], v[52:55]
    v_add_f32 v22, v22, v126
    v_cvt_pk_bf16_f32 v103, v126, v127
    v_add_f32 v22, v22, v127
    v_mfma_f32_16x16x32_bf16 v[48:51], a[216:219], a[184:187], v[48:51]
    s_waitcnt lgkmcnt(6)
    ds_read_b64_tr_b16 a[208:209], v10 offset:33920
    ds_read_b64_tr_b16 a[210:211], v10 offset:34432
    v_mfma_f32_16x16x32_bf16 v[56:59], a[216:219], a[188:191], v[56:59]
    v_max_f32 v30, v21, v22
    v_cmp_nge_f32 vcc, s35, v30
    v_mfma_f32_16x16x32_bf16 v[60:63], a[220:223], a[188:191], v[60:63]
    s_add_u32 m0, s38, 86112
    ds_read_b64_tr_b16 a[212:213], v10 offset:33952
    ds_read_b64_tr_b16 a[214:215], v10 offset:34464
    v_mfma_f32_16x16x32_bf16 v[52:55], a[220:223], a[184:187], v[52:55]
    s_nop 0
    buffer_load_dwordx4 v19, s[16:19], s45 offen offset:1536 nt lds
    s_cbranch_vccnz T_c12
B_c12:
    v_mfma_f32_16x16x32_bf16 v[128:131], a[192:195], v[96:99], v[128:131]
    s_waitcnt lgkmcnt(6)
    ds_read_b64_tr_b16 a[216:217], v10 offset:33984
    ds_read_b64_tr_b16 a[218:219], v10 offset:34496
    s_waitcnt vmcnt(9)
    v_mfma_f32_16x16x32_bf16 v[132:135], a[192:195], v[100:103], v[132:135]
    s_barrier
    v_mfma_f32_16x16x32_bf16 v[140:143], a[196:199], v[100:103], v[140:143]
    s_nop 0
    ds_read_b64_tr_b16 a[220:221], v10 offset:34016
    ds_read_b64_tr_b16 a[222:223], v10 offset:34528
    v_mfma_f32_16x16x32_bf16 v[136:139], a[196:199], v[96:99], v[136:139]
    v_exp_f32 v112, v48
    v_exp_f32 v113, v49
    v_mfma_f32_16x16x32_bf16 v[144:147], a[200:203], v[96:99], v[144:147]
    s_waitcnt lgkmcnt(6)
    ds_read_b64_tr_b16 a[192:193], v10 offset:34048
    ds_read_b64_tr_b16 a[194:195], v10 offset:34560
    v_mfma_f32_16x16x32_bf16 v[148:151], a[200:203], v[100:103], v[148:151]
    v_exp_f32 v114, v50
    v_exp_f32 v115, v51
    v_add_f32 v23, v21, v112
    v_cvt_pk_bf16_f32 v104, v112, v113
    v_mfma_f32_16x16x32_bf16 v[156:159], a[204:207], v[100:103], v[156:159]
    s_add_u32 m0, s38, 0
    ds_read_b64_tr_b16 a[196:197], v10 offset:34080
    ds_read_b64_tr_b16 a[198:199], v10 offset:34592
    v_mfma_f32_16x16x32_bf16 v[152:155], a[204:207], v[96:99], v[152:155]
    s_mov_b32 s45, 245760
    buffer_load_dwordx4 v19, s[16:19], s45 offen nt lds
    v_add_f32 v23, v23, v113
    v_mfma_f32_16x16x32_bf16 v[160:163], a[208:211], v[96:99], v[160:163]
    s_waitcnt lgkmcnt(6)
    ds_read_b64_tr_b16 a[200:201], v10 offset:34112
    ds_read_b64_tr_b16 a[202:203], v10 offset:34624
    v_mfma_f32_16x16x32_bf16 v[164:167], a[208:211], v[100:103], v[164:167]
    v_exp_f32 v116, v52
    v_exp_f32 v117, v53
    v_add_f32 v23, v23, v114
    v_mfma_f32_16x16x32_bf16 v[172:175], a[212:215], v[100:103], v[172:175]
    s_nop 0
    ds_read_b64_tr_b16 a[204:205], v10 offset:34144
    ds_read_b64_tr_b16 a[206:207], v10 offset:34656
    v_mfma_f32_16x16x32_bf16 v[168:171], a[212:215], v[96:99], v[168:171]
    v_cvt_pk_bf16_f32 v105, v114, v115
    v_add_f32 v23, v23, v115
    v_exp_f32 v118, v54
    v_mfma_f32_16x16x32_bf16 v[176:179], a[216:219], v[96:99], v[176:179]
    s_waitcnt lgkmcnt(6)
    ds_read_b64_tr_b16 a[208:209], v10 offset:34176
    ds_read_b64_tr_b16 a[210:211], v10 offset:34688
    v_mfma_f32_16x16x32_bf16 v[180:183], a[216:219], v[100:103], v[180:183]
    v_exp_f32 v119, v55
    v_add_f32 v23, v23, v116
    v_cvt_pk_bf16_f32 v106, v116, v117
    v_add_f32 v23, v23, v117
    v_mfma_f32_16x16x32_bf16 v[188:191], a[220:223], v[100:103], v[188:191]
    s_add_u32 m0, s38, 544
    ds_read_b64_tr_b16 a[212:213], v10 offset:34208
    ds_read_b64_tr_b16 a[214:215], v10 offset:34720
    v_mfma_f32_16x16x32_bf16 v[184:187], a[220:223], v[96:99], v[184:187]
    s_nop 0
    buffer_load_dwordx4 v19, s[16:19], s45 offen offset:512 nt lds
    v_mfma_f32_16x16x32_bf16 v[192:195], a[192:195], v[96:99], v[192:195]
    s_waitcnt lgkmcnt(6)
    ds_read_b64_tr_b16 a[216:217], v10 offset:34240
    ds_read_b64_tr_b16 a[218:219], v10 offset:34752
    v_mfma_f32_16x16x32_bf16 v[196:199], a[192:195], v[100:103], v[196:199]
    v_exp_f32 v120, v56
    v_exp_f32 v121, v57
    v_add_f32 v23, v23, v118
    v_cvt_pk_bf16_f32 v107, v118, v119
    v_add_f32 v23, v23, v119
    v_mfma_f32_16x16x32_bf16 v[204:207], a[196:199], v[100:103], v[204:207]
    s_nop 0
    ds_read_b64_tr_b16 a[220:221], v10 offset:34272
    ds_read_b64_tr_b16 a[222:223], v10 offset:34784
    v_mfma_f32_16x16x32_bf16 v[200:203], a[196:199], v[96:99], v[200:203]
    v_exp_f32 v122, v58
    v_exp_f32 v123, v59
    v_add_f32 v24, v22, v120
    v_mfma_f32_16x16x32_bf16 v[208:211], a[200:203], v[96:99], v[208:211]
    s_waitcnt lgkmcnt(6)
    ds_read_b64_tr_b16 a[192:193], v11 offset:0
    ds_read_b64_tr_b16 a[194:195], v11 offset:512
    v_mfma_f32_16x16x32_bf16 v[212:215], a[200:203], v[100:103], v[212:215]
    v_cvt_pk_bf16_f32 v108, v120, v121
    v_add_f32 v24, v24, v121
    v_exp_f32 v124, v60
    v_mfma_f32_16x16x32_bf16 v[220:223], a[204:207], v[100:103], v[220:223]
    s_add_u32 m0, s38, 1088
    ds_read_b64_tr_b16 a[196:197], v11 offset:32
    ds_read_b64_tr_b16 a[198:199], v11 offset:544
    v_mfma_f32_16x16x32_bf16 v[216:219], a[204:207], v[96:99], v[216:219]
    s_nop 0
    buffer_load_dwordx4 v19, s[16:19], s45 offen offset:1024 nt lds
    v_mfma_f32_16x16x32_bf16 v[224:227], a[208:211], v[96:99], v[224:227]
    s_waitcnt lgkmcnt(6)
    ds_read_b64_tr_b16 a[200:201], v11 offset:64
    ds_read_b64_tr_b16 a[202:203], v11 offset:576
    v_mfma_f32_16x16x32_bf16 v[228:231], a[208:211], v[100:103], v[228:231]
    v_exp_f32 v125, v61
    v_add_f32 v24, v24, v122
    v_cvt_pk_bf16_f32 v109, v122, v123
    v_add_f32 v24, v24, v123
    v_exp_f32 v126, v62
    v_mfma_f32_16x16x32_bf16 v[236:239], a[212:215], v[100:103], v[236:239]
    s_nop 0
    ds_read_b64_tr_b16 a[204:205], v11 offset:96
    ds_read_b64_tr_b16 a[206:207], v11 offset:608
    v_mfma_f32_16x16x32_bf16 v[232:235], a[212:215], v[96:99], v[232:235]
    v_exp_f32 v127, v63
    v_add_f32 v24, v24, v124
    v_cvt_pk_bf16_f32 v110, v124, v125
    v_add_f32 v24, v24, v125
    v_mfma_f32_16x16x32_bf16 v[240:243], a[216:219], v[96:99], v[240:243]
    s_waitcnt lgkmcnt(6)
    ds_read_b64_tr_b16 a[208:209], v11 offset:128
    ds_read_b64_tr_b16 a[210:211], v11 offset:640
    v_mfma_f32_16x16x32_bf16 v[244:247], a[216:219], v[100:103], v[244:247]
    v_add_f32 v24, v24, v126
    v_cvt_pk_bf16_f32 v111, v126, v127
    v_add_f32 v24, v24, v127
    v_max_f32 v30, v23, v24
    v_cmp_nge_f32 vcc, s35, v30
    v_mfma_f32_16x16x32_bf16 v[252:255], a[220:223], v[100:103], v[252:255]
    s_add_u32 m0, s38, 1632
    ds_read_b64_tr_b16 a[212:213], v11 offset:160
    ds_read_b64_tr_b16 a[214:215], v11 offset:672
    v_mfma_f32_16x16x32_bf16 v[248:251], a[220:223], v[96:99], v[248:251]
    s_nop 0
    buffer_load_dwordx4 v19, s[16:19], s45 offen offset:1536 nt lds
    s_cbranch_vccnz T_c13
B_c13:
    s_waitcnt vmcnt(52)
    v_cmp_gt_u32 vcc, 16, v95
    s_cbranch_vccnz T_rdy
B_rdy:
    v_mfma_f32_16x16x32_bf16 v[128:131], a[192:195], v[104:107], v[128:131]
    s_waitcnt lgkmcnt(6)
    ds_read_b64_tr_b16 a[216:217], v11 offset:192
    ds_read_b64_tr_b16 a[218:219], v11 offset:704
    s_waitcnt vmcnt(9)
    v_mfma_f32_16x16x32_bf16 v[132:135], a[192:195], v[108:111], v[132:135]
    s_barrier
    v_mfma_f32_16x16x32_bf16 v[140:143], a[196:199], v[108:111], v[140:143]
    s_nop 0
    ds_read_b64_tr_b16 a[220:221], v11 offset:224
    ds_read_b64_tr_b16 a[222:223], v11 offset:736
    v_mfma_f32_16x16x32_bf16 v[136:139], a[196:199], v[104:107], v[136:139]
    v_accvgpr_read_b32 v112, a112
    v_accvgpr_read_b32 v113, a113
    v_mfma_f32_16x16x32_bf16 v[144:147], a[200:203], v[104:107], v[144:147]
    s_waitcnt lgkmcnt(6)
    ds_read_b64_tr_b16 a[192:193], v11 offset:256
    ds_read_b64_tr_b16 a[194:195], v11 offset:768
    v_mfma_f32_16x16x32_bf16 v[148:151], a[200:203], v[108:111], v[148:151]
    v_accvgpr_read_b32 v114, a114
    v_accvgpr_read_b32 v115, a115
    v_mfma_f32_16x16x32_bf16 v[156:159], a[204:207], v[108:111], v[156:159]
    s_add_u32 m0, s38, 33792
    ds_read_b64_tr_b16 a[196:197], v11 offset:288
    ds_read_b64_tr_b16 a[198:199], v11 offset:800
    v_mfma_f32_16x16x32_bf16 v[152:155], a[204:207], v[104:107], v[152:155]
    s_mov_b32 s45, 256
    buffer_load_dwordx4 v20, s[20:23], s45 offen lds
    v_mfma_f32_16x16x32_bf16 v[160:163], a[208:211], v[104:107], v[160:163]
    s_waitcnt lgkmcnt(6)
    ds_read_b64_tr_b16 a[200:201], v11 offset:320
    ds_read_b64_tr_b16 a[202:203], v11 offset:832
    v_mfma_f32_16x16x32_bf16 v[164:167], a[208:211], v[108:111], v[164:167]
    v_exp_f32 v112, v112
    v_exp_f32 v113, v113
    v_mfma_f32_16x16x32_bf16 v[172:175], a[212:215], v[108:111], v[172:175]
    s_nop 0
    ds_read_b64_tr_b16 a[204:205], v11 offset:352
    ds_read_b64_tr_b16 a[206:207], v11 offset:864
    v_mfma_f32_16x16x32_bf16 v[168:171], a[212:215], v[104:107], v[168:171]
    v_accvgpr_read_b32 v116, a116
    v_accvgpr_read_b32 v117, a117
    v_mfma_f32_16x16x32_bf16 v[176:179], a[216:219], v[104:107], v[176:179]
    s_waitcnt lgkmcnt(6)
    ds_read_b64_tr_b16 a[208:209], v11 offset:384
    ds_read_b64_tr_b16 a[210:211], v11 offset:896
    v_mfma_f32_16x16x32_bf16 v[180:183], a[216:219], v[108:111], v[180:183]
    s_nop 0
    buffer_load_dword v37, v36, s[20:23], s49 offen offset:768
    v_mfma_f32_16x16x32_bf16 v[188:191], a[220:223], v[108:111], v[188:191]
    s_add_u32 m0, s38, 34848
    ds_read_b64_tr_b16 a[212:213], v11 offset:416
    ds_read_b64_tr_b16 a[214:215], v11 offset:928
    v_mfma_f32_16x16x32_bf16 v[184:187], a[220:223], v[104:107], v[184:187]
    s_mov_b32 s45, 7424
    buffer_load_dwordx4 v20, s[20:23], s45 offen lds
    v_mfma_f32_16x16x32_bf16 v[192:195], a[192:195], v[104:107], v[192:195]
    s_waitcnt lgkmcnt(6)
    ds_read_b64_tr_b16 a[216:217], v11 offset:448
    ds_read_b64_tr_b16 a[218:219], v11 offset:960
    v_mfma_f32_16x16x32_bf16 v[196:199], a[192:195], v[108:111], v[196:199]
    v_exp_f32 v114, v114
    v_exp_f32 v115, v115
    v_mfma_f32_16x16x32_bf16 v[204:207], a[196:199], v[108:111], v[204:207]
    s_nop 0
    ds_read_b64_tr_b16 a[220:221], v11 offset:480
    ds_read_b64_tr_b16 a[222:223], v11 offset:992
    v_mfma_f32_16x16x32_bf16 v[200:203], a[196:199], v[104:107], v[200:203]
    v_add_f32 v21, v23, v112
    v_cvt_pk_bf16_f32 v96, v112, v113
    v_mfma_f32_16x16x32_bf16 v[208:211], a[200:203], v[104:107], v[208:211]
    s_waitcnt lgkmcnt(6)
    ds_read_b128 a[192:195], v33 offset:16896
    ds_read_b128 a[196:199], v33 offset:17408
    v_mfma_f32_16x16x32_bf16 v[212:215], a[200:203], v[108:111], v[212:215]
    v_add_f32 v21, v21, v113
    v_accvgpr_read_b32 v118, a118
    v_mfma_f32_16x16x32_bf16 v[220:223], a[204:207], v[108:111], v[220:223]
    s_add_u32 m0, s38, 35904
    v_accvgpr_read_b32 v119, a119
    v_exp_f32 v116, v116
    v_mfma_f32_16x16x32_bf16 v[216:219], a[204:207], v[104:107], v[216:219]
    s_mov_b32 s45, 14592
    buffer_load_dwordx4 v20, s[20:23], s45 offen lds
    v_mfma_f32_16x16x32_bf16 v[224:227], a[208:211], v[104:107], v[224:227]
    s_waitcnt lgkmcnt(4)
    ds_read_b128 a[200:203], v33 offset:16960
    ds_read_b128 a[204:207], v33 offset:17472
    v_mfma_f32_16x16x32_bf16 v[228:231], a[208:211], v[108:111], v[228:231]
    v_exp_f32 v117, v117
    v_add_f32 v21, v21, v114
    v_mfma_f32_16x16x32_bf16 v[236:239], a[212:215], v[108:111], v[236:239]
    v_cvt_pk_bf16_f32 v97, v114, v115
    v_add_f32 v21, v21, v115
    v_mfma_f32_16x16x32_bf16 v[232:235], a[212:215], v[104:107], v[232:235]
    v_accvgpr_read_b32 v120, a120
    v_accvgpr_read_b32 v121, a121
    v_mfma_f32_16x16x32_bf16 v[240:243], a[216:219], v[104:107], v[240:243]
    s_waitcnt lgkmcnt(3)
    ds_read_b128 a[208:211], v33 offset:17024
    ds_read_b128 a[212:215], v33 offset:17536
    v_mfma_f32_16x16x32_bf16 v[244:247], a[216:219], v[108:111], v[244:247]
    v_exp_f32 v118, v118
    v_mfma_f32_16x16x32_bf16 v[252:255], a[220:223], v[108:111], v[252:255]
    s_add_u32 m0, s38, 36960
    v_exp_f32 v119, v119
    v_add_f32 v21, v21, v116
    v_mfma_f32_16x16x32_bf16 v[248:251], a[220:223], v[104:107], v[248:251]
    s_mov_b32 s45, 21760
    buffer_load_dwordx4 v20, s[20:23], s45 offen lds
    v_cvt_pk_bf16_f32 v98, v116, v117
    v_mfma_f32_16x16x32_bf16 v[48:51], a[192:195], a[128:131], v[40:43]
    s_waitcnt lgkmcnt(3)
    ds_read_b128 a[216:219], v33 offset:17088
    ds_read_b128 a[220:223], v33 offset:17600
    s_waitcnt vmcnt(9)
    v_mfma_f32_16x16x32_bf16 v[56:59], a[192:195], a[132:135], v[44:47]
    s_barrier
    v_mfma_f32_16x16x32_bf16 v[60:63], a[196:199], a[132:135], v[44:47]
    v_add_f32 v21, v21, v117
    v_accvgpr_read_b32 v122, a122
    v_mfma_f32_16x16x32_bf16 v[52:55], a[196:199], a[128:131], v[40:43]
    v_accvgpr_read_b32 v123, a123
    v_exp_f32 v120, v120
    v_mfma_f32_16x16x32_bf16 v[48:51], a[200:203], a[136:139], v[48:51]
    s_waitcnt lgkmcnt(3)
    ds_read_b128 a[192:195], v33 offset:17152
    ds_read_b128 a[196:199], v33 offset:17664
    v_mfma_f32_16x16x32_bf16 v[56:59], a[200:203], a[140:143], v[56:59]
    v_exp_f32 v121, v121
    v_mfma_f32_16x16x32_bf16 v[60:63], a[204:207], a[140:143], v[60:63]
    s_add_u32 m0, s38, 50688
    v_add_f32 v21, v21, v118
    v_cvt_pk_bf16_f32 v99, v118, v119
    v_mfma_f32_16x16x32_bf16 v[52:55], a[204:207], a[136:139], v[52:55]
    s_mov_b32 s45, 114944
    buffer_load_dwordx4 v20, s[20:23], s45 offen lds
    v_add_f32 v21, v21, v119
    v_mfma_f32_16x16x32_bf16 v[48:51], a[208:211], a[144:147], v[48:51]
    s_waitcnt lgkmcnt(3)
    ds_read_b128 a[200:203], v33 offset:17216
    ds_read_b128 a[204:207], v33 offset:17728
    v_mfma_f32_16x16x32_bf16 v[56:59], a[208:211], a[148:151], v[56:59]
    v_accvgpr_read_b32 v124, a124
    v_accvgpr_read_b32 v125, a125
    v_mfma_f32_16x16x32_bf16 v[60:63], a[212:215], a[148:151], v[60:63]
    v_exp_f32 v122, v122
    v_mfma_f32_16x16x32_bf16 v[52:55], a[212:215], a[144:147], v[52:55]
    v_exp_f32 v123, v123
    v_add_f32 v22, v24, v120
    v_mfma_f32_16x16x32_bf16 v[48:51], a[216:219], a[152:155], v[48:51]
    s_waitcnt lgkmcnt(3)
    ds_read_b128 a[208:211], v33 offset:17280
    ds_read_b128 a[212:215], v33 offset:17792
    v_mfma_f32_16x16x32_bf16 v[56:59], a[216:219], a[156:159], v[56:59]
    v_cvt_pk_bf16_f32 v100, v120, v121
    v_add_f32 v22, v22, v121
    v_accvgpr_read_b32 v126, a126
    v_mfma_f32_16x16x32_bf16 v[60:63], a[220:223], a[156:159], v[60:63]
    s_add_u32 m0, s38, 51744
    v_accvgpr_read_b32 v127, a127
    v_mfma_f32_16x16x32_bf16 v[52:55], a[220:223], a[152:155], v[52:55]
    s_mov_b32 s45, 122112
    buffer_load_dwordx4 v20, s[20:23], s45 offen lds
    v_mfma_f32_16x16x32_bf16 v[48:51], a[192:195], a[160:163], v[48:51]
    s_waitcnt lgkmcnt(3)
    ds_read_b128 a[216:219], v33 offset:17344
    ds_read_b128 a[220:223], v33 offset:17856
    v_mfma_f32_16x16x32_bf16 v[56:59], a[192:195], a[164:167], v[56:59]
    v_exp_f32 v124, v124
    v_exp_f32 v125, v125
    v_mfma_f32_16x16x32_bf16 v[60:63], a[196:199], a[164:167], v[60:63]
    v_add_f32 v22, v22, v122
    v_cvt_pk_bf16_f32 v101, v122, v123
    v_mfma_f32_16x16x32_bf16 v[52:55], a[196:199], a[160:163], v[52:55]
    v_add_f32 v22, v22, v123
    v_exp_f32 v126, v126
    v_mfma_f32_16x16x32_bf16 v[48:51], a[200:203], a[168:171], v[48:51]
    s_waitcnt lgkmcnt(3)
    ds_read_b64_tr_b16 a[192:193], v11 offset:33792
    ds_read_b64_tr_b16 a[194:195], v11 offset:34304
    v_mfma_f32_16x16x32_bf16 v[56:59], a[200:203], a[172:175], v[56:59]
    v_exp_f32 v127, v127
    v_mfma_f32_16x16x32_bf16 v[60:63], a[204:207], a[172:175], v[60:63]
    s_add_u32 m0, s38, 52800
    ds_read_b64_tr_b16 a[196:197], v11 offset:33824
    ds_read_b64_tr_b16 a[198:199], v11 offset:34336
    v_mfma_f32_16x16x32_bf16 v[52:55], a[204:207], a[168:171], v[52:55]
    s_mov_b32 s45, 129280
    buffer_load_dwordx4 v20, s[20:23], s45 offen lds
    v_add_f32 v22, v22, v124
    v_mfma_f32_16x16x32_bf16 v[48:51], a[208:211], a[176:179], v[48:51]
    s_waitcnt lgkmcnt(5)
    ds_read_b64_tr_b16 a[200:201], v11 offset:33856
    ds_read_b64_tr_b16 a[202:203], v11 offset:34368
    v_mfma_f32_16x16x32_bf16 v[56:59], a[208:211], a[180:183], v[56:59]
    v_cvt_pk_bf16_f32 v102, v124, v125
    v_add_f32 v22, v22, v125
    v_mfma_f32_16x16x32_bf16 v[60:63], a[212:215], a[180:183], v[60:63]
    s_nop 0
    ds_read_b64_tr_b16 a[204:205], v11 offset:33888
    ds_read_b64_tr_b16 a[206:207], v11 offset:34400
    v_mfma_f32_16x16x32_bf16 v[52:55], a[212:215], a[176:179], v[52:55]
    v_add_f32 v22, v22, v126
    v_cvt_pk_bf16_f32 v103, v126, v127
    v_add_f32 v22, v22, v127
    v_mfma_f32_16x16x32_bf16 v[48:51], a[216:219], a[184:187], v[48:51]
    s_waitcnt lgkmcnt(6)
    ds_read_b64_tr_b16 a[208:209], v11 offset:33920
    ds_read_b64_tr_b16 a[210:211], v11 offset:34432
    v_mfma_f32_16x16x32_bf16 v[56:59], a[216:219], a[188:191], v[56:59]
    v_max_f32 v30, v21, v22
    v_cmp_nge_f32 vcc, s35, v30
    v_mfma_f32_16x16x32_bf16 v[60:63], a[220:223], a[188:191], v[60:63]
    s_add_u32 m0, s38, 53856
    ds_read_b64_tr_b16 a[212:213], v11 offset:33952
    ds_read_b64_tr_b16 a[214:215], v11 offset:34464
    v_mfma_f32_16x16x32_bf16 v[52:55], a[220:223], a[184:187], v[52:55]
    s_mov_b32 s45, 136448
    buffer_load_dwordx4 v20, s[20:23], s45 offen lds
    s_cbranch_vccnz T_c14
B_c14:
    v_mfma_f32_16x16x32_bf16 v[128:131], a[192:195], v[96:99], v[128:131]
    s_waitcnt lgkmcnt(6)
    ds_read_b64_tr_b16 a[216:217], v11 offset:33984
    ds_read_b64_tr_b16 a[218:219], v11 offset:34496
    s_waitcnt vmcnt(9)
    v_mfma_f32_16x16x32_bf16 v[132:135], a[192:195], v[100:103], v[132:135]
    s_barrier
    v_mfma_f32_16x16x32_bf16 v[140:143], a[196:199], v[100:103], v[140:143]
    s_nop 0
    ds_read_b64_tr_b16 a[220:221], v11 offset:34016
    ds_read_b64_tr_b16 a[222:223], v11 offset:34528
    v_mfma_f32_16x16x32_bf16 v[136:139], a[196:199], v[96:99], v[136:139]
    v_exp_f32 v112, v48
    v_exp_f32 v113, v49
    v_mfma_f32_16x16x32_bf16 v[144:147], a[200:203], v[96:99], v[144:147]
    s_waitcnt lgkmcnt(6)
    ds_read_b64_tr_b16 a[192:193], v11 offset:34048
    ds_read_b64_tr_b16 a[194:195], v11 offset:34560
    v_mfma_f32_16x16x32_bf16 v[148:151], a[200:203], v[100:103], v[148:151]
    v_exp_f32 v114, v50
    v_exp_f32 v115, v51
    v_add_f32 v23, v21, v112
    v_cvt_pk_bf16_f32 v104, v112, v113
    v_mfma_f32_16x16x32_bf16 v[156:159], a[204:207], v[100:103], v[156:159]
    s_add_u32 m0, s38, 67584
    ds_read_b64_tr_b16 a[196:197], v11 offset:34080
    ds_read_b64_tr_b16 a[198:199], v11 offset:34592
    v_mfma_f32_16x16x32_bf16 v[152:155], a[204:207], v[96:99], v[152:155]
    s_mov_b32 s45, 384
    buffer_load_dwordx4 v20, s[20:23], s45 offen lds
    v_add_f32 v23, v23, v113
    v_mfma_f32_16x16x32_bf16 v[160:163], a[208:211], v[96:99], v[160:163]
    s_waitcnt lgkmcnt(6)
    ds_read_b64_tr_b16 a[200:201], v11 offset:34112
    ds_read_b64_tr_b16 a[202:203], v11 offset:34624
    v_mfma_f32_16x16x32_bf16 v[164:167], a[208:211], v[100:103], v[164:167]
    v_exp_f32 v116, v52
    v_exp_f32 v117, v53
    v_add_f32 v23, v23, v114
    v_mfma_f32_16x16x32_bf16 v[172:175], a[212:215], v[100:103], v[172:175]
    s_nop 0
    ds_read_b64_tr_b16 a[204:205], v11 offset:34144
    ds_read_b64_tr_b16 a[206:207], v11 offset:34656
    v_mfma_f32_16x16x32_bf16 v[168:171], a[212:215], v[96:99], v[168:171]
    v_cvt_pk_bf16_f32 v105, v114, v115
    v_add_f32 v23, v23, v115
    v_exp_f32 v118, v54
    v_mfma_f32_16x16x32_bf16 v[176:179], a[216:219], v[96:99], v[176:179]
    s_waitcnt lgkmcnt(6)
    ds_read_b64_tr_b16 a[208:209], v11 offset:34176
    ds_read_b64_tr_b16 a[210:211], v11 offset:34688
    v_mfma_f32_16x16x32_bf16 v[180:183], a[216:219], v[100:103], v[180:183]
    v_exp_f32 v119, v55
    v_add_f32 v23, v23, v116
    v_cvt_pk_bf16_f32 v106, v116, v117
    v_add_f32 v23, v23, v117
    v_mfma_f32_16x16x32_bf16 v[188:191], a[220:223], v[100:103], v[188:191]
    s_add_u32 m0, s38, 68640
    ds_read_b64_tr_b16 a[212:213], v11 offset:34208
    ds_read_b64_tr_b16 a[214:215], v11 offset:34720
    v_mfma_f32_16x16x32_bf16 v[184:187], a[220:223], v[96:99], v[184:187]
    s_mov_b32 s45, 7552
    buffer_load_dwordx4 v20, s[20:23], s45 offen lds
    v_mfma_f32_16x16x32_bf16 v[192:195], a[192:195], v[96:99], v[192:195]
    s_waitcnt lgkmcnt(6)
    ds_read_b64_tr_b16 a[216:217], v11 offset:34240
    ds_read_b64_tr_b16 a[218:219], v11 offset:34752
    v_mfma_f32_16x16x32_bf16 v[196:199], a[192:195], v[100:103], v[196:199]
    v_exp_f32 v120, v56
    v_exp_f32 v121, v57
    v_add_f32 v23, v23, v118
    v_cvt_pk_bf16_f32 v107, v118, v119
    v_add_f32 v23, v23, v119
    v_mfma_f32_16x16x32_bf16 v[204:207], a[196:199], v[100:103], v[204:207]
    s_nop 0
    ds_read_b64_tr_b16 a[220:221], v11 offset:34272
    ds_read_b64_tr_b16 a[222:223], v11 offset:34784
    v_mfma_f32_16x16x32_bf16 v[200:203], a[196:199], v[96:99], v[200:203]
    v_exp_f32 v122, v58
    v_exp_f32 v123, v59
    v_add_f32 v24, v22, v120
    v_mfma_f32_16x16x32_bf16 v[208:211], a[200:203], v[96:99], v[208:211]
    s_waitcnt lgkmcnt(6)
    ds_read_b64_tr_b16 a[192:193], v10 offset:0
    ds_read_b64_tr_b16 a[194:195], v10 offset:512
    v_mfma_f32_16x16x32_bf16 v[212:215], a[200:203], v[100:103], v[212:215]
    v_cvt_pk_bf16_f32 v108, v120, v121
    v_add_f32 v24, v24, v121
    v_exp_f32 v124, v60
    v_mfma_f32_16x16x32_bf16 v[220:223], a[204:207], v[100:103], v[220:223]
    s_add_u32 m0, s38, 69696
    ds_read_b64_tr_b16 a[196:197], v10 offset:32
    ds_read_b64_tr_b16 a[198:199], v10 offset:544
    v_mfma_f32_16x16x32_bf16 v[216:219], a[204:207], v[96:99], v[216:219]
    s_mov_b32 s45, 14720
    buffer_load_dwordx4 v20, s[20:23], s45 offen lds
    v_mfma_f32_16x16x32_bf16 v[224:227], a[208:211], v[96:99], v[224:227]
    s_waitcnt lgkmcnt(6)
    ds_read_b64_tr_b16 a[200:201], v10 offset:64
    ds_read_b64_tr_b16 a[202:203], v10 offset:576
    v_mfma_f32_16x16x32_bf16 v[228:231], a[208:211], v[100:103], v[228:231]
    v_exp_f32 v125, v61
    v_add_f32 v24, v24, v122
    v_cvt_pk_bf16_f32 v109, v122, v123
    v_add_f32 v24, v24, v123
    v_exp_f32 v126, v62
    v_mfma_f32_16x16x32_bf16 v[236:239], a[212:215], v[100:103], v[236:239]
    s_nop 0
    ds_read_b64_tr_b16 a[204:205], v10 offset:96
    ds_read_b64_tr_b16 a[206:207], v10 offset:608
    v_mfma_f32_16x16x32_bf16 v[232:235], a[212:215], v[96:99], v[232:235]
    v_exp_f32 v127, v63
    v_add_f32 v24, v24, v124
    v_cvt_pk_bf16_f32 v110, v124, v125
    v_add_f32 v24, v24, v125
    v_mfma_f32_16x16x32_bf16 v[240:243], a[216:219], v[96:99], v[240:243]
    s_waitcnt lgkmcnt(6)
    ds_read_b64_tr_b16 a[208:209], v10 offset:128
    ds_read_b64_tr_b16 a[210:211], v10 offset:640
    v_mfma_f32_16x16x32_bf16 v[244:247], a[216:219], v[100:103], v[244:247]
    v_add_f32 v24, v24, v126
    v_cvt_pk_bf16_f32 v111, v126, v127
    v_add_f32 v24, v24, v127
    v_max_f32 v30, v23, v24
    v_cmp_nge_f32 vcc, s35, v30
    v_mfma_f32_16x16x32_bf16 v[252:255], a[220:223], v[100:103], v[252:255]
    s_add_u32 m0, s38, 70752
    ds_read_b64_tr_b16 a[212:213], v10 offset:160
    ds_read_b64_tr_b16 a[214:215], v10 offset:672
    v_mfma_f32_16x16x32_bf16 v[248:251], a[220:223], v[96:99], v[248:251]
    s_mov_b32 s45, 21888
    buffer_load_dwordx4 v20, s[20:23], s45 offen lds
    s_cbranch_vccnz T_c15
B_c15:
    v_mfma_f32_16x16x32_bf16 v[128:131], a[192:195], v[104:107], v[128:131]
    s_waitcnt lgkmcnt(6)
    ds_read_b64_tr_b16 a[216:217], v10 offset:192
    ds_read_b64_tr_b16 a[218:219], v10 offset:704
    s_waitcnt vmcnt(63)
    v_mfma_f32_16x16x32_bf16 v[132:135], a[192:195], v[108:111], v[132:135]
    s_barrier
    v_mov_b32 v26, v23
    v_mov_b32 v27, v24
    v_mfma_f32_16x16x32_bf16 v[140:143], a[196:199], v[108:111], v[140:143]
    s_nop 0
    ds_read_b64_tr_b16 a[220:221], v10 offset:224
    ds_read_b64_tr_b16 a[222:223], v10 offset:736
    v_permlane32_swap_b32 v23, v26
    v_permlane32_swap_b32 v24, v27
    v_mfma_f32_16x16x32_bf16 v[136:139], a[196:199], v[104:107], v[136:139]
    v_add_f32 v23, v23, v26
    v_add_f32 v24, v24, v27
    v_mfma_f32_16x16x32_bf16 v[144:147], a[200:203], v[104:107], v[144:147]
    s_waitcnt lgkmcnt(6)
    ds_read_b64_tr_b16 a[192:193], v10 offset:256
    ds_read_b64_tr_b16 a[194:195], v10 offset:768
    v_mov_b32 v26, v23
    v_mov_b32 v27, v24
    v_mfma_f32_16x16x32_bf16 v[148:151], a[200:203], v[108:111], v[148:151]
    v_permlane16_swap_b32 v23, v26
    v_permlane16_swap_b32 v24, v27
    v_mfma_f32_16x16x32_bf16 v[156:159], a[204:207], v[108:111], v[156:159]
    s_add_u32 m0, s38, 84480
    ds_read_b64_tr_b16 a[196:197], v10 offset:288
    ds_read_b64_tr_b16 a[198:199], v10 offset:800
    v_add_f32 v23, v23, v26
    v_add_f32 v24, v24, v27
    v_mfma_f32_16x16x32_bf16 v[152:155], a[204:207], v[104:107], v[152:155]
    s_mov_b32 s45, 115072
    buffer_load_dwordx4 v20, s[20:23], s45 offen lds
    v_rcp_f32 v28, v23
    v_rcp_f32 v30, v24
    v_mfma_f32_16x16x32_bf16 v[160:163], a[208:211], v[104:107], v[160:163]
    s_waitcnt lgkmcnt(6)
    ds_read_b64_tr_b16 a[200:201], v10 offset:320
    ds_read_b64_tr_b16 a[202:203], v10 offset:832
    v_mfma_f32_16x16x32_bf16 v[164:167], a[208:211], v[108:111], v[164:167]
    v_mul_f32 v128, v128, v28
    v_mul_f32 v129, v129, v28
    v_mul_f32 v130, v130, v28
    v_mul_f32 v131, v131, v28
    v_mul_f32 v132, v132, v30
    v_mul_f32 v133, v133, v30
    v_mul_f32 v134, v134, v30
    v_mul_f32 v135, v135, v30
    v_mul_f32 v136, v136, v28
    v_mul_f32 v137, v137, v28
    v_mul_f32 v138, v138, v28
    v_mfma_f32_16x16x32_bf16 v[172:175], a[212:215], v[108:111], v[172:175]
    s_nop 0
    ds_read_b64_tr_b16 a[204:205], v10 offset:352
    ds_read_b64_tr_b16 a[206:207], v10 offset:864
    v_mfma_f32_16x16x32_bf16 v[168:171], a[212:215], v[104:107], v[168:171]
    v_mul_f32 v139, v139, v28
    v_mul_f32 v140, v140, v30
    v_mul_f32 v141, v141, v30
    v_mul_f32 v142, v142, v30
    v_mul_f32 v143, v143, v30
    v_cvt_pk_bf16_f32 v64, v128, v129
    v_cvt_pk_bf16_f32 v65, v130, v131
    v_cvt_pk_bf16_f32 v66, v136, v137
    v_cvt_pk_bf16_f32 v67, v138, v139
    v_cvt_pk_bf16_f32 v68, v132, v133
    v_cvt_pk_bf16_f32 v69, v134, v135
    v_cvt_pk_bf16_f32 v70, v140, v141
    v_mfma_f32_16x16x32_bf16 v[176:179], a[216:219], v[104:107], v[176:179]
    s_waitcnt lgkmcnt(6)
    ds_read_b64_tr_b16 a[208:209], v10 offset:384
    ds_read_b64_tr_b16 a[210:211], v10 offset:896
    v_mfma_f32_16x16x32_bf16 v[180:183], a[216:219], v[108:111], v[180:183]
    v_cvt_pk_bf16_f32 v71, v142, v143
    v_mov_b32 v128, v64
    v_mov_b32 v129, v65
    v_mov_b32 v130, v66
    v_mov_b32 v131, v67
    v_mov_b32 v132, v68
    v_mov_b32 v133, v69
    v_mov_b32 v134, v70
    v_mov_b32 v135, v71
    v_mul_f32 v144, v144, v28
    v_mul_f32 v145, v145, v28
    v_mfma_f32_16x16x32_bf16 v[188:191], a[220:223], v[108:111], v[188:191]
    s_add_u32 m0, s38, 85536
    ds_read_b64_tr_b16 a[212:213], v10 offset:416
    ds_read_b64_tr_b16 a[214:215], v10 offset:928
    v_mfma_f32_16x16x32_bf16 v[184:187], a[220:223], v[104:107], v[184:187]
    s_mov_b32 s45, 122240
    buffer_load_dwordx4 v20, s[20:23], s45 offen lds
    v_mul_f32 v146, v146, v28
    v_mfma_f32_16x16x32_bf16 v[192:195], a[192:195], v[104:107], v[192:195]
    s_waitcnt lgkmcnt(6)
    ds_read_b64_tr_b16 a[216:217], v10 offset:448
    ds_read_b64_tr_b16 a[218:219], v10 offset:960
    v_mfma_f32_16x16x32_bf16 v[196:199], a[192:195], v[108:111], v[196:199]
    v_mul_f32 v147, v147, v28
    v_mul_f32 v148, v148, v30
    v_mul_f32 v149, v149, v30
    v_mul_f32 v150, v150, v30
    v_mul_f32 v151, v151, v30
    v_mul_f32 v152, v152, v28
    v_mul_f32 v153, v153, v28
    v_mul_f32 v154, v154, v28
    v_mul_f32 v155, v155, v28
    v_mul_f32 v156, v156, v30
    v_mul_f32 v157, v157, v30
    v_mfma_f32_16x16x32_bf16 v[204:207], a[196:199], v[108:111], v[204:207]
    s_nop 0
    ds_read_b64_tr_b16 a[220:221], v10 offset:480
    ds_read_b64_tr_b16 a[222:223], v10 offset:992
    v_mfma_f32_16x16x32_bf16 v[200:203], a[196:199], v[104:107], v[200:203]
    v_mul_f32 v158, v158, v30
    v_mul_f32 v159, v159, v30
    v_cvt_pk_bf16_f32 v136, v144, v145
    v_cvt_pk_bf16_f32 v137, v146, v147
    v_cvt_pk_bf16_f32 v138, v152, v153
    v_cvt_pk_bf16_f32 v139, v154, v155
    v_cvt_pk_bf16_f32 v140, v148, v149
    v_cvt_pk_bf16_f32 v141, v150, v151
    v_cvt_pk_bf16_f32 v142, v156, v157
    v_cvt_pk_bf16_f32 v143, v158, v159
    v_mul_f32 v160, v160, v28
    v_mul_f32 v161, v161, v28
    v_mfma_f32_16x16x32_bf16 v[208:211], a[200:203], v[104:107], v[208:211]
    s_waitcnt lgkmcnt(6)
    ds_read_b64_tr_b16 a[192:193], v88 offset:33792
    ds_read_b64_tr_b16 a[194:195], v88 offset:35904
    v_mfma_f32_16x16x32_bf16 v[212:215], a[200:203], v[108:111], v[212:215]
    v_mul_f32 v162, v162, v28
    v_mul_f32 v163, v163, v28
    v_mul_f32 v164, v164, v30
    v_mul_f32 v165, v165, v30
    v_mul_f32 v166, v166, v30
    v_mul_f32 v167, v167, v30
    v_mul_f32 v168, v168, v28
    v_mul_f32 v169, v169, v28
    v_mul_f32 v170, v170, v28
    v_mul_f32 v171, v171, v28
    v_mul_f32 v172, v172, v30
    v_mfma_f32_16x16x32_bf16 v[220:223], a[204:207], v[108:111], v[220:223]
    s_add_u32 m0, s38, 86592
    ds_read_b64_tr_b16 a[196:197], v89 offset:33792
    ds_read_b64_tr_b16 a[198:199], v89 offset:35904
    v_mfma_f32_16x16x32_bf16 v[216:219], a[204:207], v[104:107], v[216:219]
    s_mov_b32 s45, 129408
    buffer_load_dwordx4 v20, s[20:23], s45 offen lds
    v_mul_f32 v173, v173, v30
    v_mfma_f32_16x16x32_bf16 v[224:227], a[208:211], v[104:107], v[224:227]
    s_waitcnt lgkmcnt(6)
    ds_read_b64_tr_b16 a[200:201], v88 offset:38016
    ds_read_b64_tr_b16 a[202:203], v88 offset:40128
    v_mfma_f32_16x16x32_bf16 v[228:231], a[208:211], v[108:111], v[228:231]
    v_mul_f32 v174, v174, v30
    v_mul_f32 v175, v175, v30
    v_cvt_pk_bf16_f32 v144, v160, v161
    v_cvt_pk_bf16_f32 v145, v162, v163
    v_cvt_pk_bf16_f32 v146, v168, v169
    v_cvt_pk_bf16_f32 v147, v170, v171
    v_cvt_pk_bf16_f32 v148, v164, v165
    v_cvt_pk_bf16_f32 v149, v166, v167
    v_cvt_pk_bf16_f32 v150, v172, v173
    v_cvt_pk_bf16_f32 v151, v174, v175
    v_mul_f32 v176, v176, v28
    v_mfma_f32_16x16x32_bf16 v[236:239], a[212:215], v[108:111], v[236:239]
    s_nop 0
    ds_read_b64_tr_b16 a[204:205], v89 offset:38016
    ds_read_b64_tr_b16 a[206:207], v89 offset:40128
    v_mfma_f32_16x16x32_bf16 v[232:235], a[212:215], v[104:107], v[232:235]
    v_mul_f32 v177, v177, v28
    v_mul_f32 v178, v178, v28
    v_mul_f32 v179, v179, v28
    v_mul_f32 v180, v180, v30
    v_mul_f32 v181, v181, v30
    v_mul_f32 v182, v182, v30
    v_mul_f32 v183, v183, v30
    v_mul_f32 v184, v184, v28
    v_mul_f32 v185, v185, v28
    v_mul_f32 v186, v186, v28
    v_mul_f32 v187, v187, v28
    v_mul_f32 v188, v188, v30
    v_mfma_f32_16x16x32_bf16 v[240:243], a[216:219], v[104:107], v[240:243]
    s_waitcnt lgkmcnt(6)
    ds_read_b64_tr_b16 a[208:209], v88 offset:42240
    ds_read_b64_tr_b16 a[210:211], v88 offset:44352
    v_mfma_f32_16x16x32_bf16 v[244:247], a[216:219], v[108:111], v[244:247]
    v_mul_f32 v189, v189, v30
    v_mul_f32 v190, v190, v30
    v_mul_f32 v191, v191, v30
    v_cvt_pk_bf16_f32 v152, v176, v177
    v_cvt_pk_bf16_f32 v153, v178, v179
    v_cvt_pk_bf16_f32 v154, v184, v185
    v_cvt_pk_bf16_f32 v155, v186, v187
    v_cvt_pk_bf16_f32 v156, v180, v181
    v_cvt_pk_bf16_f32 v157, v182, v183
    v_cvt_pk_bf16_f32 v158, v188, v189
    v_cvt_pk_bf16_f32 v159, v190, v191
    v_mfma_f32_16x16x32_bf16 v[252:255], a[220:223], v[108:111], v[252:255]
    s_add_u32 m0, s38, 87648
    ds_read_b64_tr_b16 a[212:213], v89 offset:42240
    ds_read_b64_tr_b16 a[214:215], v89 offset:44352
    v_mfma_f32_16x16x32_bf16 v[248:251], a[220:223], v[104:107], v[248:251]
    s_mov_b32 s45, 136576
    buffer_load_dwordx4 v20, s[20:23], s45 offen lds
    s_lshr_b32 s47, s94, 4
    s_mul_i32 s48, s47, 1835008
    s_add_u32 s4, s58, s48
    s_addc_u32 s5, s59, 0
    s_and_b32 s5, s5, 0xffff
    s_mov_b32 s6, 1835008
    s_mov_b32 s8, s80
    s_and_b32 s9, s81, 0xffff
    s_mov_b32 s10, 1835008
    s_mov_b32 s53, 0
    s_nop 1
    v_mfma_f32_16x16x32_bf16 v[96:99], a[192:195], v[128:131], 0
    s_waitcnt lgkmcnt(6)
    ds_read_b64_tr_b16 a[216:217], v88 offset:46464
    ds_read_b64_tr_b16 a[218:219], v88 offset:48576
    s_waitcnt vmcnt(63)
    v_mfma_f32_16x16x32_bf16 v[104:107], a[192:195], v[132:135], 0
    s_barrier
    v_mfma_f32_16x16x32_bf16 v[108:111], a[196:199], v[132:135], 0
    s_nop 0
    ds_read_b64_tr_b16 a[220:221], v89 offset:46464
    ds_read_b64_tr_b16 a[222:223], v89 offset:48576
    v_mfma_f32_16x16x32_bf16 v[100:103], a[196:199], v[128:131], 0
    v_mul_f32 v192, v192, v28
    v_mul_f32 v193, v193, v28
    v_mul_f32 v194, v194, v28
    v_mul_f32 v195, v195, v28
    v_mul_f32 v196, v196, v30
    v_mul_f32 v197, v197, v30
    v_mul_f32 v198, v198, v30
    v_mul_f32 v199, v199, v30
    v_mfma_f32_16x16x32_bf16 v[96:99], a[200:203], v[136:139], v[96:99]
    s_waitcnt lgkmcnt(6)
    ds_read_b64_tr_b16 a[192:193], v90 offset:33792
    ds_read_b64_tr_b16 a[194:195], v90 offset:35904
    v_mfma_f32_16x16x32_bf16 v[104:107], a[200:203], v[140:143], v[104:107]
    v_mul_f32 v200, v200, v28
    v_mul_f32 v201, v201, v28
    v_mul_f32 v202, v202, v28
    v_mul_f32 v203, v203, v28
    v_mul_f32 v204, v204, v30
    v_mul_f32 v205, v205, v30
    v_mul_f32 v206, v206, v30
    v_mul_f32 v207, v207, v30
    v_cvt_pk_bf16_f32 v160, v192, v193
    v_and_b32 v26, 15, v1
    v_lshrrev_b32 v27, 4, v1
    v_mfma_f32_16x16x32_bf16 v[108:111], a[204:207], v[140:143], v[108:111]
    s_add_u32 m0, s38, 0
    ds_read_b64_tr_b16 a[196:197], v91 offset:33792
    ds_read_b64_tr_b16 a[198:199], v91 offset:35904
    v_mfma_f32_16x16x32_bf16 v[100:103], a[204:207], v[136:139], v[100:103]
    s_mov_b32 s45, 512
    buffer_load_dwordx4 v20, s[20:23], s45 offen lds
    v_cvt_pk_bf16_f32 v161, v194, v195
    v_mfma_f32_16x16x32_bf16 v[96:99], a[208:211], v[144:147], v[96:99]
    s_waitcnt lgkmcnt(6)
    ds_read_b64_tr_b16 a[200:201], v90 offset:38016
    ds_read_b64_tr_b16 a[202:203], v90 offset:40128
    v_mfma_f32_16x16x32_bf16 v[104:107], a[208:211], v[148:151], v[104:107]
    v_cvt_pk_bf16_f32 v162, v200, v201
    v_cvt_pk_bf16_f32 v163, v202, v203
    v_cvt_pk_bf16_f32 v164, v196, v197
    v_cvt_pk_bf16_f32 v165, v198, v199
    v_cvt_pk_bf16_f32 v166, v204, v205
    v_cvt_pk_bf16_f32 v167, v206, v207
    v_mul_f32 v208, v208, v28
    v_mul_f32 v209, v209, v28
    v_mul_u32_u24 v93, 1792, v26
    v_cmp_ne_u32 s[88:89], s52, v26
    v_mfma_f32_16x16x32_bf16 v[108:111], a[212:215], v[148:151], v[108:111]
    s_nop 0
    ds_read_b64_tr_b16 a[204:205], v91 offset:38016
    ds_read_b64_tr_b16 a[206:207], v91 offset:40128
    v_mfma_f32_16x16x32_bf16 v[100:103], a[212:215], v[144:147], v[100:103]
    v_mul_f32 v210, v210, v28
    v_mul_f32 v211, v211, v28
    v_mul_f32 v212, v212, v30
    v_mul_f32 v213, v213, v30
    v_mul_f32 v214, v214, v30
    v_mul_f32 v215, v215, v30
    v_mul_f32 v216, v216, v28
    v_mul_f32 v217, v217, v28
    v_mul_f32 v218, v218, v28
    v_mfma_f32_16x16x32_bf16 v[96:99], a[216:219], v[152:155], v[96:99]
    s_waitcnt lgkmcnt(6)
    ds_read_b64_tr_b16 a[208:209], v90 offset:42240
    ds_read_b64_tr_b16 a[210:211], v90 offset:44352
    v_mfma_f32_16x16x32_bf16 v[104:107], a[216:219], v[156:159], v[104:107]
    v_mul_f32 v219, v219, v28
    v_mul_f32 v220, v220, v30
    v_mul_f32 v221, v221, v30
    v_mul_f32 v222, v222, v30
    v_mul_f32 v223, v223, v30
    v_cvt_pk_bf16_f32 v168, v208, v209
    v_cvt_pk_bf16_f32 v169, v210, v211
    v_cvt_pk_bf16_f32 v170, v216, v217
    v_lshl_add_u32 v93, v27, 4, v93
    v_and_b32 v27, 1, v27
    v_mfma_f32_16x16x32_bf16 v[108:111], a[220:223], v[156:159], v[108:111]
    s_add_u32 m0, s38, 1056
    ds_read_b64_tr_b16 a[212:213], v91 offset:42240
    ds_read_b64_tr_b16 a[214:215], v91 offset:44352
    v_mfma_f32_16x16x32_bf16 v[100:103], a[220:223], v[152:155], v[100:103]
    s_mov_b32 s45, 7680
    buffer_load_dwordx4 v20, s[20:23], s45 offen lds
    v_cvt_pk_bf16_f32 v171, v218, v219
    v_mfma_f32_16x16x32_bf16 v[112:115], a[192:195], v[128:131], 0
    s_waitcnt lgkmcnt(6)
    ds_read_b64_tr_b16 a[216:217], v90 offset:46464
    ds_read_b64_tr_b16 a[218:219], v90 offset:48576
    v_mfma_f32_16x16x32_bf16 v[120:123], a[192:195], v[132:135], 0
    v_cvt_pk_bf16_f32 v172, v212, v213
    v_cvt_pk_bf16_f32 v173, v214, v215
    v_cvt_pk_bf16_f32 v174, v220, v221
    v_cvt_pk_bf16_f32 v175, v222, v223
    v_mul_f32 v224, v224, v28
    v_mul_f32 v225, v225, v28
    v_mul_f32 v226, v226, v28
    v_mul_f32 v227, v227, v28
    v_mul_f32 v228, v228, v30
    v_lshlrev_b32 v26, 7, v26
    s_nop 0
    v_mfma_f32_16x16x32_bf16 v[124:127], a[196:199], v[132:135], 0
    s_nop 0
    ds_read_b64_tr_b16 a[220:221], v91 offset:46464
    ds_read_b64_tr_b16 a[222:223], v91 offset:48576
    v_mfma_f32_16x16x32_bf16 v[116:119], a[196:199], v[128:131], 0
    v_mul_f32 v229, v229, v30
    v_mul_f32 v230, v230, v30
    v_mul_f32 v231, v231, v30
    v_mul_f32 v232, v232, v28
    v_mul_f32 v233, v233, v28
    v_mul_f32 v234, v234, v28
    v_mul_f32 v235, v235, v28
    v_mul_f32 v236, v236, v30
    v_mfma_f32_16x16x32_bf16 v[112:115], a[200:203], v[136:139], v[112:115]
    s_waitcnt lgkmcnt(6)
    ds_read_b64_tr_b16 a[192:193], v80 offset:16896
    ds_read_b64_tr_b16 a[194:195], v80 offset:19008
    v_mfma_f32_16x16x32_bf16 v[120:123], a[200:203], v[140:143], v[120:123]
    v_mul_f32 v237, v237, v30
    v_mul_f32 v238, v238, v30
    v_mul_f32 v239, v239, v30
    v_cvt_pk_bf16_f32 v176, v224, v225
    v_cvt_pk_bf16_f32 v177, v226, v227
    v_cvt_pk_bf16_f32 v178, v232, v233
    v_cvt_pk_bf16_f32 v179, v234, v235
    v_cvt_pk_bf16_f32 v180, v228, v229
    v_cvt_pk_bf16_f32 v181, v230, v231
    v_mfma_f32_16x16x32_bf16 v[124:127], a[204:207], v[140:143], v[124:127]
    s_add_u32 m0, s38, 2112
    ds_read_b64_tr_b16 a[196:197], v81 offset:16896
    ds_read_b64_tr_b16 a[198:199], v81 offset:19008
    v_mfma_f32_16x16x32_bf16 v[116:119], a[204:207], v[136:139], v[116:119]
    s_mov_b32 s45, 14848
    buffer_load_dwordx4 v20, s[20:23], s45 offen lds
    v_cvt_pk_bf16_f32 v182, v236, v237
    v_mfma_f32_16x16x32_bf16 v[112:115], a[208:211], v[144:147], v[112:115]
    s_waitcnt lgkmcnt(6)
    ds_read_b64_tr_b16 a[200:201], v80 offset:21120
    ds_read_b64_tr_b16 a[202:203], v80 offset:23232
    v_mfma_f32_16x16x32_bf16 v[120:123], a[208:211], v[148:151], v[120:123]
    v_cvt_pk_bf16_f32 v183, v238, v239
    v_mul_f32 v240, v240, v28
    v_mul_f32 v241, v241, v28
    v_mul_f32 v242, v242, v28
    v_mul_f32 v243, v243, v28
    v_mul_f32 v244, v244, v30
    v_mul_f32 v245, v245, v30
    v_mul_f32 v246, v246, v30
    v_mfma_f32_16x16x32_bf16 v[124:127], a[212:215], v[148:151], v[124:127]
    s_nop 0
    ds_read_b64_tr_b16 a[204:205], v81 offset:21120
    ds_read_b64_tr_b16 a[206:207], v81 offset:23232
    v_mfma_f32_16x16x32_bf16 v[116:119], a[212:215], v[144:147], v[116:119]
    v_mul_f32 v247, v247, v30
    v_mul_f32 v248, v248, v28
    v_mul_f32 v249, v249, v28
    v_mul_f32 v250, v250, v28
    v_mul_f32 v251, v251, v28
    v_mul_f32 v252, v252, v30
    v_mul_f32 v253, v253, v30
    v_mul_f32 v254, v254, v30
    v_mul_f32 v255, v255, v30
    v_mfma_f32_16x16x32_bf16 v[112:115], a[216:219], v[152:155], v[112:115]
    s_waitcnt lgkmcnt(6)
    ds_read_b64_tr_b16 a[208:209], v80 offset:25344
    ds_read_b64_tr_b16 a[210:211], v80 offset:27456
    v_mfma_f32_16x16x32_bf16 v[120:123], a[216:219], v[156:159], v[120:123]
    v_cvt_pk_bf16_f32 v184, v240, v241
    v_cvt_pk_bf16_f32 v185, v242, v243
    v_cvt_pk_bf16_f32 v186, v248, v249
    v_cvt_pk_bf16_f32 v187, v250, v251
    v_cvt_pk_bf16_f32 v188, v244, v245
    v_cvt_pk_bf16_f32 v189, v246, v247
    v_cvt_pk_bf16_f32 v190, v252, v253
    v_cvt_pk_bf16_f32 v191, v254, v255
    v_mfma_f32_16x16x32_bf16 v[124:127], a[220:223], v[156:159], v[124:127]
    s_add_u32 m0, s38, 3168
    ds_read_b64_tr_b16 a[212:213], v81 offset:25344
    ds_read_b64_tr_b16 a[214:215], v81 offset:27456
    v_mfma_f32_16x16x32_bf16 v[116:119], a[220:223], v[152:155], v[116:119]
    s_mov_b32 s45, 22016
    buffer_load_dwordx4 v20, s[20:23], s45 offen lds
    v_mfma_f32_16x16x32_bf16 v[96:99], a[192:195], v[160:163], v[96:99]
    s_waitcnt lgkmcnt(6)
    ds_read_b64_tr_b16 a[216:217], v80 offset:29568
    ds_read_b64_tr_b16 a[218:219], v80 offset:31680
    s_waitcnt vmcnt(63)
    v_mfma_f32_16x16x32_bf16 v[104:107], a[192:195], v[164:167], v[104:107]
    s_barrier
    v_mfma_f32_16x16x32_bf16 v[108:111], a[196:199], v[164:167], v[108:111]
    s_add_u32 m0, s38, 135168
    ds_read_b64_tr_b16 a[220:221], v81 offset:29568
    ds_read_b64_tr_b16 a[222:223], v81 offset:31680
    v_mfma_f32_16x16x32_bf16 v[100:103], a[196:199], v[160:163], v[100:103]
    s_mov_b32 s45, 115200
    buffer_load_dwordx4 v20, s[20:23], s45 offen lds
    v_mfma_f32_16x16x32_bf16 v[96:99], a[200:203], v[168:171], v[96:99]
    s_waitcnt lgkmcnt(6)
    ds_read_b64_tr_b16 a[192:193], v82 offset:16896
    ds_read_b64_tr_b16 a[194:195], v82 offset:19008
    v_mfma_f32_16x16x32_bf16 v[104:107], a[200:203], v[172:175], v[104:107]
    s_andn2_b32 s86, s88, 0xffff
    v_mfma_f32_16x16x32_bf16 v[108:111], a[204:207], v[172:175], v[108:111]
    s_add_u32 m0, s38, 136224
    ds_read_b64_tr_b16 a[196:197], v83 offset:16896
    ds_read_b64_tr_b16 a[198:199], v83 offset:19008
    v_mfma_f32_16x16x32_bf16 v[100:103], a[204:207], v[168:171], v[100:103]
    s_mov_b32 s45, 122368
    buffer_load_dwordx4 v20, s[20:23], s45 offen lds
    v_mfma_f32_16x16x32_bf16 v[96:99], a[208:211], v[176:179], v[96:99]
    s_waitcnt lgkmcnt(6)
    ds_read_b64_tr_b16 a[200:201], v82 offset:21120
    ds_read_b64_tr_b16 a[202:203], v82 offset:23232
    v_mfma_f32_16x16x32_bf16 v[104:107], a[208:211], v[180:183], v[104:107]
    s_mov_b32 s87, 0
    v_mfma_f32_16x16x32_bf16 v[108:111], a[212:215], v[180:183], v[108:111]
    s_add_u32 m0, s38, 137280
    ds_read_b64_tr_b16 a[204:205], v83 offset:21120
    ds_read_b64_tr_b16 a[206:207], v83 offset:23232
    v_mfma_f32_16x16x32_bf16 v[100:103], a[212:215], v[176:179], v[100:103]
    s_mov_b32 s45, 129536
    buffer_load_dwordx4 v20, s[20:23], s45 offen lds
    v_mfma_f32_16x16x32_bf16 v[96:99], a[216:219], v[184:187], v[96:99]
    s_waitcnt lgkmcnt(6)
    ds_read_b64_tr_b16 a[208:209], v82 offset:25344
    ds_read_b64_tr_b16 a[210:211], v82 offset:27456
    v_mfma_f32_16x16x32_bf16 v[104:107], a[216:219], v[188:191], v[104:107]
    s_and_b32 s88, s88, 0xffff
    v_mfma_f32_16x16x32_bf16 v[108:111], a[220:223], v[188:191], v[108:111]
    s_add_u32 m0, s38, 138336
    ds_read_b64_tr_b16 a[212:213], v83 offset:25344
    ds_read_b64_tr_b16 a[214:215], v83 offset:27456
    v_mfma_f32_16x16x32_bf16 v[100:103], a[220:223], v[184:187], v[100:103]
    s_mov_b32 s45, 136704
    buffer_load_dwordx4 v20, s[20:23], s45 offen lds
    v_mfma_f32_16x16x32_bf16 v[112:115], a[192:195], v[160:163], v[112:115]
    s_waitcnt lgkmcnt(6)
    ds_read_b64_tr_b16 a[216:217], v82 offset:29568
    ds_read_b64_tr_b16 a[218:219], v82 offset:31680
    v_mfma_f32_16x16x32_bf16 v[120:123], a[192:195], v[164:167], v[120:123]
    s_mov_b32 s89, 0
    v_mfma_f32_16x16x32_bf16 v[124:127], a[196:199], v[164:167], v[124:127]
    s_nop 0
    ds_read_b64_tr_b16 a[220:221], v83 offset:29568
    ds_read_b64_tr_b16 a[222:223], v83 offset:31680
    v_mfma_f32_16x16x32_bf16 v[116:119], a[196:199], v[160:163], v[116:119]
    v_cvt_pk_bf16_f32 v64, v96, v97
    v_cvt_pk_bf16_f32 v65, v98, v99
    v_mfma_f32_16x16x32_bf16 v[112:115], a[200:203], v[168:171], v[112:115]
    s_waitcnt lgkmcnt(6)
    ds_read_b64_tr_b16 a[192:193], v88 offset:16896
    ds_read_b64_tr_b16 a[194:195], v88 offset:19008
    v_mfma_f32_16x16x32_bf16 v[120:123], a[200:203], v[172:175], v[120:123]
    v_mfma_f32_16x16x32_bf16 v[124:127], a[204:207], v[172:175], v[124:127]
    s_nop 0
    ds_read_b64_tr_b16 a[196:197], v89 offset:16896
    ds_read_b64_tr_b16 a[198:199], v89 offset:19008
    v_mfma_f32_16x16x32_bf16 v[116:119], a[204:207], v[168:171], v[116:119]
    v_cvt_pk_bf16_f32 v66, v100, v101
    v_cvt_pk_bf16_f32 v67, v102, v103
    v_mfma_f32_16x16x32_bf16 v[112:115], a[208:211], v[176:179], v[112:115]
    s_waitcnt lgkmcnt(6)
    ds_read_b64_tr_b16 a[200:201], v88 offset:21120
    ds_read_b64_tr_b16 a[202:203], v88 offset:23232
    v_mfma_f32_16x16x32_bf16 v[120:123], a[208:211], v[180:183], v[120:123]
    v_mfma_f32_16x16x32_bf16 v[124:127], a[212:215], v[180:183], v[124:127]
    s_nop 0
    ds_read_b64_tr_b16 a[204:205], v89 offset:21120
    ds_read_b64_tr_b16 a[206:207], v89 offset:23232
    v_mfma_f32_16x16x32_bf16 v[116:119], a[212:215], v[176:179], v[116:119]
    v_cvt_pk_bf16_f32 v68, v104, v105
    v_cvt_pk_bf16_f32 v69, v106, v107
    v_mfma_f32_16x16x32_bf16 v[112:115], a[216:219], v[184:187], v[112:115]
    s_waitcnt lgkmcnt(6)
    ds_read_b64_tr_b16 a[208:209], v88 offset:25344
    ds_read_b64_tr_b16 a[210:211], v88 offset:27456
    v_mfma_f32_16x16x32_bf16 v[120:123], a[216:219], v[188:191], v[120:123]
    v_cvt_pk_bf16_f32 v70, v108, v109
    v_cvt_pk_bf16_f32 v71, v110, v111
    v_mfma_f32_16x16x32_bf16 v[124:127], a[220:223], v[188:191], v[124:127]
    s_nop 0
    ds_read_b64_tr_b16 a[212:213], v89 offset:25344
    ds_read_b64_tr_b16 a[214:215], v89 offset:27456
    v_mfma_f32_16x16x32_bf16 v[116:119], a[220:223], v[184:187], v[116:119]
    s_nop 0
    buffer_store_dwordx4 v[64:67], v16, s[24:27], s43 offen offset:0 sc1
    v_mfma_f32_16x16x32_bf16 v[96:99], a[192:195], v[128:131], 0
    s_waitcnt lgkmcnt(6)
    ds_read_b64_tr_b16 a[216:217], v88 offset:29568
    ds_read_b64_tr_b16 a[218:219], v88 offset:31680
    s_waitcnt vmcnt(63)
    v_mfma_f32_16x16x32_bf16 v[104:107], a[192:195], v[132:135], 0
    s_barrier
    v_mfma_f32_16x16x32_bf16 v[108:111], a[196:199], v[132:135], 0
    s_nop 0
    ds_read_b64_tr_b16 a[220:221], v89 offset:29568
    ds_read_b64_tr_b16 a[222:223], v89 offset:31680
    v_mfma_f32_16x16x32_bf16 v[100:103], a[196:199], v[128:131], 0
    s_nop 0
    buffer_store_dwordx4 v[68:71], v16, s[24:27], s43 offen offset:1024 sc1
    v_mfma_f32_16x16x32_bf16 v[96:99], a[200:203], v[136:139], v[96:99]
    s_waitcnt lgkmcnt(6)
    ds_read_b64_tr_b16 a[192:193], v90 offset:16896
    ds_read_b64_tr_b16 a[194:195], v90 offset:19008
    v_mfma_f32_16x16x32_bf16 v[104:107], a[200:203], v[140:143], v[104:107]
    v_cvt_pk_bf16_f32 v72, v112, v113
    v_cvt_pk_bf16_f32 v73, v114, v115
    v_mfma_f32_16x16x32_bf16 v[108:111], a[204:207], v[140:143], v[108:111]
    s_nop 0
    ds_read_b64_tr_b16 a[196:197], v91 offset:16896
    ds_read_b64_tr_b16 a[198:199], v91 offset:19008
    v_mfma_f32_16x16x32_bf16 v[100:103], a[204:207], v[136:139], v[100:103]
    v_mfma_f32_16x16x32_bf16 v[96:99], a[208:211], v[144:147], v[96:99]
    s_waitcnt lgkmcnt(6)
    ds_read_b64_tr_b16 a[200:201], v90 offset:21120
    ds_read_b64_tr_b16 a[202:203], v90 offset:23232
    v_mfma_f32_16x16x32_bf16 v[104:107], a[208:211], v[148:151], v[104:107]
    v_cvt_pk_bf16_f32 v74, v116, v117
    v_cvt_pk_bf16_f32 v75, v118, v119
    v_mfma_f32_16x16x32_bf16 v[108:111], a[212:215], v[148:151], v[108:111]
    s_nop 0
    ds_read_b64_tr_b16 a[204:205], v91 offset:21120
    ds_read_b64_tr_b16 a[206:207], v91 offset:23232
    v_mfma_f32_16x16x32_bf16 v[100:103], a[212:215], v[144:147], v[100:103]
    v_mfma_f32_16x16x32_bf16 v[96:99], a[216:219], v[152:155], v[96:99]
    s_waitcnt lgkmcnt(6)
    ds_read_b64_tr_b16 a[208:209], v90 offset:25344
    ds_read_b64_tr_b16 a[210:211], v90 offset:27456
    v_mfma_f32_16x16x32_bf16 v[104:107], a[216:219], v[156:159], v[104:107]
    v_cvt_pk_bf16_f32 v76, v120, v121
    v_cvt_pk_bf16_f32 v77, v122, v123
    v_mfma_f32_16x16x32_bf16 v[108:111], a[220:223], v[156:159], v[108:111]
    s_nop 0
    ds_read_b64_tr_b16 a[212:213], v91 offset:25344
    ds_read_b64_tr_b16 a[214:215], v91 offset:27456
    v_mfma_f32_16x16x32_bf16 v[100:103], a[220:223], v[152:155], v[100:103]
    v_cvt_pk_bf16_f32 v78, v124, v125
    v_cvt_pk_bf16_f32 v79, v126, v127
    v_mfma_f32_16x16x32_bf16 v[112:115], a[192:195], v[128:131], 0
    s_waitcnt lgkmcnt(6)
    ds_read_b64_tr_b16 a[216:217], v90 offset:29568
    ds_read_b64_tr_b16 a[218:219], v90 offset:31680
    v_mfma_f32_16x16x32_bf16 v[120:123], a[192:195], v[132:135], 0
    s_nop 0
    buffer_store_dwordx4 v[72:75], v16, s[24:27], s43 offen offset:2048 sc1
    v_mfma_f32_16x16x32_bf16 v[124:127], a[196:199], v[132:135], 0
    s_add_u32 m0, s38, 16896
    ds_read_b64_tr_b16 a[220:221], v91 offset:29568
    ds_read_b64_tr_b16 a[222:223], v91 offset:31680
    v_mfma_f32_16x16x32_bf16 v[116:119], a[196:199], v[128:131], 0
    s_mov_b32 s45, 640
    buffer_load_dwordx4 v20, s[20:23], s45 offen lds
    v_mfma_f32_16x16x32_bf16 v[112:115], a[200:203], v[136:139], v[112:115]
    s_waitcnt lgkmcnt(6)
    ds_read_b64_tr_b16 a[192:193], v88 offset:0
    ds_read_b64_tr_b16 a[194:195], v88 offset:2112
    v_mfma_f32_16x16x32_bf16 v[120:123], a[200:203], v[140:143], v[120:123]
    s_nop 0
    buffer_store_dwordx4 v[76:79], v16, s[24:27], s43 offen offset:3072 sc1
    v_mfma_f32_16x16x32_bf16 v[124:127], a[204:207], v[140:143], v[124:127]
    s_add_u32 m0, s38, 17952
    ds_read_b64_tr_b16 a[196:197], v89 offset:0
    ds_read_b64_tr_b16 a[198:199], v89 offset:2112
    v_mfma_f32_16x16x32_bf16 v[116:119], a[204:207], v[136:139], v[116:119]
    s_mov_b32 s45, 7808
    buffer_load_dwordx4 v20, s[20:23], s45 offen lds
    v_mfma_f32_16x16x32_bf16 v[112:115], a[208:211], v[144:147], v[112:115]
    s_waitcnt lgkmcnt(6)
    ds_read_b64_tr_b16 a[200:201], v88 offset:4224
    ds_read_b64_tr_b16 a[202:203], v88 offset:6336
    v_mfma_f32_16x16x32_bf16 v[120:123], a[208:211], v[148:151], v[120:123]
    s_add_u32 s43, s43, 4096
    v_mfma_f32_16x16x32_bf16 v[124:127], a[212:215], v[148:151], v[124:127]
    s_add_u32 m0, s38, 19008
    ds_read_b64_tr_b16 a[204:205], v89 offset:4224
    ds_read_b64_tr_b16 a[206:207], v89 offset:6336
    v_mfma_f32_16x16x32_bf16 v[116:119], a[212:215], v[144:147], v[116:119]
    s_mov_b32 s45, 14976
    buffer_load_dwordx4 v20, s[20:23], s45 offen lds
    v_mfma_f32_16x16x32_bf16 v[112:115], a[216:219], v[152:155], v[112:115]
    s_waitcnt lgkmcnt(6)
    ds_read_b64_tr_b16 a[208:209], v88 offset:8448
    ds_read_b64_tr_b16 a[210:211], v88 offset:10560
    v_mfma_f32_16x16x32_bf16 v[120:123], a[216:219], v[156:159], v[120:123]
    v_mfma_f32_16x16x32_bf16 v[124:127], a[220:223], v[156:159], v[124:127]
    s_add_u32 m0, s38, 20064
    ds_read_b64_tr_b16 a[212:213], v89 offset:8448
    ds_read_b64_tr_b16 a[214:215], v89 offset:10560
    v_mfma_f32_16x16x32_bf16 v[116:119], a[220:223], v[152:155], v[116:119]
    s_mov_b32 s45, 22144
    buffer_load_dwordx4 v20, s[20:23], s45 offen lds
    v_mfma_f32_16x16x32_bf16 v[96:99], a[192:195], v[160:163], v[96:99]
    s_waitcnt lgkmcnt(6)
    ds_read_b64_tr_b16 a[216:217], v88 offset:12672
    ds_read_b64_tr_b16 a[218:219], v88 offset:14784
    s_waitcnt vmcnt(28)
    v_mfma_f32_16x16x32_bf16 v[104:107], a[192:195], v[164:167], v[104:107]
    s_barrier
    v_mfma_f32_16x16x32_bf16 v[108:111], a[196:199], v[164:167], v[108:111]
    s_add_u32 m0, s38, 118272
    ds_read_b64_tr_b16 a[220:221], v89 offset:12672
    ds_read_b64_tr_b16 a[222:223], v89 offset:14784
    v_mfma_f32_16x16x32_bf16 v[100:103], a[196:199], v[160:163], v[100:103]
    s_mov_b32 s45, 115328
    buffer_load_dwordx4 v20, s[20:23], s45 offen lds
    v_mfma_f32_16x16x32_bf16 v[96:99], a[200:203], v[168:171], v[96:99]
    s_waitcnt lgkmcnt(6)
    ds_read_b64_tr_b16 a[192:193], v90 offset:0
    ds_read_b64_tr_b16 a[194:195], v90 offset:2112
    v_mfma_f32_16x16x32_bf16 v[104:107], a[200:203], v[172:175], v[104:107]
    v_mfma_f32_16x16x32_bf16 v[108:111], a[204:207], v[172:175], v[108:111]
    s_add_u32 m0, s38, 119328
    ds_read_b64_tr_b16 a[196:197], v91 offset:0
    ds_read_b64_tr_b16 a[198:199], v91 offset:2112
    v_mfma_f32_16x16x32_bf16 v[100:103], a[204:207], v[168:171], v[100:103]
    s_mov_b32 s45, 122496
    buffer_load_dwordx4 v20, s[20:23], s45 offen lds
    v_mfma_f32_16x16x32_bf16 v[96:99], a[208:211], v[176:179], v[96:99]
    s_waitcnt lgkmcnt(6)
    ds_read_b64_tr_b16 a[200:201], v90 offset:4224
    ds_read_b64_tr_b16 a[202:203], v90 offset:6336
    v_mfma_f32_16x16x32_bf16 v[104:107], a[208:211], v[180:183], v[104:107]
    v_mfma_f32_16x16x32_bf16 v[108:111], a[212:215], v[180:183], v[108:111]
    s_add_u32 m0, s38, 120384
    ds_read_b64_tr_b16 a[204:205], v91 offset:4224
    ds_read_b64_tr_b16 a[206:207], v91 offset:6336
    v_mfma_f32_16x16x32_bf16 v[100:103], a[212:215], v[176:179], v[100:103]
    s_mov_b32 s45, 129664
    buffer_load_dwordx4 v20, s[20:23], s45 offen lds
    v_mfma_f32_16x16x32_bf16 v[96:99], a[216:219], v[184:187], v[96:99]
    s_waitcnt lgkmcnt(6)
    ds_read_b64_tr_b16 a[208:209], v90 offset:8448
    ds_read_b64_tr_b16 a[210:211], v90 offset:10560
    v_mfma_f32_16x16x32_bf16 v[104:107], a[216:219], v[188:191], v[104:107]
    v_mfma_f32_16x16x32_bf16 v[108:111], a[220:223], v[188:191], v[108:111]
    s_add_u32 m0, s38, 121440
    ds_read_b64_tr_b16 a[212:213], v91 offset:8448
    ds_read_b64_tr_b16 a[214:215], v91 offset:10560
    v_mfma_f32_16x16x32_bf16 v[100:103], a[220:223], v[184:187], v[100:103]
    s_mov_b32 s45, 136832
    buffer_load_dwordx4 v20, s[20:23], s45 offen lds
    v_mfma_f32_16x16x32_bf16 v[112:115], a[192:195], v[160:163], v[112:115]
    s_waitcnt lgkmcnt(6)
    ds_read_b64_tr_b16 a[216:217], v90 offset:12672
    ds_read_b64_tr_b16 a[218:219], v90 offset:14784
    v_mfma_f32_16x16x32_bf16 v[120:123], a[192:195], v[164:167], v[120:123]
    v_mfma_f32_16x16x32_bf16 v[124:127], a[196:199], v[164:167], v[124:127]
    s_nop 0
    ds_read_b64_tr_b16 a[220:221], v91 offset:12672
    ds_read_b64_tr_b16 a[222:223], v91 offset:14784
    v_mfma_f32_16x16x32_bf16 v[116:119], a[196:199], v[160:163], v[116:119]
    v_cvt_pk_bf16_f32 v64, v96, v97
    v_cvt_pk_bf16_f32 v65, v98, v99
    v_mfma_f32_16x16x32_bf16 v[112:115], a[200:203], v[168:171], v[112:115]
    s_waitcnt lgkmcnt(6)
    ds_read_b64_tr_b16 a[192:193], v80 offset:33792
    ds_read_b64_tr_b16 a[194:195], v80 offset:35904
    v_mfma_f32_16x16x32_bf16 v[120:123], a[200:203], v[172:175], v[120:123]
    v_mfma_f32_16x16x32_bf16 v[124:127], a[204:207], v[172:175], v[124:127]
    s_nop 0
    ds_read_b64_tr_b16 a[196:197], v81 offset:33792
    ds_read_b64_tr_b16 a[198:199], v81 offset:35904
    v_mfma_f32_16x16x32_bf16 v[116:119], a[204:207], v[168:171], v[116:119]
    v_cvt_pk_bf16_f32 v66, v100, v101
    v_cvt_pk_bf16_f32 v67, v102, v103
    v_mfma_f32_16x16x32_bf16 v[112:115], a[208:211], v[176:179], v[112:115]
    s_waitcnt lgkmcnt(6)
    ds_read_b64_tr_b16 a[200:201], v80 offset:38016
    ds_read_b64_tr_b16 a[202:203], v80 offset:40128
    v_mfma_f32_16x16x32_bf16 v[120:123], a[208:211], v[180:183], v[120:123]
    v_mfma_f32_16x16x32_bf16 v[124:127], a[212:215], v[180:183], v[124:127]
    s_nop 0
    ds_read_b64_tr_b16 a[204:205], v81 offset:38016
    ds_read_b64_tr_b16 a[206:207], v81 offset:40128
    v_mfma_f32_16x16x32_bf16 v[116:119], a[212:215], v[176:179], v[116:119]
    v_cvt_pk_bf16_f32 v68, v104, v105
    v_cvt_pk_bf16_f32 v69, v106, v107
    v_mfma_f32_16x16x32_bf16 v[112:115], a[216:219], v[184:187], v[112:115]
    s_waitcnt lgkmcnt(6)
    ds_read_b64_tr_b16 a[208:209], v80 offset:42240
    ds_read_b64_tr_b16 a[210:211], v80 offset:44352
    v_mfma_f32_16x16x32_bf16 v[120:123], a[216:219], v[188:191], v[120:123]
    v_cvt_pk_bf16_f32 v70, v108, v109
    v_cvt_pk_bf16_f32 v71, v110, v111
    v_mfma_f32_16x16x32_bf16 v[124:127], a[220:223], v[188:191], v[124:127]
    s_nop 0
    ds_read_b64_tr_b16 a[212:213], v81 offset:42240
    ds_read_b64_tr_b16 a[214:215], v81 offset:44352
    v_mfma_f32_16x16x32_bf16 v[116:119], a[220:223], v[184:187], v[116:119]
    s_nop 0
    buffer_store_dwordx4 v[64:67], v16, s[24:27], s43 offen offset:0 sc1
    v_mfma_f32_16x16x32_bf16 v[96:99], a[192:195], v[128:131], 0
    s_waitcnt lgkmcnt(6)
    ds_read_b64_tr_b16 a[216:217], v80 offset:46464
    ds_read_b64_tr_b16 a[218:219], v80 offset:48576
    s_waitcnt vmcnt(29)
    v_mfma_f32_16x16x32_bf16 v[104:107], a[192:195], v[132:135], 0
    s_barrier
    v_mfma_f32_16x16x32_bf16 v[108:111], a[196:199], v[132:135], 0
    s_nop 0
    ds_read_b64_tr_b16 a[220:221], v81 offset:46464
    ds_read_b64_tr_b16 a[222:223], v81 offset:48576
    v_mfma_f32_16x16x32_bf16 v[100:103], a[196:199], v[128:131], 0
    s_nop 0
    buffer_store_dwordx4 v[68:71], v16, s[24:27], s43 offen offset:1024 sc1
    v_mfma_f32_16x16x32_bf16 v[96:99], a[200:203], v[136:139], v[96:99]
    s_waitcnt lgkmcnt(6)
    ds_read_b64_tr_b16 a[192:193], v82 offset:33792
    ds_read_b64_tr_b16 a[194:195], v82 offset:35904
    v_mfma_f32_16x16x32_bf16 v[104:107], a[200:203], v[140:143], v[104:107]
    v_cvt_pk_bf16_f32 v72, v112, v113
    v_cvt_pk_bf16_f32 v73, v114, v115
    v_mfma_f32_16x16x32_bf16 v[108:111], a[204:207], v[140:143], v[108:111]
    s_nop 0
    ds_read_b64_tr_b16 a[196:197], v83 offset:33792
    ds_read_b64_tr_b16 a[198:199], v83 offset:35904
    v_mfma_f32_16x16x32_bf16 v[100:103], a[204:207], v[136:139], v[100:103]
    v_mfma_f32_16x16x32_bf16 v[96:99], a[208:211], v[144:147], v[96:99]
    s_waitcnt lgkmcnt(6)
    ds_read_b64_tr_b16 a[200:201], v82 offset:38016
    ds_read_b64_tr_b16 a[202:203], v82 offset:40128
    v_mfma_f32_16x16x32_bf16 v[104:107], a[208:211], v[148:151], v[104:107]
    v_cvt_pk_bf16_f32 v74, v116, v117
    v_cvt_pk_bf16_f32 v75, v118, v119
    v_mfma_f32_16x16x32_bf16 v[108:111], a[212:215], v[148:151], v[108:111]
    s_nop 0
    ds_read_b64_tr_b16 a[204:205], v83 offset:38016
    ds_read_b64_tr_b16 a[206:207], v83 offset:40128
    v_mfma_f32_16x16x32_bf16 v[100:103], a[212:215], v[144:147], v[100:103]
    v_mfma_f32_16x16x32_bf16 v[96:99], a[216:219], v[152:155], v[96:99]
    s_waitcnt lgkmcnt(6)
    ds_read_b64_tr_b16 a[208:209], v82 offset:42240
    ds_read_b64_tr_b16 a[210:211], v82 offset:44352
    v_mfma_f32_16x16x32_bf16 v[104:107], a[216:219], v[156:159], v[104:107]
    v_cvt_pk_bf16_f32 v76, v120, v121
    v_cvt_pk_bf16_f32 v77, v122, v123
    v_mfma_f32_16x16x32_bf16 v[108:111], a[220:223], v[156:159], v[108:111]
    s_nop 0
    ds_read_b64_tr_b16 a[212:213], v83 offset:42240
    ds_read_b64_tr_b16 a[214:215], v83 offset:44352
    v_mfma_f32_16x16x32_bf16 v[100:103], a[220:223], v[152:155], v[100:103]
    v_cvt_pk_bf16_f32 v78, v124, v125
    v_cvt_pk_bf16_f32 v79, v126, v127
    v_mfma_f32_16x16x32_bf16 v[112:115], a[192:195], v[128:131], 0
    s_waitcnt lgkmcnt(6)
    ds_read_b64_tr_b16 a[216:217], v82 offset:46464
    ds_read_b64_tr_b16 a[218:219], v82 offset:48576
    v_mfma_f32_16x16x32_bf16 v[120:123], a[192:195], v[132:135], 0
    s_nop 0
    buffer_store_dwordx4 v[72:75], v16, s[24:27], s43 offen offset:2048 sc1
    v_mfma_f32_16x16x32_bf16 v[124:127], a[196:199], v[132:135], 0
    s_add_u32 m0, s38, 101376
    ds_read_b64_tr_b16 a[220:221], v83 offset:46464
    ds_read_b64_tr_b16 a[222:223], v83 offset:48576
    v_mfma_f32_16x16x32_bf16 v[116:119], a[196:199], v[128:131], 0
    s_mov_b32 s45, 768
    buffer_load_dwordx4 v20, s[20:23], s45 offen lds
    v_mfma_f32_16x16x32_bf16 v[112:115], a[200:203], v[136:139], v[112:115]
    s_waitcnt lgkmcnt(6)
    ds_read_b64_tr_b16 a[192:193], v84 offset:0
    ds_read_b64_tr_b16 a[194:195], v84 offset:2112
    v_mfma_f32_16x16x32_bf16 v[120:123], a[200:203], v[140:143], v[120:123]
    s_nop 0
    buffer_store_dwordx4 v[76:79], v16, s[24:27], s43 offen offset:3072 sc1
    v_mfma_f32_16x16x32_bf16 v[124:127], a[204:207], v[140:143], v[124:127]
    s_add_u32 m0, s38, 102432
    ds_read_b64_tr_b16 a[196:197], v85 offset:0
    ds_read_b64_tr_b16 a[198:199], v85 offset:2112
    v_mfma_f32_16x16x32_bf16 v[116:119], a[204:207], v[136:139], v[116:119]
    s_mov_b32 s45, 7936
    buffer_load_dwordx4 v20, s[20:23], s45 offen lds
    v_mfma_f32_16x16x32_bf16 v[112:115], a[208:211], v[144:147], v[112:115]
    s_waitcnt lgkmcnt(6)
    ds_read_b64_tr_b16 a[200:201], v84 offset:4224
    ds_read_b64_tr_b16 a[202:203], v84 offset:6336
    v_mfma_f32_16x16x32_bf16 v[120:123], a[208:211], v[148:151], v[120:123]
    s_add_u32 s43, s43, 4096
    v_mfma_f32_16x16x32_bf16 v[124:127], a[212:215], v[148:151], v[124:127]
    s_add_u32 m0, s38, 103488
    ds_read_b64_tr_b16 a[204:205], v85 offset:4224
    ds_read_b64_tr_b16 a[206:207], v85 offset:6336
    v_mfma_f32_16x16x32_bf16 v[116:119], a[212:215], v[144:147], v[116:119]
    s_mov_b32 s45, 15104
    buffer_load_dwordx4 v20, s[20:23], s45 offen lds
    v_mfma_f32_16x16x32_bf16 v[112:115], a[216:219], v[152:155], v[112:115]
    s_waitcnt lgkmcnt(6)
    ds_read_b64_tr_b16 a[208:209], v84 offset:8448
    ds_read_b64_tr_b16 a[210:211], v84 offset:10560
    v_mfma_f32_16x16x32_bf16 v[120:123], a[216:219], v[156:159], v[120:123]
    v_mfma_f32_16x16x32_bf16 v[124:127], a[220:223], v[156:159], v[124:127]
    s_add_u32 m0, s38, 104544
    ds_read_b64_tr_b16 a[212:213], v85 offset:8448
    ds_read_b64_tr_b16 a[214:215], v85 offset:10560
    v_mfma_f32_16x16x32_bf16 v[116:119], a[220:223], v[152:155], v[116:119]
    s_mov_b32 s45, 22272
    buffer_load_dwordx4 v20, s[20:23], s45 offen lds
    v_mfma_f32_16x16x32_bf16 v[96:99], a[192:195], v[160:163], v[96:99]
    s_waitcnt lgkmcnt(6)
    ds_read_b64_tr_b16 a[216:217], v84 offset:12672
    ds_read_b64_tr_b16 a[218:219], v84 offset:14784
    s_waitcnt vmcnt(32)
    v_mfma_f32_16x16x32_bf16 v[104:107], a[192:195], v[164:167], v[104:107]
    s_barrier
    v_mfma_f32_16x16x32_bf16 v[108:111], a[196:199], v[164:167], v[108:111]
    s_add_u32 m0, s38, 33792
    ds_read_b64_tr_b16 a[220:221], v85 offset:12672
    ds_read_b64_tr_b16 a[222:223], v85 offset:14784
    v_mfma_f32_16x16x32_bf16 v[100:103], a[196:199], v[160:163], v[100:103]
    s_mov_b32 s45, 115456
    buffer_load_dwordx4 v20, s[20:23], s45 offen lds
    v_mfma_f32_16x16x32_bf16 v[96:99], a[200:203], v[168:171], v[96:99]
    s_waitcnt lgkmcnt(6)
    ds_read_b64_tr_b16 a[192:193], v86 offset:0
    ds_read_b64_tr_b16 a[194:195], v86 offset:2112
    v_mfma_f32_16x16x32_bf16 v[104:107], a[200:203], v[172:175], v[104:107]
    v_mfma_f32_16x16x32_bf16 v[108:111], a[204:207], v[172:175], v[108:111]
    s_add_u32 m0, s38, 34848
    ds_read_b64_tr_b16 a[196:197], v87 offset:0
    ds_read_b64_tr_b16 a[198:199], v87 offset:2112
    v_mfma_f32_16x16x32_bf16 v[100:103], a[204:207], v[168:171], v[100:103]
    s_mov_b32 s45, 122624
    buffer_load_dwordx4 v20, s[20:23], s45 offen lds
    v_mfma_f32_16x16x32_bf16 v[96:99], a[208:211], v[176:179], v[96:99]
    s_waitcnt lgkmcnt(6)
    ds_read_b64_tr_b16 a[200:201], v86 offset:4224
    ds_read_b64_tr_b16 a[202:203], v86 offset:6336
    v_mfma_f32_16x16x32_bf16 v[104:107], a[208:211], v[180:183], v[104:107]
    v_mfma_f32_16x16x32_bf16 v[108:111], a[212:215], v[180:183], v[108:111]
    s_add_u32 m0, s38, 35904
    ds_read_b64_tr_b16 a[204:205], v87 offset:4224
    ds_read_b64_tr_b16 a[206:207], v87 offset:6336
    v_mfma_f32_16x16x32_bf16 v[100:103], a[212:215], v[176:179], v[100:103]
    s_mov_b32 s45, 129792
    buffer_load_dwordx4 v20, s[20:23], s45 offen lds
    v_mfma_f32_16x16x32_bf16 v[96:99], a[216:219], v[184:187], v[96:99]
    s_waitcnt lgkmcnt(6)
    ds_read_b64_tr_b16 a[208:209], v86 offset:8448
    ds_read_b64_tr_b16 a[210:211], v86 offset:10560
    v_mfma_f32_16x16x32_bf16 v[104:107], a[216:219], v[188:191], v[104:107]
    v_mfma_f32_16x16x32_bf16 v[108:111], a[220:223], v[188:191], v[108:111]
    s_add_u32 m0, s38, 36960
    ds_read_b64_tr_b16 a[212:213], v87 offset:8448
    ds_read_b64_tr_b16 a[214:215], v87 offset:10560
    v_mfma_f32_16x16x32_bf16 v[100:103], a[220:223], v[184:187], v[100:103]
    s_mov_b32 s45, 136960
    buffer_load_dwordx4 v20, s[20:23], s45 offen lds
    v_mfma_f32_16x16x32_bf16 v[112:115], a[192:195], v[160:163], v[112:115]
    s_waitcnt lgkmcnt(6)
    ds_read_b64_tr_b16 a[216:217], v86 offset:12672
    ds_read_b64_tr_b16 a[218:219], v86 offset:14784
    v_mfma_f32_16x16x32_bf16 v[120:123], a[192:195], v[164:167], v[120:123]
    v_mul_i32_i24 v27, s55, v27
    v_add3_u32 v92, v26, v27, s54
    v_mfma_f32_16x16x32_bf16 v[124:127], a[196:199], v[164:167], v[124:127]
    s_nop 0
    ds_read_b64_tr_b16 a[220:221], v87 offset:12672
    ds_read_b64_tr_b16 a[222:223], v87 offset:14784
    v_mfma_f32_16x16x32_bf16 v[116:119], a[196:199], v[160:163], v[116:119]
    v_cvt_pk_bf16_f32 v64, v96, v97
    v_cvt_pk_bf16_f32 v65, v98, v99
    v_mfma_f32_16x16x32_bf16 v[112:115], a[200:203], v[168:171], v[112:115]
    s_waitcnt lgkmcnt(6)
    ds_read_b64_tr_b16 a[192:193], v84 offset:16896
    ds_read_b64_tr_b16 a[194:195], v84 offset:19008
    v_mfma_f32_16x16x32_bf16 v[120:123], a[200:203], v[172:175], v[120:123]
    v_mfma_f32_16x16x32_bf16 v[124:127], a[204:207], v[172:175], v[124:127]
    s_nop 0
    ds_read_b64_tr_b16 a[196:197], v85 offset:16896
    ds_read_b64_tr_b16 a[198:199], v85 offset:19008
    v_mfma_f32_16x16x32_bf16 v[116:119], a[204:207], v[168:171], v[116:119]
    v_cvt_pk_bf16_f32 v66, v100, v101
    v_cvt_pk_bf16_f32 v67, v102, v103
    v_mfma_f32_16x16x32_bf16 v[112:115], a[208:211], v[176:179], v[112:115]
    s_waitcnt lgkmcnt(6)
    ds_read_b64_tr_b16 a[200:201], v84 offset:21120
    ds_read_b64_tr_b16 a[202:203], v84 offset:23232
    v_mfma_f32_16x16x32_bf16 v[120:123], a[208:211], v[180:183], v[120:123]
    v_mfma_f32_16x16x32_bf16 v[124:127], a[212:215], v[180:183], v[124:127]
    s_nop 0
    ds_read_b64_tr_b16 a[204:205], v85 offset:21120
    ds_read_b64_tr_b16 a[206:207], v85 offset:23232
    v_mfma_f32_16x16x32_bf16 v[116:119], a[212:215], v[176:179], v[116:119]
    v_cvt_pk_bf16_f32 v68, v104, v105
    v_cvt_pk_bf16_f32 v69, v106, v107
    v_mfma_f32_16x16x32_bf16 v[112:115], a[216:219], v[184:187], v[112:115]
    s_waitcnt lgkmcnt(6)
    ds_read_b64_tr_b16 a[208:209], v84 offset:25344
    ds_read_b64_tr_b16 a[210:211], v84 offset:27456
    v_mfma_f32_16x16x32_bf16 v[120:123], a[216:219], v[188:191], v[120:123]
    v_cvt_pk_bf16_f32 v70, v108, v109
    v_cvt_pk_bf16_f32 v71, v110, v111
    v_mfma_f32_16x16x32_bf16 v[124:127], a[220:223], v[188:191], v[124:127]
    s_nop 0
    ds_read_b64_tr_b16 a[212:213], v85 offset:25344
    ds_read_b64_tr_b16 a[214:215], v85 offset:27456
    v_mfma_f32_16x16x32_bf16 v[116:119], a[220:223], v[184:187], v[116:119]
    s_nop 0
    buffer_store_dwordx4 v[64:67], v16, s[24:27], s43 offen offset:0 sc1
    v_mfma_f32_16x16x32_bf16 v[96:99], a[192:195], v[128:131], 0
    s_waitcnt lgkmcnt(6)
    ds_read_b64_tr_b16 a[216:217], v84 offset:29568
    ds_read_b64_tr_b16 a[218:219], v84 offset:31680
    s_waitcnt vmcnt(33)
    v_mfma_f32_16x16x32_bf16 v[104:107], a[192:195], v[132:135], 0
    s_barrier
    v_mfma_f32_16x16x32_bf16 v[108:111], a[196:199], v[132:135], 0
    s_nop 0
    ds_read_b64_tr_b16 a[220:221], v85 offset:29568
    ds_read_b64_tr_b16 a[222:223], v85 offset:31680
    v_mfma_f32_16x16x32_bf16 v[100:103], a[196:199], v[128:131], 0
    s_nop 0
    buffer_store_dwordx4 v[68:71], v16, s[24:27], s43 offen offset:1024 sc1
    v_mfma_f32_16x16x32_bf16 v[96:99], a[200:203], v[136:139], v[96:99]
    s_waitcnt lgkmcnt(6)
    ds_read_b64_tr_b16 a[192:193], v86 offset:16896
    ds_read_b64_tr_b16 a[194:195], v86 offset:19008
    v_mfma_f32_16x16x32_bf16 v[104:107], a[200:203], v[140:143], v[104:107]
    v_cvt_pk_bf16_f32 v72, v112, v113
    v_cvt_pk_bf16_f32 v73, v114, v115
    v_mfma_f32_16x16x32_bf16 v[108:111], a[204:207], v[140:143], v[108:111]
    s_nop 0
    ds_read_b64_tr_b16 a[196:197], v87 offset:16896
    ds_read_b64_tr_b16 a[198:199], v87 offset:19008
    v_mfma_f32_16x16x32_bf16 v[100:103], a[204:207], v[136:139], v[100:103]
    v_mfma_f32_16x16x32_bf16 v[96:99], a[208:211], v[144:147], v[96:99]
    s_waitcnt lgkmcnt(6)
    ds_read_b64_tr_b16 a[200:201], v86 offset:21120
    ds_read_b64_tr_b16 a[202:203], v86 offset:23232
    v_mfma_f32_16x16x32_bf16 v[104:107], a[208:211], v[148:151], v[104:107]
    v_cvt_pk_bf16_f32 v74, v116, v117
    v_cvt_pk_bf16_f32 v75, v118, v119
    v_mfma_f32_16x16x32_bf16 v[108:111], a[212:215], v[148:151], v[108:111]
    s_nop 0
    ds_read_b64_tr_b16 a[204:205], v87 offset:21120
    ds_read_b64_tr_b16 a[206:207], v87 offset:23232
    v_mfma_f32_16x16x32_bf16 v[100:103], a[212:215], v[144:147], v[100:103]
    v_mfma_f32_16x16x32_bf16 v[96:99], a[216:219], v[152:155], v[96:99]
    s_waitcnt lgkmcnt(6)
    ds_read_b64_tr_b16 a[208:209], v86 offset:25344
    ds_read_b64_tr_b16 a[210:211], v86 offset:27456
    v_mfma_f32_16x16x32_bf16 v[104:107], a[216:219], v[156:159], v[104:107]
    v_cvt_pk_bf16_f32 v76, v120, v121
    v_cvt_pk_bf16_f32 v77, v122, v123
    v_mfma_f32_16x16x32_bf16 v[108:111], a[220:223], v[156:159], v[108:111]
    s_nop 0
    ds_read_b64_tr_b16 a[212:213], v87 offset:25344
    ds_read_b64_tr_b16 a[214:215], v87 offset:27456
    v_mfma_f32_16x16x32_bf16 v[100:103], a[220:223], v[152:155], v[100:103]
    v_cvt_pk_bf16_f32 v78, v124, v125
    v_cvt_pk_bf16_f32 v79, v126, v127
    v_mfma_f32_16x16x32_bf16 v[112:115], a[192:195], v[128:131], 0
    s_waitcnt lgkmcnt(6)
    ds_read_b64_tr_b16 a[216:217], v86 offset:29568
    ds_read_b64_tr_b16 a[218:219], v86 offset:31680
    v_mfma_f32_16x16x32_bf16 v[120:123], a[192:195], v[132:135], 0
    s_nop 0
    buffer_store_dwordx4 v[72:75], v16, s[24:27], s43 offen offset:2048 sc1
    v_mfma_f32_16x16x32_bf16 v[124:127], a[196:199], v[132:135], 0
    s_nop 0
    ds_read_b64_tr_b16 a[220:221], v87 offset:29568
    ds_read_b64_tr_b16 a[222:223], v87 offset:31680
    v_mfma_f32_16x16x32_bf16 v[116:119], a[196:199], v[128:131], 0
    v_mfma_f32_16x16x32_bf16 v[112:115], a[200:203], v[136:139], v[112:115]
    s_waitcnt lgkmcnt(6)
    ds_read_b64_tr_b16 a[192:193], v84 offset:33792
    ds_read_b64_tr_b16 a[194:195], v84 offset:35904
    v_mfma_f32_16x16x32_bf16 v[120:123], a[200:203], v[140:143], v[120:123]
    s_nop 0
    buffer_store_dwordx4 v[76:79], v16, s[24:27], s43 offen offset:3072 sc1
    v_mfma_f32_16x16x32_bf16 v[124:127], a[204:207], v[140:143], v[124:127]
    s_nop 0
    ds_read_b64_tr_b16 a[196:197], v85 offset:33792
    ds_read_b64_tr_b16 a[198:199], v85 offset:35904
    v_mfma_f32_16x16x32_bf16 v[116:119], a[204:207], v[136:139], v[116:119]
    v_mfma_f32_16x16x32_bf16 v[112:115], a[208:211], v[144:147], v[112:115]
    s_waitcnt lgkmcnt(6)
    ds_read_b64_tr_b16 a[200:201], v84 offset:38016
    ds_read_b64_tr_b16 a[202:203], v84 offset:40128
    v_mfma_f32_16x16x32_bf16 v[120:123], a[208:211], v[148:151], v[120:123]
    s_add_u32 s43, s43, 4096
    v_mfma_f32_16x16x32_bf16 v[124:127], a[212:215], v[148:151], v[124:127]
    s_nop 0
    ds_read_b64_tr_b16 a[204:205], v85 offset:38016
    ds_read_b64_tr_b16 a[206:207], v85 offset:40128
    v_mfma_f32_16x16x32_bf16 v[116:119], a[212:215], v[144:147], v[116:119]
    v_mfma_f32_16x16x32_bf16 v[112:115], a[216:219], v[152:155], v[112:115]
    s_waitcnt lgkmcnt(6)
    ds_read_b64_tr_b16 a[208:209], v84 offset:42240
    ds_read_b64_tr_b16 a[210:211], v84 offset:44352
    v_mfma_f32_16x16x32_bf16 v[120:123], a[216:219], v[156:159], v[120:123]
    v_mfma_f32_16x16x32_bf16 v[124:127], a[220:223], v[156:159], v[124:127]
    s_nop 0
    ds_read_b64_tr_b16 a[212:213], v85 offset:42240
    ds_read_b64_tr_b16 a[214:215], v85 offset:44352
    v_mfma_f32_16x16x32_bf16 v[116:119], a[220:223], v[152:155], v[116:119]
    v_mfma_f32_16x16x32_bf16 v[96:99], a[192:195], v[160:163], v[96:99]
    s_waitcnt lgkmcnt(6)
    ds_read_b64_tr_b16 a[216:217], v84 offset:46464
    ds_read_b64_tr_b16 a[218:219], v84 offset:48576
    s_waitcnt vmcnt(32)
    v_mfma_f32_16x16x32_bf16 v[104:107], a[192:195], v[164:167], v[104:107]
    s_barrier
    v_mfma_f32_16x16x32_bf16 v[108:111], a[196:199], v[164:167], v[108:111]
    s_nop 0
    ds_read_b64_tr_b16 a[220:221], v85 offset:46464
    ds_read_b64_tr_b16 a[222:223], v85 offset:48576
    v_mfma_f32_16x16x32_bf16 v[100:103], a[196:199], v[160:163], v[100:103]
    v_mfma_f32_16x16x32_bf16 v[96:99], a[200:203], v[168:171], v[96:99]
    s_waitcnt lgkmcnt(6)
    ds_read_b64_tr_b16 a[192:193], v86 offset:33792
    ds_read_b64_tr_b16 a[194:195], v86 offset:35904
    v_mfma_f32_16x16x32_bf16 v[104:107], a[200:203], v[172:175], v[104:107]
    v_mfma_f32_16x16x32_bf16 v[108:111], a[204:207], v[172:175], v[108:111]
    s_nop 0
    ds_read_b64_tr_b16 a[196:197], v87 offset:33792
    ds_read_b64_tr_b16 a[198:199], v87 offset:35904
    v_mfma_f32_16x16x32_bf16 v[100:103], a[204:207], v[168:171], v[100:103]
    v_mfma_f32_16x16x32_bf16 v[96:99], a[208:211], v[176:179], v[96:99]
    s_waitcnt lgkmcnt(6)
    ds_read_b64_tr_b16 a[200:201], v86 offset:38016
    ds_read_b64_tr_b16 a[202:203], v86 offset:40128
    v_mfma_f32_16x16x32_bf16 v[104:107], a[208:211], v[180:183], v[104:107]
    v_mfma_f32_16x16x32_bf16 v[108:111], a[212:215], v[180:183], v[108:111]
    s_nop 0
    ds_read_b64_tr_b16 a[204:205], v87 offset:38016
    ds_read_b64_tr_b16 a[206:207], v87 offset:40128
    v_mfma_f32_16x16x32_bf16 v[100:103], a[212:215], v[176:179], v[100:103]
    v_mfma_f32_16x16x32_bf16 v[96:99], a[216:219], v[184:187], v[96:99]
    s_waitcnt lgkmcnt(6)
    ds_read_b64_tr_b16 a[208:209], v86 offset:42240
    ds_read_b64_tr_b16 a[210:211], v86 offset:44352
    v_mfma_f32_16x16x32_bf16 v[104:107], a[216:219], v[188:191], v[104:107]
    v_mfma_f32_16x16x32_bf16 v[108:111], a[220:223], v[188:191], v[108:111]
    s_nop 0
    ds_read_b64_tr_b16 a[212:213], v87 offset:42240
    ds_read_b64_tr_b16 a[214:215], v87 offset:44352
    v_mfma_f32_16x16x32_bf16 v[100:103], a[220:223], v[184:187], v[100:103]
    v_mfma_f32_16x16x32_bf16 v[112:115], a[192:195], v[160:163], v[112:115]
    s_waitcnt lgkmcnt(6)
    ds_read_b64_tr_b16 a[216:217], v86 offset:46464
    ds_read_b64_tr_b16 a[218:219], v86 offset:48576
    v_mfma_f32_16x16x32_bf16 v[120:123], a[192:195], v[164:167], v[120:123]
    v_mfma_f32_16x16x32_bf16 v[124:127], a[196:199], v[164:167], v[124:127]
    s_nop 0
    ds_read_b64_tr_b16 a[220:221], v87 offset:46464
    ds_read_b64_tr_b16 a[222:223], v87 offset:48576
    v_mfma_f32_16x16x32_bf16 v[116:119], a[196:199], v[160:163], v[116:119]
    v_cvt_pk_bf16_f32 v64, v96, v97
    v_cvt_pk_bf16_f32 v65, v98, v99
    v_mfma_f32_16x16x32_bf16 v[112:115], a[200:203], v[168:171], v[112:115]
    s_waitcnt lgkmcnt(6)
    ds_read_b64_tr_b16 a[192:193], v80 offset:0
    ds_read_b64_tr_b16 a[194:195], v80 offset:2112
    v_mfma_f32_16x16x32_bf16 v[120:123], a[200:203], v[172:175], v[120:123]
    v_mfma_f32_16x16x32_bf16 v[124:127], a[204:207], v[172:175], v[124:127]
    s_nop 0
    ds_read_b64_tr_b16 a[196:197], v81 offset:0
    ds_read_b64_tr_b16 a[198:199], v81 offset:2112
    v_mfma_f32_16x16x32_bf16 v[116:119], a[204:207], v[168:171], v[116:119]
    v_cvt_pk_bf16_f32 v66, v100, v101
    v_cvt_pk_bf16_f32 v67, v102, v103
    v_mfma_f32_16x16x32_bf16 v[112:115], a[208:211], v[176:179], v[112:115]
    s_waitcnt lgkmcnt(6)
    ds_read_b64_tr_b16 a[200:201], v80 offset:4224
    ds_read_b64_tr_b16 a[202:203], v80 offset:6336
    v_mfma_f32_16x16x32_bf16 v[120:123], a[208:211], v[180:183], v[120:123]
    v_mfma_f32_16x16x32_bf16 v[124:127], a[212:215], v[180:183], v[124:127]
    s_nop 0
    ds_read_b64_tr_b16 a[204:205], v81 offset:4224
    ds_read_b64_tr_b16 a[206:207], v81 offset:6336
    v_mfma_f32_16x16x32_bf16 v[116:119], a[212:215], v[176:179], v[116:119]
    v_cvt_pk_bf16_f32 v68, v104, v105
    v_cvt_pk_bf16_f32 v69, v106, v107
    v_mfma_f32_16x16x32_bf16 v[112:115], a[216:219], v[184:187], v[112:115]
    s_waitcnt lgkmcnt(6)
    ds_read_b64_tr_b16 a[208:209], v80 offset:8448
    ds_read_b64_tr_b16 a[210:211], v80 offset:10560
    v_mfma_f32_16x16x32_bf16 v[120:123], a[216:219], v[188:191], v[120:123]
    v_cvt_pk_bf16_f32 v70, v108, v109
    v_cvt_pk_bf16_f32 v71, v110, v111
    v_mfma_f32_16x16x32_bf16 v[124:127], a[220:223], v[188:191], v[124:127]
    s_nop 0
    ds_read_b64_tr_b16 a[212:213], v81 offset:8448
    ds_read_b64_tr_b16 a[214:215], v81 offset:10560
    v_mfma_f32_16x16x32_bf16 v[116:119], a[220:223], v[184:187], v[116:119]
    s_nop 0
    buffer_store_dwordx4 v[64:67], v16, s[24:27], s43 offen offset:0 sc1
    v_mfma_f32_16x16x32_bf16 v[96:99], a[192:195], v[128:131], 0
    s_waitcnt lgkmcnt(6)
    ds_read_b64_tr_b16 a[216:217], v80 offset:12672
    ds_read_b64_tr_b16 a[218:219], v80 offset:14784
    s_waitcnt vmcnt(29)
    v_mfma_f32_16x16x32_bf16 v[104:107], a[192:195], v[132:135], 0
    s_barrier
    v_mfma_f32_16x16x32_bf16 v[108:111], a[196:199], v[132:135], 0
    s_nop 0
    ds_read_b64_tr_b16 a[220:221], v81 offset:12672
    ds_read_b64_tr_b16 a[222:223], v81 offset:14784
    v_mfma_f32_16x16x32_bf16 v[100:103], a[196:199], v[128:131], 0
    s_nop 0
    buffer_store_dwordx4 v[68:71], v16, s[24:27], s43 offen offset:1024 sc1
    v_mfma_f32_16x16x32_bf16 v[96:99], a[200:203], v[136:139], v[96:99]
    s_waitcnt lgkmcnt(6)
    ds_read_b64_tr_b16 a[192:193], v82 offset:0
    ds_read_b64_tr_b16 a[194:195], v82 offset:2112
    v_mfma_f32_16x16x32_bf16 v[104:107], a[200:203], v[140:143], v[104:107]
    v_cvt_pk_bf16_f32 v72, v112, v113
    v_cvt_pk_bf16_f32 v73, v114, v115
    v_mfma_f32_16x16x32_bf16 v[108:111], a[204:207], v[140:143], v[108:111]
    s_nop 0
    ds_read_b64_tr_b16 a[196:197], v83 offset:0
    ds_read_b64_tr_b16 a[198:199], v83 offset:2112
    v_mfma_f32_16x16x32_bf16 v[100:103], a[204:207], v[136:139], v[100:103]
    v_mfma_f32_16x16x32_bf16 v[96:99], a[208:211], v[144:147], v[96:99]
    s_waitcnt lgkmcnt(6)
    ds_read_b64_tr_b16 a[200:201], v82 offset:4224
    ds_read_b64_tr_b16 a[202:203], v82 offset:6336
    v_mfma_f32_16x16x32_bf16 v[104:107], a[208:211], v[148:151], v[104:107]
    v_cvt_pk_bf16_f32 v74, v116, v117
    v_cvt_pk_bf16_f32 v75, v118, v119
    v_mfma_f32_16x16x32_bf16 v[108:111], a[212:215], v[148:151], v[108:111]
    s_nop 0
    ds_read_b64_tr_b16 a[204:205], v83 offset:4224
    ds_read_b64_tr_b16 a[206:207], v83 offset:6336
    v_mfma_f32_16x16x32_bf16 v[100:103], a[212:215], v[144:147], v[100:103]
    v_mfma_f32_16x16x32_bf16 v[96:99], a[216:219], v[152:155], v[96:99]
    s_waitcnt lgkmcnt(6)
    ds_read_b64_tr_b16 a[208:209], v82 offset:8448
    ds_read_b64_tr_b16 a[210:211], v82 offset:10560
    v_mfma_f32_16x16x32_bf16 v[104:107], a[216:219], v[156:159], v[104:107]
    v_cvt_pk_bf16_f32 v76, v120, v121
    v_cvt_pk_bf16_f32 v77, v122, v123
    v_mfma_f32_16x16x32_bf16 v[108:111], a[220:223], v[156:159], v[108:111]
    s_nop 0
    ds_read_b64_tr_b16 a[212:213], v83 offset:8448
    ds_read_b64_tr_b16 a[214:215], v83 offset:10560
    v_mfma_f32_16x16x32_bf16 v[100:103], a[220:223], v[152:155], v[100:103]
    v_cvt_pk_bf16_f32 v78, v124, v125
    v_cvt_pk_bf16_f32 v79, v126, v127
    v_mfma_f32_16x16x32_bf16 v[112:115], a[192:195], v[128:131], 0
    s_waitcnt lgkmcnt(6)
    ds_read_b64_tr_b16 a[216:217], v82 offset:12672
    ds_read_b64_tr_b16 a[218:219], v82 offset:14784
    v_mfma_f32_16x16x32_bf16 v[120:123], a[192:195], v[132:135], 0
    s_nop 0
    buffer_store_dwordx4 v[72:75], v16, s[24:27], s43 offen offset:2048 sc1
    v_mfma_f32_16x16x32_bf16 v[124:127], a[196:199], v[132:135], 0
    s_nop 0
    ds_read_b64_tr_b16 a[220:221], v83 offset:12672
    ds_read_b64_tr_b16 a[222:223], v83 offset:14784
    v_mfma_f32_16x16x32_bf16 v[116:119], a[196:199], v[128:131], 0
    v_mfma_f32_16x16x32_bf16 v[112:115], a[200:203], v[136:139], v[112:115]
    s_waitcnt lgkmcnt(6)
    ds_read_b64_tr_b16 a[192:193], v88 offset:33792
    ds_read_b64_tr_b16 a[194:195], v88 offset:35904
    v_mfma_f32_16x16x32_bf16 v[120:123], a[200:203], v[140:143], v[120:123]
    s_nop 0
    buffer_store_dwordx4 v[76:79], v16, s[24:27], s43 offen offset:3072 sc1
    v_mfma_f32_16x16x32_bf16 v[124:127], a[204:207], v[140:143], v[124:127]
    s_nop 0
    ds_read_b64_tr_b16 a[196:197], v89 offset:33792
    ds_read_b64_tr_b16 a[198:199], v89 offset:35904
    v_mfma_f32_16x16x32_bf16 v[116:119], a[204:207], v[136:139], v[116:119]
    v_mfma_f32_16x16x32_bf16 v[112:115], a[208:211], v[144:147], v[112:115]
    s_waitcnt lgkmcnt(6)
    ds_read_b64_tr_b16 a[200:201], v88 offset:38016
    ds_read_b64_tr_b16 a[202:203], v88 offset:40128
    v_mfma_f32_16x16x32_bf16 v[120:123], a[208:211], v[148:151], v[120:123]
    s_add_u32 s43, s43, 4096
    v_mfma_f32_16x16x32_bf16 v[124:127], a[212:215], v[148:151], v[124:127]
    s_nop 0
    ds_read_b64_tr_b16 a[204:205], v89 offset:38016
    ds_read_b64_tr_b16 a[206:207], v89 offset:40128
    v_mfma_f32_16x16x32_bf16 v[116:119], a[212:215], v[144:147], v[116:119]
    v_mfma_f32_16x16x32_bf16 v[112:115], a[216:219], v[152:155], v[112:115]
    s_waitcnt lgkmcnt(6)
    ds_read_b64_tr_b16 a[208:209], v88 offset:42240
    ds_read_b64_tr_b16 a[210:211], v88 offset:44352
    v_mfma_f32_16x16x32_bf16 v[120:123], a[216:219], v[156:159], v[120:123]
    v_mfma_f32_16x16x32_bf16 v[124:127], a[220:223], v[156:159], v[124:127]
    s_nop 0
    ds_read_b64_tr_b16 a[212:213], v89 offset:42240
    ds_read_b64_tr_b16 a[214:215], v89 offset:44352
    v_mfma_f32_16x16x32_bf16 v[116:119], a[220:223], v[152:155], v[116:119]
    v_mfma_f32_16x16x32_bf16 v[96:99], a[192:195], v[160:163], v[96:99]
    s_waitcnt lgkmcnt(6)
    ds_read_b64_tr_b16 a[216:217], v88 offset:46464
    ds_read_b64_tr_b16 a[218:219], v88 offset:48576
    s_waitcnt vmcnt(24)
    v_mfma_f32_16x16x32_bf16 v[104:107], a[192:195], v[164:167], v[104:107]
    s_barrier
    v_mfma_f32_16x16x32_bf16 v[108:111], a[196:199], v[164:167], v[108:111]
    s_nop 0
    ds_read_b64_tr_b16 a[220:221], v89 offset:46464
    ds_read_b64_tr_b16 a[222:223], v89 offset:48576
    v_mfma_f32_16x16x32_bf16 v[100:103], a[196:199], v[160:163], v[100:103]
    v_mfma_f32_16x16x32_bf16 v[96:99], a[200:203], v[168:171], v[96:99]
    s_waitcnt lgkmcnt(6)
    ds_read_b64_tr_b16 a[192:193], v90 offset:33792
    ds_read_b64_tr_b16 a[194:195], v90 offset:35904
    v_mfma_f32_16x16x32_bf16 v[104:107], a[200:203], v[172:175], v[104:107]
    v_mfma_f32_16x16x32_bf16 v[108:111], a[204:207], v[172:175], v[108:111]
    s_nop 0
    ds_read_b64_tr_b16 a[196:197], v91 offset:33792
    ds_read_b64_tr_b16 a[198:199], v91 offset:35904
    v_mfma_f32_16x16x32_bf16 v[100:103], a[204:207], v[168:171], v[100:103]
    v_mfma_f32_16x16x32_bf16 v[96:99], a[208:211], v[176:179], v[96:99]
    s_waitcnt lgkmcnt(6)
    ds_read_b64_tr_b16 a[200:201], v90 offset:38016
    ds_read_b64_tr_b16 a[202:203], v90 offset:40128
    v_mfma_f32_16x16x32_bf16 v[104:107], a[208:211], v[180:183], v[104:107]
    v_mfma_f32_16x16x32_bf16 v[108:111], a[212:215], v[180:183], v[108:111]
    s_nop 0
    ds_read_b64_tr_b16 a[204:205], v91 offset:38016
    ds_read_b64_tr_b16 a[206:207], v91 offset:40128
    v_mfma_f32_16x16x32_bf16 v[100:103], a[212:215], v[176:179], v[100:103]
    v_mfma_f32_16x16x32_bf16 v[96:99], a[216:219], v[184:187], v[96:99]
    s_waitcnt lgkmcnt(6)
    ds_read_b64_tr_b16 a[208:209], v90 offset:42240
    ds_read_b64_tr_b16 a[210:211], v90 offset:44352
    v_mfma_f32_16x16x32_bf16 v[104:107], a[216:219], v[188:191], v[104:107]
    v_mfma_f32_16x16x32_bf16 v[108:111], a[220:223], v[188:191], v[108:111]
    s_nop 0
    ds_read_b64_tr_b16 a[212:213], v91 offset:42240
    ds_read_b64_tr_b16 a[214:215], v91 offset:44352
    v_mfma_f32_16x16x32_bf16 v[100:103], a[220:223], v[184:187], v[100:103]
    v_mfma_f32_16x16x32_bf16 v[112:115], a[192:195], v[160:163], v[112:115]
    s_waitcnt lgkmcnt(6)
    ds_read_b64_tr_b16 a[216:217], v90 offset:46464
    ds_read_b64_tr_b16 a[218:219], v90 offset:48576
    v_mfma_f32_16x16x32_bf16 v[120:123], a[192:195], v[164:167], v[120:123]
    v_mfma_f32_16x16x32_bf16 v[124:127], a[196:199], v[164:167], v[124:127]
    s_nop 0
    ds_read_b64_tr_b16 a[220:221], v91 offset:46464
    ds_read_b64_tr_b16 a[222:223], v91 offset:48576
    v_mfma_f32_16x16x32_bf16 v[116:119], a[196:199], v[160:163], v[116:119]
    v_cvt_pk_bf16_f32 v64, v96, v97
    v_cvt_pk_bf16_f32 v65, v98, v99
    v_mfma_f32_16x16x32_bf16 v[112:115], a[200:203], v[168:171], v[112:115]
    s_waitcnt lgkmcnt(6)
    ds_read_b64_tr_b16 a[192:193], v80 offset:16896
    ds_read_b64_tr_b16 a[194:195], v80 offset:19008
    v_mfma_f32_16x16x32_bf16 v[120:123], a[200:203], v[172:175], v[120:123]
    v_mfma_f32_16x16x32_bf16 v[124:127], a[204:207], v[172:175], v[124:127]
    s_nop 0
    ds_read_b64_tr_b16 a[196:197], v81 offset:16896
    ds_read_b64_tr_b16 a[198:199], v81 offset:19008
    v_mfma_f32_16x16x32_bf16 v[116:119], a[204:207], v[168:171], v[116:119]
    v_cvt_pk_bf16_f32 v66, v100, v101
    v_cvt_pk_bf16_f32 v67, v102, v103
    v_mfma_f32_16x16x32_bf16 v[112:115], a[208:211], v[176:179], v[112:115]
    s_waitcnt lgkmcnt(6)
    ds_read_b64_tr_b16 a[200:201], v80 offset:21120
    ds_read_b64_tr_b16 a[202:203], v80 offset:23232
    v_mfma_f32_16x16x32_bf16 v[120:123], a[208:211], v[180:183], v[120:123]
    v_mfma_f32_16x16x32_bf16 v[124:127], a[212:215], v[180:183], v[124:127]
    s_nop 0
    ds_read_b64_tr_b16 a[204:205], v81 offset:21120
    ds_read_b64_tr_b16 a[206:207], v81 offset:23232
    v_mfma_f32_16x16x32_bf16 v[116:119], a[212:215], v[176:179], v[116:119]
    v_cvt_pk_bf16_f32 v68, v104, v105
    v_cvt_pk_bf16_f32 v69, v106, v107
    v_mfma_f32_16x16x32_bf16 v[112:115], a[216:219], v[184:187], v[112:115]
    s_waitcnt lgkmcnt(6)
    ds_read_b64_tr_b16 a[208:209], v80 offset:25344
    ds_read_b64_tr_b16 a[210:211], v80 offset:27456
    v_mfma_f32_16x16x32_bf16 v[120:123], a[216:219], v[188:191], v[120:123]
    v_cvt_pk_bf16_f32 v70, v108, v109
    v_cvt_pk_bf16_f32 v71, v110, v111
    v_mfma_f32_16x16x32_bf16 v[124:127], a[220:223], v[188:191], v[124:127]
    s_nop 0
    ds_read_b64_tr_b16 a[212:213], v81 offset:25344
    ds_read_b64_tr_b16 a[214:215], v81 offset:27456
    v_mfma_f32_16x16x32_bf16 v[116:119], a[220:223], v[184:187], v[116:119]
    s_nop 0
    buffer_store_dwordx4 v[64:67], v16, s[24:27], s43 offen offset:0 sc1
    v_mfma_f32_16x16x32_bf16 v[96:99], a[192:195], v[128:131], 0
    s_waitcnt lgkmcnt(6)
    ds_read_b64_tr_b16 a[216:217], v80 offset:29568
    ds_read_b64_tr_b16 a[218:219], v80 offset:31680
    s_waitcnt vmcnt(21)
    v_mfma_f32_16x16x32_bf16 v[104:107], a[192:195], v[132:135], 0
    s_barrier
    v_mfma_f32_16x16x32_bf16 v[108:111], a[196:199], v[132:135], 0
    s_nop 0
    ds_read_b64_tr_b16 a[220:221], v81 offset:29568
    ds_read_b64_tr_b16 a[222:223], v81 offset:31680
    v_mfma_f32_16x16x32_bf16 v[100:103], a[196:199], v[128:131], 0
    s_nop 0
    buffer_store_dwordx4 v[68:71], v16, s[24:27], s43 offen offset:1024 sc1
    v_mfma_f32_16x16x32_bf16 v[96:99], a[200:203], v[136:139], v[96:99]
    s_waitcnt lgkmcnt(6)
    ds_read_b64_tr_b16 a[192:193], v82 offset:16896
    ds_read_b64_tr_b16 a[194:195], v82 offset:19008
    v_mfma_f32_16x16x32_bf16 v[104:107], a[200:203], v[140:143], v[104:107]
    v_cvt_pk_bf16_f32 v72, v112, v113
    v_cvt_pk_bf16_f32 v73, v114, v115
    v_mfma_f32_16x16x32_bf16 v[108:111], a[204:207], v[140:143], v[108:111]
    s_nop 0
    ds_read_b64_tr_b16 a[196:197], v83 offset:16896
    ds_read_b64_tr_b16 a[198:199], v83 offset:19008
    v_mfma_f32_16x16x32_bf16 v[100:103], a[204:207], v[136:139], v[100:103]
    v_mfma_f32_16x16x32_bf16 v[96:99], a[208:211], v[144:147], v[96:99]
    s_waitcnt lgkmcnt(6)
    ds_read_b64_tr_b16 a[200:201], v82 offset:21120
    ds_read_b64_tr_b16 a[202:203], v82 offset:23232
    v_mfma_f32_16x16x32_bf16 v[104:107], a[208:211], v[148:151], v[104:107]
    v_cvt_pk_bf16_f32 v74, v116, v117
    v_cvt_pk_bf16_f32 v75, v118, v119
    v_mfma_f32_16x16x32_bf16 v[108:111], a[212:215], v[148:151], v[108:111]
    s_nop 0
    ds_read_b64_tr_b16 a[204:205], v83 offset:21120
    ds_read_b64_tr_b16 a[206:207], v83 offset:23232
    v_mfma_f32_16x16x32_bf16 v[100:103], a[212:215], v[144:147], v[100:103]
    v_mfma_f32_16x16x32_bf16 v[96:99], a[216:219], v[152:155], v[96:99]
    s_waitcnt lgkmcnt(6)
    ds_read_b64_tr_b16 a[208:209], v82 offset:25344
    ds_read_b64_tr_b16 a[210:211], v82 offset:27456
    v_mfma_f32_16x16x32_bf16 v[104:107], a[216:219], v[156:159], v[104:107]
    v_cvt_pk_bf16_f32 v76, v120, v121
    v_cvt_pk_bf16_f32 v77, v122, v123
    v_mfma_f32_16x16x32_bf16 v[108:111], a[220:223], v[156:159], v[108:111]
    s_nop 0
    ds_read_b64_tr_b16 a[212:213], v83 offset:25344
    ds_read_b64_tr_b16 a[214:215], v83 offset:27456
    v_mfma_f32_16x16x32_bf16 v[100:103], a[220:223], v[152:155], v[100:103]
    v_cvt_pk_bf16_f32 v78, v124, v125
    v_cvt_pk_bf16_f32 v79, v126, v127
    v_mfma_f32_16x16x32_bf16 v[112:115], a[192:195], v[128:131], 0
    s_waitcnt lgkmcnt(6)
    ds_read_b64_tr_b16 a[216:217], v82 offset:29568
    ds_read_b64_tr_b16 a[218:219], v82 offset:31680
    v_mfma_f32_16x16x32_bf16 v[120:123], a[192:195], v[132:135], 0
    s_nop 0
    buffer_store_dwordx4 v[72:75], v16, s[24:27], s43 offen offset:2048 sc1
    v_mfma_f32_16x16x32_bf16 v[124:127], a[196:199], v[132:135], 0
    s_nop 0
    ds_read_b64_tr_b16 a[220:221], v83 offset:29568
    ds_read_b64_tr_b16 a[222:223], v83 offset:31680
    v_mfma_f32_16x16x32_bf16 v[116:119], a[196:199], v[128:131], 0
    v_mfma_f32_16x16x32_bf16 v[112:115], a[200:203], v[136:139], v[112:115]
    s_waitcnt lgkmcnt(6)
    ds_read_b64_tr_b16 a[192:193], v88 offset:16896
    ds_read_b64_tr_b16 a[194:195], v88 offset:19008
    v_mfma_f32_16x16x32_bf16 v[120:123], a[200:203], v[140:143], v[120:123]
    s_nop 0
    buffer_store_dwordx4 v[76:79], v16, s[24:27], s43 offen offset:3072 sc1
    v_mfma_f32_16x16x32_bf16 v[124:127], a[204:207], v[140:143], v[124:127]
    s_nop 0
    ds_read_b64_tr_b16 a[196:197], v89 offset:16896
    ds_read_b64_tr_b16 a[198:199], v89 offset:19008
    v_mfma_f32_16x16x32_bf16 v[116:119], a[204:207], v[136:139], v[116:119]
    v_mfma_f32_16x16x32_bf16 v[112:115], a[208:211], v[144:147], v[112:115]
    s_waitcnt lgkmcnt(6)
    ds_read_b64_tr_b16 a[200:201], v88 offset:21120
    ds_read_b64_tr_b16 a[202:203], v88 offset:23232
    v_mfma_f32_16x16x32_bf16 v[120:123], a[208:211], v[148:151], v[120:123]
    s_add_u32 s43, s43, 4096
    v_mfma_f32_16x16x32_bf16 v[124:127], a[212:215], v[148:151], v[124:127]
    s_nop 0
    ds_read_b64_tr_b16 a[204:205], v89 offset:21120
    ds_read_b64_tr_b16 a[206:207], v89 offset:23232
    v_mfma_f32_16x16x32_bf16 v[116:119], a[212:215], v[144:147], v[116:119]
    v_mfma_f32_16x16x32_bf16 v[112:115], a[216:219], v[152:155], v[112:115]
    s_waitcnt lgkmcnt(6)
    ds_read_b64_tr_b16 a[208:209], v88 offset:25344
    ds_read_b64_tr_b16 a[210:211], v88 offset:27456
    v_mfma_f32_16x16x32_bf16 v[120:123], a[216:219], v[156:159], v[120:123]
    v_mfma_f32_16x16x32_bf16 v[124:127], a[220:223], v[156:159], v[124:127]
    s_nop 0
    ds_read_b64_tr_b16 a[212:213], v89 offset:25344
    ds_read_b64_tr_b16 a[214:215], v89 offset:27456
    v_mfma_f32_16x16x32_bf16 v[116:119], a[220:223], v[152:155], v[116:119]
    v_mfma_f32_16x16x32_bf16 v[96:99], a[192:195], v[160:163], v[96:99]
    s_waitcnt lgkmcnt(6)
    ds_read_b64_tr_b16 a[216:217], v88 offset:29568
    ds_read_b64_tr_b16 a[218:219], v88 offset:31680
    s_waitcnt vmcnt(12)
    v_mfma_f32_16x16x32_bf16 v[104:107], a[192:195], v[164:167], v[104:107]
    s_barrier
    s_getreg_b32 s48, hwreg(HW_REG_IB_STS)
    s_and_b32 s48, s48, 0xc0000f
    s_cmp_le_u32 s48, 8
    s_cselect_b32 s53, 3, s53
    s_cmp_le_u32 s48, 4
    s_cselect_b32 s53, 4, s53
    v_mov_b32 v94, s53
    v_mfma_f32_16x16x32_bf16 v[108:111], a[196:199], v[164:167], v[108:111]
    s_nop 0
    ds_read_b64_tr_b16 a[220:221], v89 offset:29568
    ds_read_b64_tr_b16 a[222:223], v89 offset:31680
    v_mfma_f32_16x16x32_bf16 v[100:103], a[196:199], v[160:163], v[100:103]
    s_nop 0
    s_mov_b32 exec_hi, 0
    global_store_dword v2, v94, s[84:85] sc1
    s_mov_b32 exec_hi, -1
    v_mfma_f32_16x16x32_bf16 v[96:99], a[200:203], v[168:171], v[96:99]
    s_waitcnt lgkmcnt(6)
    ds_read_b64_tr_b16 a[192:193], v90 offset:16896
    ds_read_b64_tr_b16 a[194:195], v90 offset:19008
    v_mfma_f32_16x16x32_bf16 v[104:107], a[200:203], v[172:175], v[104:107]
    v_mfma_f32_16x16x32_bf16 v[108:111], a[204:207], v[172:175], v[108:111]
    s_nop 0
    ds_read_b64_tr_b16 a[196:197], v91 offset:16896
    ds_read_b64_tr_b16 a[198:199], v91 offset:19008
    v_mfma_f32_16x16x32_bf16 v[100:103], a[204:207], v[168:171], v[100:103]
    v_mfma_f32_16x16x32_bf16 v[96:99], a[208:211], v[176:179], v[96:99]
    s_waitcnt lgkmcnt(6)
    ds_read_b64_tr_b16 a[200:201], v90 offset:21120
    ds_read_b64_tr_b16 a[202:203], v90 offset:23232
    v_mfma_f32_16x16x32_bf16 v[104:107], a[208:211], v[180:183], v[104:107]
    v_mfma_f32_16x16x32_bf16 v[108:111], a[212:215], v[180:183], v[108:111]
    s_nop 0
    ds_read_b64_tr_b16 a[204:205], v91 offset:21120
    ds_read_b64_tr_b16 a[206:207], v91 offset:23232
    v_mfma_f32_16x16x32_bf16 v[100:103], a[212:215], v[176:179], v[100:103]
    v_mfma_f32_16x16x32_bf16 v[96:99], a[216:219], v[184:187], v[96:99]
    s_waitcnt lgkmcnt(6)
    ds_read_b64_tr_b16 a[208:209], v90 offset:25344
    ds_read_b64_tr_b16 a[210:211], v90 offset:27456
    v_mfma_f32_16x16x32_bf16 v[104:107], a[216:219], v[188:191], v[104:107]
    v_mfma_f32_16x16x32_bf16 v[108:111], a[220:223], v[188:191], v[108:111]
    s_nop 0
    ds_read_b64_tr_b16 a[212:213], v91 offset:25344
    ds_read_b64_tr_b16 a[214:215], v91 offset:27456
    v_mfma_f32_16x16x32_bf16 v[100:103], a[220:223], v[184:187], v[100:103]
    v_mfma_f32_16x16x32_bf16 v[112:115], a[192:195], v[160:163], v[112:115]
    s_waitcnt lgkmcnt(6)
    ds_read_b64_tr_b16 a[216:217], v90 offset:29568
    ds_read_b64_tr_b16 a[218:219], v90 offset:31680
    v_mfma_f32_16x16x32_bf16 v[120:123], a[192:195], v[164:167], v[120:123]
    v_mfma_f32_16x16x32_bf16 v[124:127], a[196:199], v[164:167], v[124:127]
    s_nop 0
    ds_read_b64_tr_b16 a[220:221], v91 offset:29568
    ds_read_b64_tr_b16 a[222:223], v91 offset:31680
    v_mfma_f32_16x16x32_bf16 v[116:119], a[196:199], v[160:163], v[116:119]
    v_cvt_pk_bf16_f32 v64, v96, v97
    v_cvt_pk_bf16_f32 v65, v98, v99
    v_mfma_f32_16x16x32_bf16 v[112:115], a[200:203], v[168:171], v[112:115]
    s_waitcnt lgkmcnt(6)
    ds_read_b64_tr_b16 a[192:193], v88 offset:0
    ds_read_b64_tr_b16 a[194:195], v88 offset:2112
    v_mfma_f32_16x16x32_bf16 v[120:123], a[200:203], v[172:175], v[120:123]
    v_mfma_f32_16x16x32_bf16 v[124:127], a[204:207], v[172:175], v[124:127]
    s_nop 0
    ds_read_b64_tr_b16 a[196:197], v89 offset:0
    ds_read_b64_tr_b16 a[198:199], v89 offset:2112
    v_mfma_f32_16x16x32_bf16 v[116:119], a[204:207], v[168:171], v[116:119]
    v_cvt_pk_bf16_f32 v66, v100, v101
    v_cvt_pk_bf16_f32 v67, v102, v103
    v_mfma_f32_16x16x32_bf16 v[112:115], a[208:211], v[176:179], v[112:115]
    s_waitcnt lgkmcnt(6)
    ds_read_b64_tr_b16 a[200:201], v88 offset:4224
    ds_read_b64_tr_b16 a[202:203], v88 offset:6336
    v_mfma_f32_16x16x32_bf16 v[120:123], a[208:211], v[180:183], v[120:123]
    v_mfma_f32_16x16x32_bf16 v[124:127], a[212:215], v[180:183], v[124:127]
    s_nop 0
    ds_read_b64_tr_b16 a[204:205], v89 offset:4224
    ds_read_b64_tr_b16 a[206:207], v89 offset:6336
    v_mfma_f32_16x16x32_bf16 v[116:119], a[212:215], v[176:179], v[116:119]
    v_cvt_pk_bf16_f32 v68, v104, v105
    v_cvt_pk_bf16_f32 v69, v106, v107
    v_mfma_f32_16x16x32_bf16 v[112:115], a[216:219], v[184:187], v[112:115]
    s_waitcnt lgkmcnt(6)
    ds_read_b64_tr_b16 a[208:209], v88 offset:8448
    ds_read_b64_tr_b16 a[210:211], v88 offset:10560
    v_mfma_f32_16x16x32_bf16 v[120:123], a[216:219], v[188:191], v[120:123]
    v_cvt_pk_bf16_f32 v70, v108, v109
    v_cvt_pk_bf16_f32 v71, v110, v111
    v_mfma_f32_16x16x32_bf16 v[124:127], a[220:223], v[188:191], v[124:127]
    s_nop 0
    ds_read_b64_tr_b16 a[212:213], v89 offset:8448
    ds_read_b64_tr_b16 a[214:215], v89 offset:10560
    v_mfma_f32_16x16x32_bf16 v[116:119], a[220:223], v[184:187], v[116:119]
    s_nop 0
    buffer_store_dwordx4 v[64:67], v16, s[24:27], s43 offen offset:0 sc1
    v_mfma_f32_16x16x32_bf16 v[96:99], a[192:195], v[128:131], 0
    s_waitcnt lgkmcnt(6)
    ds_read_b64_tr_b16 a[216:217], v88 offset:12672
    ds_read_b64_tr_b16 a[218:219], v88 offset:14784
    v_mfma_f32_16x16x32_bf16 v[104:107], a[192:195], v[132:135], 0
    v_mfma_f32_16x16x32_bf16 v[108:111], a[196:199], v[132:135], 0
    s_nop 0
    ds_read_b64_tr_b16 a[220:221], v89 offset:12672
    ds_read_b64_tr_b16 a[222:223], v89 offset:14784
    v_mfma_f32_16x16x32_bf16 v[100:103], a[196:199], v[128:131], 0
    s_nop 0
    buffer_store_dwordx4 v[68:71], v16, s[24:27], s43 offen offset:1024 sc1
    v_mfma_f32_16x16x32_bf16 v[96:99], a[200:203], v[136:139], v[96:99]
    s_waitcnt lgkmcnt(6)
    ds_read_b64_tr_b16 a[192:193], v90 offset:0
    ds_read_b64_tr_b16 a[194:195], v90 offset:2112
    v_mfma_f32_16x16x32_bf16 v[104:107], a[200:203], v[140:143], v[104:107]
    v_cvt_pk_bf16_f32 v72, v112, v113
    v_cvt_pk_bf16_f32 v73, v114, v115
    v_mfma_f32_16x16x32_bf16 v[108:111], a[204:207], v[140:143], v[108:111]
    s_nop 0
    ds_read_b64_tr_b16 a[196:197], v91 offset:0
    ds_read_b64_tr_b16 a[198:199], v91 offset:2112
    v_mfma_f32_16x16x32_bf16 v[100:103], a[204:207], v[136:139], v[100:103]
    v_mfma_f32_16x16x32_bf16 v[96:99], a[208:211], v[144:147], v[96:99]
    s_waitcnt lgkmcnt(6)
    ds_read_b64_tr_b16 a[200:201], v90 offset:4224
    ds_read_b64_tr_b16 a[202:203], v90 offset:6336
    v_mfma_f32_16x16x32_bf16 v[104:107], a[208:211], v[148:151], v[104:107]
    v_cvt_pk_bf16_f32 v74, v116, v117
    v_cvt_pk_bf16_f32 v75, v118, v119
    v_mfma_f32_16x16x32_bf16 v[108:111], a[212:215], v[148:151], v[108:111]
    s_nop 0
    ds_read_b64_tr_b16 a[204:205], v91 offset:4224
    ds_read_b64_tr_b16 a[206:207], v91 offset:6336
    v_mfma_f32_16x16x32_bf16 v[100:103], a[212:215], v[144:147], v[100:103]
    v_mfma_f32_16x16x32_bf16 v[96:99], a[216:219], v[152:155], v[96:99]
    s_waitcnt lgkmcnt(6)
    ds_read_b64_tr_b16 a[208:209], v90 offset:8448
    ds_read_b64_tr_b16 a[210:211], v90 offset:10560
    v_mfma_f32_16x16x32_bf16 v[104:107], a[216:219], v[156:159], v[104:107]
    v_cvt_pk_bf16_f32 v76, v120, v121
    v_cvt_pk_bf16_f32 v77, v122, v123
    v_mfma_f32_16x16x32_bf16 v[108:111], a[220:223], v[156:159], v[108:111]
    s_nop 0
    ds_read_b64_tr_b16 a[212:213], v91 offset:8448
    ds_read_b64_tr_b16 a[214:215], v91 offset:10560
    v_mfma_f32_16x16x32_bf16 v[100:103], a[220:223], v[152:155], v[100:103]
    v_cvt_pk_bf16_f32 v78, v124, v125
    v_cvt_pk_bf16_f32 v79, v126, v127
    v_mfma_f32_16x16x32_bf16 v[112:115], a[192:195], v[128:131], 0
    s_waitcnt lgkmcnt(6)
    ds_read_b64_tr_b16 a[216:217], v90 offset:12672
    ds_read_b64_tr_b16 a[218:219], v90 offset:14784
    v_mfma_f32_16x16x32_bf16 v[120:123], a[192:195], v[132:135], 0
    s_nop 0
    buffer_store_dwordx4 v[72:75], v16, s[24:27], s43 offen offset:2048 sc1
    v_mfma_f32_16x16x32_bf16 v[124:127], a[196:199], v[132:135], 0
    s_nop 0
    ds_read_b64_tr_b16 a[220:221], v91 offset:12672
    ds_read_b64_tr_b16 a[222:223], v91 offset:14784
    v_mfma_f32_16x16x32_bf16 v[116:119], a[196:199], v[128:131], 0
    v_mfma_f32_16x16x32_bf16 v[112:115], a[200:203], v[136:139], v[112:115]
    s_waitcnt lgkmcnt(6)
    ds_read_b64_tr_b16 a[192:193], v80 offset:33792
    ds_read_b64_tr_b16 a[194:195], v80 offset:35904
    v_mfma_f32_16x16x32_bf16 v[120:123], a[200:203], v[140:143], v[120:123]
    s_nop 0
    buffer_store_dwordx4 v[76:79], v16, s[24:27], s43 offen offset:3072 sc1
    v_mfma_f32_16x16x32_bf16 v[124:127], a[204:207], v[140:143], v[124:127]
    s_nop 0
    ds_read_b64_tr_b16 a[196:197], v81 offset:33792
    ds_read_b64_tr_b16 a[198:199], v81 offset:35904
    v_mfma_f32_16x16x32_bf16 v[116:119], a[204:207], v[136:139], v[116:119]
    v_mfma_f32_16x16x32_bf16 v[112:115], a[208:211], v[144:147], v[112:115]
    s_waitcnt lgkmcnt(6)
    ds_read_b64_tr_b16 a[200:201], v80 offset:38016
    ds_read_b64_tr_b16 a[202:203], v80 offset:40128
    v_mfma_f32_16x16x32_bf16 v[120:123], a[208:211], v[148:151], v[120:123]
    s_add_u32 s43, s43, 4096
    v_mfma_f32_16x16x32_bf16 v[124:127], a[212:215], v[148:151], v[124:127]
    s_nop 0
    ds_read_b64_tr_b16 a[204:205], v81 offset:38016
    ds_read_b64_tr_b16 a[206:207], v81 offset:40128
    v_mfma_f32_16x16x32_bf16 v[116:119], a[212:215], v[144:147], v[116:119]
    v_mfma_f32_16x16x32_bf16 v[112:115], a[216:219], v[152:155], v[112:115]
    s_waitcnt lgkmcnt(6)
    ds_read_b64_tr_b16 a[208:209], v80 offset:42240
    ds_read_b64_tr_b16 a[210:211], v80 offset:44352
    v_mfma_f32_16x16x32_bf16 v[120:123], a[216:219], v[156:159], v[120:123]
    v_mfma_f32_16x16x32_bf16 v[124:127], a[220:223], v[156:159], v[124:127]
    s_nop 0
    ds_read_b64_tr_b16 a[212:213], v81 offset:42240
    ds_read_b64_tr_b16 a[214:215], v81 offset:44352
    v_mfma_f32_16x16x32_bf16 v[116:119], a[220:223], v[152:155], v[116:119]
    v_mfma_f32_16x16x32_bf16 v[96:99], a[192:195], v[160:163], v[96:99]
    s_waitcnt lgkmcnt(6)
    ds_read_b64_tr_b16 a[216:217], v80 offset:46464
    ds_read_b64_tr_b16 a[218:219], v80 offset:48576
    v_mfma_f32_16x16x32_bf16 v[104:107], a[192:195], v[164:167], v[104:107]
    v_mfma_f32_16x16x32_bf16 v[108:111], a[196:199], v[164:167], v[108:111]
    s_nop 0
    ds_read_b64_tr_b16 a[220:221], v81 offset:46464
    ds_read_b64_tr_b16 a[222:223], v81 offset:48576
    v_mfma_f32_16x16x32_bf16 v[100:103], a[196:199], v[160:163], v[100:103]
    v_mfma_f32_16x16x32_bf16 v[96:99], a[200:203], v[168:171], v[96:99]
    s_waitcnt lgkmcnt(6)
    ds_read_b64_tr_b16 a[192:193], v82 offset:33792
    ds_read_b64_tr_b16 a[194:195], v82 offset:35904
    v_mfma_f32_16x16x32_bf16 v[104:107], a[200:203], v[172:175], v[104:107]
    v_mfma_f32_16x16x32_bf16 v[108:111], a[204:207], v[172:175], v[108:111]
    s_nop 0
    ds_read_b64_tr_b16 a[196:197], v83 offset:33792
    ds_read_b64_tr_b16 a[198:199], v83 offset:35904
    v_mfma_f32_16x16x32_bf16 v[100:103], a[204:207], v[168:171], v[100:103]
    v_mfma_f32_16x16x32_bf16 v[96:99], a[208:211], v[176:179], v[96:99]
    s_waitcnt lgkmcnt(6)
    ds_read_b64_tr_b16 a[200:201], v82 offset:38016
    ds_read_b64_tr_b16 a[202:203], v82 offset:40128
    v_mfma_f32_16x16x32_bf16 v[104:107], a[208:211], v[180:183], v[104:107]
    v_mfma_f32_16x16x32_bf16 v[108:111], a[212:215], v[180:183], v[108:111]
    s_nop 0
    ds_read_b64_tr_b16 a[204:205], v83 offset:38016
    ds_read_b64_tr_b16 a[206:207], v83 offset:40128
    v_mfma_f32_16x16x32_bf16 v[100:103], a[212:215], v[176:179], v[100:103]
    v_mfma_f32_16x16x32_bf16 v[96:99], a[216:219], v[184:187], v[96:99]
    s_waitcnt lgkmcnt(6)
    ds_read_b64_tr_b16 a[208:209], v82 offset:42240
    ds_read_b64_tr_b16 a[210:211], v82 offset:44352
    v_mfma_f32_16x16x32_bf16 v[104:107], a[216:219], v[188:191], v[104:107]
    v_mfma_f32_16x16x32_bf16 v[108:111], a[220:223], v[188:191], v[108:111]
    s_nop 0
    ds_read_b64_tr_b16 a[212:213], v83 offset:42240
    ds_read_b64_tr_b16 a[214:215], v83 offset:44352
    v_mfma_f32_16x16x32_bf16 v[100:103], a[220:223], v[184:187], v[100:103]
    v_mfma_f32_16x16x32_bf16 v[112:115], a[192:195], v[160:163], v[112:115]
    s_waitcnt lgkmcnt(6)
    ds_read_b64_tr_b16 a[216:217], v82 offset:46464
    ds_read_b64_tr_b16 a[218:219], v82 offset:48576
    v_mfma_f32_16x16x32_bf16 v[120:123], a[192:195], v[164:167], v[120:123]
    v_mfma_f32_16x16x32_bf16 v[124:127], a[196:199], v[164:167], v[124:127]
    s_nop 0
    ds_read_b64_tr_b16 a[220:221], v83 offset:46464
    ds_read_b64_tr_b16 a[222:223], v83 offset:48576
    v_mfma_f32_16x16x32_bf16 v[116:119], a[196:199], v[160:163], v[116:119]
    v_cvt_pk_bf16_f32 v64, v96, v97
    v_cvt_pk_bf16_f32 v65, v98, v99
    v_mfma_f32_16x16x32_bf16 v[112:115], a[200:203], v[168:171], v[112:115]
    s_waitcnt lgkmcnt(6)
    v_mfma_f32_16x16x32_bf16 v[120:123], a[200:203], v[172:175], v[120:123]
    v_mfma_f32_16x16x32_bf16 v[124:127], a[204:207], v[172:175], v[124:127]
    v_mfma_f32_16x16x32_bf16 v[116:119], a[204:207], v[168:171], v[116:119]
    v_cvt_pk_bf16_f32 v66, v100, v101
    v_cvt_pk_bf16_f32 v67, v102, v103
    v_mfma_f32_16x16x32_bf16 v[112:115], a[208:211], v[176:179], v[112:115]
    s_waitcnt lgkmcnt(2)
    v_mfma_f32_16x16x32_bf16 v[120:123], a[208:211], v[180:183], v[120:123]
    v_mfma_f32_16x16x32_bf16 v[124:127], a[212:215], v[180:183], v[124:127]
    v_mfma_f32_16x16x32_bf16 v[116:119], a[212:215], v[176:179], v[116:119]
    v_cvt_pk_bf16_f32 v68, v104, v105
    v_cvt_pk_bf16_f32 v69, v106, v107
    v_mfma_f32_16x16x32_bf16 v[112:115], a[216:219], v[184:187], v[112:115]
    s_waitcnt lgkmcnt(0)
    v_mfma_f32_16x16x32_bf16 v[120:123], a[216:219], v[188:191], v[120:123]
    v_cvt_pk_bf16_f32 v70, v108, v109
    v_cvt_pk_bf16_f32 v71, v110, v111
    v_mfma_f32_16x16x32_bf16 v[124:127], a[220:223], v[188:191], v[124:127]
    v_mfma_f32_16x16x32_bf16 v[116:119], a[220:223], v[184:187], v[116:119]
    s_nop 0
    buffer_store_dwordx4 v[64:67], v16, s[24:27], s43 offen offset:0 sc1
    buffer_store_dwordx4 v[68:71], v16, s[24:27], s43 offen offset:1024 sc1
    s_nop 5
    v_cvt_pk_bf16_f32 v72, v112, v113
    v_cvt_pk_bf16_f32 v73, v114, v115
    v_cvt_pk_bf16_f32 v74, v116, v117
    v_cvt_pk_bf16_f32 v75, v118, v119
    v_cvt_pk_bf16_f32 v76, v120, v121
    v_cvt_pk_bf16_f32 v77, v122, v123
    v_cvt_pk_bf16_f32 v78, v124, v125
    v_cvt_pk_bf16_f32 v79, v126, v127
    buffer_store_dwordx4 v[72:75], v16, s[24:27], s43 offen offset:2048 sc1
    buffer_store_dwordx4 v[76:79], v16, s[24:27], s43 offen offset:3072 sc1
    global_load_dword v95, v92, s[84:85] sc1
    v_and_b32 v48, 1, v1
    v_lshlrev_b32 v48, 4, v48
    v_mov_b32 v49, 0x3f80
    v_lshlrev_b32 v48, v48, v49
    v_bfe_u32 v49, v1, 3, 1
    v_bfe_u32 v50, v1, 1, 1
    v_lshl_add_u32 v49, v49, 1, v50
    v_bfe_u32 v50, v1, 2, 1
    v_lshlrev_b32 v50, 1, v50
    v_lshrrev_b32 v51, 4, v1
    v_sub_u32 v50, v51, v50
    v_lshl_add_u32 v49, v50, 2, v49
    v_cmp_eq_u32 vcc, 0, v49
    s_nop 1
    v_cndmask_b32 v40, 0, v48, vcc
    v_cmp_eq_u32 vcc, 1, v49
    s_nop 1
    v_cndmask_b32 v41, 0, v48, vcc
    v_cmp_eq_u32 vcc, 2, v49
    s_nop 1
    v_cndmask_b32 v42, 0, v48, vcc
    v_cmp_eq_u32 vcc, 3, v49
    s_nop 1
    v_cndmask_b32 v43, 0, v48, vcc
    v_cmp_eq_u32 vcc, 4, v49
    s_nop 1
    v_cndmask_b32 v44, 0, v48, vcc
    v_cmp_eq_u32 vcc, 5, v49
    s_nop 1
    v_cndmask_b32 v45, 0, v48, vcc
    v_cmp_eq_u32 vcc, 6, v49
    s_nop 1
    v_cndmask_b32 v46, 0, v48, vcc
    v_cmp_eq_u32 vcc, 7, v49
    s_nop 1
    v_cndmask_b32 v47, 0, v48, vcc
    v_mov_b32 v94, 7
    s_waitcnt vmcnt(0)
    s_mov_b32 exec_hi, 0
    global_store_dword v2, v94, s[84:85] sc1
    s_mov_b32 exec_hi, -1
    s_barrier
    s_mov_b32 s34, 0
L_pollA:
    v_cmp_gt_u32 vcc, s28, v95
    s_and_b64 vcc, vcc, s[88:89]
    s_cbranch_scc0 L_pdoneA
    s_cmp_ge_u32 s34, 0x20000
    s_cbranch_scc1 L_pdoneA
    s_sleep 2
    global_load_dword v95, v92, s[84:85] sc1
    s_add_u32 s34, s34, 1
    s_waitcnt vmcnt(0)
    s_branch L_pollA
L_pdoneA:
    s_add_u32 s47, s30, 0
    buffer_load_dwordx4 v[192:195], v16, s[4:7], s47 offen sc1
    s_add_u32 s47, s30, 114688
    buffer_load_dwordx4 v[196:199], v16, s[4:7], s47 offen sc1
    s_add_u32 s47, s30, 229376
    buffer_load_dwordx4 v[200:203], v16, s[4:7], s47 offen sc1
    s_add_u32 s47, s30, 344064
    buffer_load_dwordx4 v[204:207], v16, s[4:7], s47 offen sc1
    s_add_u32 s47, s30, 458752
    buffer_load_dwordx4 v[208:211], v16, s[4:7], s47 offen sc1
    s_add_u32 s47, s30, 573440
    buffer_load_dwordx4 v[212:215], v16, s[4:7], s47 offen sc1
    s_add_u32 s47, s30, 688128
    buffer_load_dwordx4 v[216:219], v16, s[4:7], s47 offen sc1
    s_add_u32 s47, s30, 802816
    buffer_load_dwordx4 v[220:223], v16, s[4:7], s47 offen sc1
    s_add_u32 s47, s30, 917504
    buffer_load_dwordx4 v[224:227], v16, s[4:7], s47 offen sc1
    s_add_u32 s47, s30, 1032192
    buffer_load_dwordx4 v[228:231], v16, s[4:7], s47 offen sc1
    s_add_u32 s47, s30, 1146880
    buffer_load_dwordx4 v[232:235], v16, s[4:7], s47 offen sc1
    s_add_u32 s47, s30, 1261568
    buffer_load_dwordx4 v[236:239], v16, s[4:7], s47 offen sc1
    s_add_u32 s47, s30, 1376256
    buffer_load_dwordx4 v[240:243], v16, s[4:7], s47 offen sc1
    s_add_u32 s47, s30, 1490944
    buffer_load_dwordx4 v[244:247], v16, s[4:7], s47 offen sc1
    s_add_u32 s47, s30, 1605632
    buffer_load_dwordx4 v[248:251], v16, s[4:7], s47 offen sc1
    s_add_u32 s47, s30, 1720320
    buffer_load_dwordx4 v[252:255], v16, s[4:7], s47 offen sc1
L_haveA2:
    v_cmp_gt_u32 vcc, s29, v95
    s_and_b64 vcc, vcc, s[86:87]
    s_cbranch_scc1 L_slowB
    s_add_u32 s47, s31, 0
    buffer_load_dwordx4 v[128:131], v16, s[4:7], s47 offen sc1
    s_add_u32 s47, s31, 114688
    buffer_load_dwordx4 v[132:135], v16, s[4:7], s47 offen sc1
    s_add_u32 s47, s31, 229376
    buffer_load_dwordx4 v[136:139], v16, s[4:7], s47 offen sc1
    s_add_u32 s47, s31, 344064
    buffer_load_dwordx4 v[140:143], v16, s[4:7], s47 offen sc1
    s_add_u32 s47, s31, 458752
    buffer_load_dwordx4 v[144:147], v16, s[4:7], s47 offen sc1
    s_add_u32 s47, s31, 573440
    buffer_load_dwordx4 v[148:151], v16, s[4:7], s47 offen sc1
    s_add_u32 s47, s31, 688128
    buffer_load_dwordx4 v[152:155], v16, s[4:7], s47 offen sc1
    s_add_u32 s47, s31, 802816
    buffer_load_dwordx4 v[156:159], v16, s[4:7], s47 offen sc1
    s_add_u32 s47, s31, 917504
    buffer_load_dwordx4 v[160:163], v16, s[4:7], s47 offen sc1
    s_add_u32 s47, s31, 1032192
    buffer_load_dwordx4 v[164:167], v16, s[4:7], s47 offen sc1
    s_add_u32 s47, s31, 1146880
    buffer_load_dwordx4 v[168:171], v16, s[4:7], s47 offen sc1
    s_add_u32 s47, s31, 1261568
    buffer_load_dwordx4 v[172:175], v16, s[4:7], s47 offen sc1
    s_add_u32 s47, s31, 1376256
    buffer_load_dwordx4 v[176:179], v16, s[4:7], s47 offen sc1
    s_add_u32 s47, s31, 1490944
    buffer_load_dwordx4 v[180:183], v16, s[4:7], s47 offen sc1
    s_add_u32 s47, s31, 1605632
    buffer_load_dwordx4 v[184:187], v16, s[4:7], s47 offen sc1
    s_add_u32 s47, s31, 1720320
    buffer_load_dwordx4 v[188:191], v16, s[4:7], s47 offen sc1
    s_waitcnt vmcnt(31)
    v_mfma_f32_16x16x32_bf16 v[32:35], v[40:43], v[192:195], 0
    v_mfma_f32_16x16x32_bf16 v[36:39], v[44:47], v[192:195], 0
    s_waitcnt vmcnt(30)
    v_mfma_f32_16x16x32_bf16 v[32:35], v[40:43], v[196:199], v[32:35]
    v_mfma_f32_16x16x32_bf16 v[36:39], v[44:47], v[196:199], v[36:39]
    s_waitcnt vmcnt(29)
    v_mfma_f32_16x16x32_bf16 v[32:35], v[40:43], v[200:203], v[32:35]
    v_mfma_f32_16x16x32_bf16 v[36:39], v[44:47], v[200:203], v[36:39]
    s_waitcnt vmcnt(28)
    v_mfma_f32_16x16x32_bf16 v[32:35], v[40:43], v[204:207], v[32:35]
    v_mfma_f32_16x16x32_bf16 v[36:39], v[44:47], v[204:207], v[36:39]
    s_waitcnt vmcnt(27)
    v_mfma_f32_16x16x32_bf16 v[32:35], v[40:43], v[208:211], v[32:35]
    v_mfma_f32_16x16x32_bf16 v[36:39], v[44:47], v[208:211], v[36:39]
    s_waitcnt vmcnt(26)
    v_mfma_f32_16x16x32_bf16 v[32:35], v[40:43], v[212:215], v[32:35]
    v_mfma_f32_16x16x32_bf16 v[36:39], v[44:47], v[212:215], v[36:39]
    s_waitcnt vmcnt(25)
    v_mfma_f32_16x16x32_bf16 v[32:35], v[40:43], v[216:219], v[32:35]
    v_mfma_f32_16x16x32_bf16 v[36:39], v[44:47], v[216:219], v[36:39]
    s_waitcnt vmcnt(24)
    v_mfma_f32_16x16x32_bf16 v[32:35], v[40:43], v[220:223], v[32:35]
    v_mfma_f32_16x16x32_bf16 v[36:39], v[44:47], v[220:223], v[36:39]
    s_waitcnt vmcnt(23)
    v_mfma_f32_16x16x32_bf16 v[32:35], v[40:43], v[224:227], v[32:35]
    v_mfma_f32_16x16x32_bf16 v[36:39], v[44:47], v[224:227], v[36:39]
    s_waitcnt vmcnt(22)
    v_mfma_f32_16x16x32_bf16 v[32:35], v[40:43], v[228:231], v[32:35]
    v_mfma_f32_16x16x32_bf16 v[36:39], v[44:47], v[228:231], v[36:39]
    s_waitcnt vmcnt(21)
    v_mfma_f32_16x16x32_bf16 v[32:35], v[40:43], v[232:235], v[32:35]
    v_mfma_f32_16x16x32_bf16 v[36:39], v[44:47], v[232:235], v[36:39]
    s_waitcnt vmcnt(20)
    v_mfma_f32_16x16x32_bf16 v[32:35], v[40:43], v[236:239], v[32:35]
    v_mfma_f32_16x16x32_bf16 v[36:39], v[44:47], v[236:239], v[36:39]
    s_waitcnt vmcnt(19)
    v_mfma_f32_16x16x32_bf16 v[32:35], v[40:43], v[240:243], v[32:35]
    v_mfma_f32_16x16x32_bf16 v[36:39], v[44:47], v[240:243], v[36:39]
    s_waitcnt vmcnt(18)
    v_mfma_f32_16x16x32_bf16 v[32:35], v[40:43], v[244:247], v[32:35]
    v_mfma_f32_16x16x32_bf16 v[36:39], v[44:47], v[244:247], v[36:39]
    s_waitcnt vmcnt(17)
    v_mfma_f32_16x16x32_bf16 v[32:35], v[40:43], v[248:251], v[32:35]
    v_mfma_f32_16x16x32_bf16 v[36:39], v[44:47], v[248:251], v[36:39]
    s_waitcnt vmcnt(16)
    v_mfma_f32_16x16x32_bf16 v[32:35], v[40:43], v[252:255], v[32:35]
    v_mfma_f32_16x16x32_bf16 v[36:39], v[44:47], v[252:255], v[36:39]
    s_nop 7
    v_cvt_pk_bf16_f32 v96, v32, v33
    v_cvt_pk_bf16_f32 v97, v34, v35
    v_cvt_pk_bf16_f32 v98, v36, v37
    v_cvt_pk_bf16_f32 v99, v38, v39
    buffer_store_dwordx4 v[96:99], v93, s[8:11], s32 offen
    s_branch L_haveB
L_slowB:
    global_load_dword v95, v92, s[84:85] sc1
    s_waitcnt vmcnt(16)
    v_mfma_f32_16x16x32_bf16 v[32:35], v[40:43], v[192:195], 0
    v_mfma_f32_16x16x32_bf16 v[36:39], v[44:47], v[192:195], 0
    s_waitcnt vmcnt(15)
    v_mfma_f32_16x16x32_bf16 v[32:35], v[40:43], v[196:199], v[32:35]
    v_mfma_f32_16x16x32_bf16 v[36:39], v[44:47], v[196:199], v[36:39]
    s_waitcnt vmcnt(14)
    v_mfma_f32_16x16x32_bf16 v[32:35], v[40:43], v[200:203], v[32:35]
    v_mfma_f32_16x16x32_bf16 v[36:39], v[44:47], v[200:203], v[36:39]
    s_waitcnt vmcnt(13)
    v_mfma_f32_16x16x32_bf16 v[32:35], v[40:43], v[204:207], v[32:35]
    v_mfma_f32_16x16x32_bf16 v[36:39], v[44:47], v[204:207], v[36:39]
    s_waitcnt vmcnt(12)
    v_mfma_f32_16x16x32_bf16 v[32:35], v[40:43], v[208:211], v[32:35]
    v_mfma_f32_16x16x32_bf16 v[36:39], v[44:47], v[208:211], v[36:39]
    s_waitcnt vmcnt(11)
    v_mfma_f32_16x16x32_bf16 v[32:35], v[40:43], v[212:215], v[32:35]
    v_mfma_f32_16x16x32_bf16 v[36:39], v[44:47], v[212:215], v[36:39]
    s_waitcnt vmcnt(10)
    v_mfma_f32_16x16x32_bf16 v[32:35], v[40:43], v[216:219], v[32:35]
    v_mfma_f32_16x16x32_bf16 v[36:39], v[44:47], v[216:219], v[36:39]
    s_waitcnt vmcnt(9)
    v_mfma_f32_16x16x32_bf16 v[32:35], v[40:43], v[220:223], v[32:35]
    v_mfma_f32_16x16x32_bf16 v[36:39], v[44:47], v[220:223], v[36:39]
    s_waitcnt vmcnt(8)
    v_mfma_f32_16x16x32_bf16 v[32:35], v[40:43], v[224:227], v[32:35]
    v_mfma_f32_16x16x32_bf16 v[36:39], v[44:47], v[224:227], v[36:39]
    s_waitcnt vmcnt(7)
    v_mfma_f32_16x16x32_bf16 v[32:35], v[40:43], v[228:231], v[32:35]
    v_mfma_f32_16x16x32_bf16 v[36:39], v[44:47], v[228:231], v[36:39]
    s_waitcnt vmcnt(6)
    v_mfma_f32_16x16x32_bf16 v[32:35], v[40:43], v[232:235], v[32:35]
    v_mfma_f32_16x16x32_bf16 v[36:39], v[44:47], v[232:235], v[36:39]
    s_waitcnt vmcnt(5)
    v_mfma_f32_16x16x32_bf16 v[32:35], v[40:43], v[236:239], v[32:35]
    v_mfma_f32_16x16x32_bf16 v[36:39], v[44:47], v[236:239], v[36:39]
    s_waitcnt vmcnt(4)
    v_mfma_f32_16x16x32_bf16 v[32:35], v[40:43], v[240:243], v[32:35]
    v_mfma_f32_16x16x32_bf16 v[36:39], v[44:47], v[240:243], v[36:39]
    s_waitcnt vmcnt(3)
    v_mfma_f32_16x16x32_bf16 v[32:35], v[40:43], v[244:247], v[32:35]
    v_mfma_f32_16x16x32_bf16 v[36:39], v[44:47], v[244:247], v[36:39]
    s_waitcnt vmcnt(2)
    v_mfma_f32_16x16x32_bf16 v[32:35], v[40:43], v[248:251], v[32:35]
    v_mfma_f32_16x16x32_bf16 v[36:39], v[44:47], v[248:251], v[36:39]
    s_waitcnt vmcnt(1)
    v_mfma_f32_16x16x32_bf16 v[32:35], v[40:43], v[252:255], v[32:35]
    v_mfma_f32_16x16x32_bf16 v[36:39], v[44:47], v[252:255], v[36:39]
    s_nop 7
    v_cvt_pk_bf16_f32 v96, v32, v33
    v_cvt_pk_bf16_f32 v97, v34, v35
    v_cvt_pk_bf16_f32 v98, v36, v37
    v_cvt_pk_bf16_f32 v99, v38, v39
    buffer_store_dwordx4 v[96:99], v93, s[8:11], s32 offen
    s_waitcnt vmcnt(1)
    s_mov_b32 s34, 0
L_pollB:
    v_cmp_gt_u32 vcc, s29, v95
    s_and_b64 vcc, vcc, s[86:87]
    s_cbranch_scc0 L_pdoneB
    s_cmp_ge_u32 s34, 0x20000
    s_cbranch_scc1 L_pdoneB
    s_sleep 2
    global_load_dword v95, v92, s[84:85] sc1
    s_add_u32 s34, s34, 1
    s_waitcnt vmcnt(0)
    s_branch L_pollB
L_pdoneB:
    s_add_u32 s47, s31, 0
    buffer_load_dwordx4 v[128:131], v16, s[4:7], s47 offen sc1
    s_add_u32 s47, s31, 114688
    buffer_load_dwordx4 v[132:135], v16, s[4:7], s47 offen sc1
    s_add_u32 s47, s31, 229376
    buffer_load_dwordx4 v[136:139], v16, s[4:7], s47 offen sc1
    s_add_u32 s47, s31, 344064
    buffer_load_dwordx4 v[140:143], v16, s[4:7], s47 offen sc1
    s_add_u32 s47, s31, 458752
    buffer_load_dwordx4 v[144:147], v16, s[4:7], s47 offen sc1
    s_add_u32 s47, s31, 573440
    buffer_load_dwordx4 v[148:151], v16, s[4:7], s47 offen sc1
    s_add_u32 s47, s31, 688128
    buffer_load_dwordx4 v[152:155], v16, s[4:7], s47 offen sc1
    s_add_u32 s47, s31, 802816
    buffer_load_dwordx4 v[156:159], v16, s[4:7], s47 offen sc1
    s_add_u32 s47, s31, 917504
    buffer_load_dwordx4 v[160:163], v16, s[4:7], s47 offen sc1
    s_add_u32 s47, s31, 1032192
    buffer_load_dwordx4 v[164:167], v16, s[4:7], s47 offen sc1
    s_add_u32 s47, s31, 1146880
    buffer_load_dwordx4 v[168:171], v16, s[4:7], s47 offen sc1
    s_add_u32 s47, s31, 1261568
    buffer_load_dwordx4 v[172:175], v16, s[4:7], s47 offen sc1
    s_add_u32 s47, s31, 1376256
    buffer_load_dwordx4 v[176:179], v16, s[4:7], s47 offen sc1
    s_add_u32 s47, s31, 1490944
    buffer_load_dwordx4 v[180:183], v16, s[4:7], s47 offen sc1
    s_add_u32 s47, s31, 1605632
    buffer_load_dwordx4 v[184:187], v16, s[4:7], s47 offen sc1
    s_add_u32 s47, s31, 1720320
    buffer_load_dwordx4 v[188:191], v16, s[4:7], s47 offen sc1
L_haveB:
    s_cmp_eq_u32 s29, 0
    s_cbranch_scc1 L_fin
    s_waitcnt vmcnt(15)
    v_mfma_f32_16x16x32_bf16 v[32:35], v[40:43], v[128:131], 0
    v_mfma_f32_16x16x32_bf16 v[36:39], v[44:47], v[128:131], 0
    s_waitcnt vmcnt(14)
    v_mfma_f32_16x16x32_bf16 v[32:35], v[40:43], v[132:135], v[32:35]
    v_mfma_f32_16x16x32_bf16 v[36:39], v[44:47], v[132:135], v[36:39]
    s_waitcnt vmcnt(13)
    v_mfma_f32_16x16x32_bf16 v[32:35], v[40:43], v[136:139], v[32:35]
    v_mfma_f32_16x16x32_bf16 v[36:39], v[44:47], v[136:139], v[36:39]
    s_waitcnt vmcnt(12)
    v_mfma_f32_16x16x32_bf16 v[32:35], v[40:43], v[140:143], v[32:35]
    v_mfma_f32_16x16x32_bf16 v[36:39], v[44:47], v[140:143], v[36:39]
    s_waitcnt vmcnt(11)
    v_mfma_f32_16x16x32_bf16 v[32:35], v[40:43], v[144:147], v[32:35]
    v_mfma_f32_16x16x32_bf16 v[36:39], v[44:47], v[144:147], v[36:39]
    s_waitcnt vmcnt(10)
    v_mfma_f32_16x16x32_bf16 v[32:35], v[40:43], v[148:151], v[32:35]
    v_mfma_f32_16x16x32_bf16 v[36:39], v[44:47], v[148:151], v[36:39]
    s_waitcnt vmcnt(9)
    v_mfma_f32_16x16x32_bf16 v[32:35], v[40:43], v[152:155], v[32:35]
    v_mfma_f32_16x16x32_bf16 v[36:39], v[44:47], v[152:155], v[36:39]
    s_waitcnt vmcnt(8)
    v_mfma_f32_16x16x32_bf16 v[32:35], v[40:43], v[156:159], v[32:35]
    v_mfma_f32_16x16x32_bf16 v[36:39], v[44:47], v[156:159], v[36:39]
    s_waitcnt vmcnt(7)
    v_mfma_f32_16x16x32_bf16 v[32:35], v[40:43], v[160:163], v[32:35]
    v_mfma_f32_16x16x32_bf16 v[36:39], v[44:47], v[160:163], v[36:39]
    s_waitcnt vmcnt(6)
    v_mfma_f32_16x16x32_bf16 v[32:35], v[40:43], v[164:167], v[32:35]
    v_mfma_f32_16x16x32_bf16 v[36:39], v[44:47], v[164:167], v[36:39]
    s_waitcnt vmcnt(5)
    v_mfma_f32_16x16x32_bf16 v[32:35], v[40:43], v[168:171], v[32:35]
    v_mfma_f32_16x16x32_bf16 v[36:39], v[44:47], v[168:171], v[36:39]
    s_waitcnt vmcnt(4)
    v_mfma_f32_16x16x32_bf16 v[32:35], v[40:43], v[172:175], v[32:35]
    v_mfma_f32_16x16x32_bf16 v[36:39], v[44:47], v[172:175], v[36:39]
    s_waitcnt vmcnt(3)
    v_mfma_f32_16x16x32_bf16 v[32:35], v[40:43], v[176:179], v[32:35]
    v_mfma_f32_16x16x32_bf16 v[36:39], v[44:47], v[176:179], v[36:39]
    s_waitcnt vmcnt(2)
    v_mfma_f32_16x16x32_bf16 v[32:35], v[40:43], v[180:183], v[32:35]
    v_mfma_f32_16x16x32_bf16 v[36:39], v[44:47], v[180:183], v[36:39]
    s_waitcnt vmcnt(1)
    v_mfma_f32_16x16x32_bf16 v[32:35], v[40:43], v[184:187], v[32:35]
    v_mfma_f32_16x16x32_bf16 v[36:39], v[44:47], v[184:187], v[36:39]
    s_waitcnt vmcnt(0)
    v_mfma_f32_16x16x32_bf16 v[32:35], v[40:43], v[188:191], v[32:35]
    v_mfma_f32_16x16x32_bf16 v[36:39], v[44:47], v[188:191], v[36:39]
    s_nop 7
    v_cvt_pk_bf16_f32 v100, v32, v33
    v_cvt_pk_bf16_f32 v101, v34, v35
    v_cvt_pk_bf16_f32 v102, v36, v37
    v_cvt_pk_bf16_f32 v103, v38, v39
    buffer_store_dwordx4 v[100:103], v93, s[8:11], s33 offen
L_fin:
L_end:
    s_endpgm
L_code_end:
T_rdy:
    s_mov_b32 s34, 0
T_rdy2:
    global_load_dword v95, v3, s[82:83] sc1
    s_add_u32 s34, s34, 1
    s_waitcnt vmcnt(0)
    v_cmp_gt_u32 vcc, 16, v95
    s_cbranch_vccz B_rdy
    s_cmp_ge_u32 s34, 0x20000
    s_cbranch_scc1 B_rdy
    s_sleep 4
    s_branch T_rdy2
T_c0:
    s_nop 15
    v_accvgpr_read_b32 v112, a0
    v_accvgpr_read_b32 v113, a1
    v_accvgpr_read_b32 v114, a2
    v_accvgpr_read_b32 v115, a3
    v_accvgpr_read_b32 v116, a4
    v_accvgpr_read_b32 v117, a5
    v_accvgpr_read_b32 v118, a6
    v_accvgpr_read_b32 v119, a7
    v_accvgpr_read_b32 v120, a8
    v_accvgpr_read_b32 v121, a9
    v_accvgpr_read_b32 v122, a10
    v_accvgpr_read_b32 v123, a11
    v_accvgpr_read_b32 v124, a12
    v_accvgpr_read_b32 v125, a13
    v_accvgpr_read_b32 v126, a14
    v_accvgpr_read_b32 v127, a15
    s_call_b64 s[40:41], R_f
    s_call_b64 s[40:41], A_1
    s_branch B_c0
T_c1:
    s_nop 15
    v_mov_b32 v112, v48
    v_mov_b32 v113, v49
    v_mov_b32 v114, v50
    v_mov_b32 v115, v51
    v_mov_b32 v116, v52
    v_mov_b32 v117, v53
    v_mov_b32 v118, v54
    v_mov_b32 v119, v55
    v_mov_b32 v120, v56
    v_mov_b32 v121, v57
    v_mov_b32 v122, v58
    v_mov_b32 v123, v59
    v_mov_b32 v124, v60
    v_mov_b32 v125, v61
    v_mov_b32 v126, v62
    v_mov_b32 v127, v63
    s_call_b64 s[40:41], R_1
    s_call_b64 s[40:41], A_1
    s_branch B_c1
T_c2:
    s_nop 15
    v_accvgpr_read_b32 v112, a16
    v_accvgpr_read_b32 v113, a17
    v_accvgpr_read_b32 v114, a18
    v_accvgpr_read_b32 v115, a19
    v_accvgpr_read_b32 v116, a20
    v_accvgpr_read_b32 v117, a21
    v_accvgpr_read_b32 v118, a22
    v_accvgpr_read_b32 v119, a23
    v_accvgpr_read_b32 v120, a24
    v_accvgpr_read_b32 v121, a25
    v_accvgpr_read_b32 v122, a26
    v_accvgpr_read_b32 v123, a27
    v_accvgpr_read_b32 v124, a28
    v_accvgpr_read_b32 v125, a29
    v_accvgpr_read_b32 v126, a30
    v_accvgpr_read_b32 v127, a31
    s_call_b64 s[40:41], R_0
    s_call_b64 s[40:41], A_2
    s_branch B_c2
T_c3:
    s_nop 15
    v_mov_b32 v112, v48
    v_mov_b32 v113, v49
    v_mov_b32 v114, v50
    v_mov_b32 v115, v51
    v_mov_b32 v116, v52
    v_mov_b32 v117, v53
    v_mov_b32 v118, v54
    v_mov_b32 v119, v55
    v_mov_b32 v120, v56
    v_mov_b32 v121, v57
    v_mov_b32 v122, v58
    v_mov_b32 v123, v59
    v_mov_b32 v124, v60
    v_mov_b32 v125, v61
    v_mov_b32 v126, v62
    v_mov_b32 v127, v63
    s_call_b64 s[40:41], R_1
    s_call_b64 s[40:41], A_2
    s_branch B_c3
T_c4:
    s_nop 15
    v_accvgpr_read_b32 v112, a32
    v_accvgpr_read_b32 v113, a33
    v_accvgpr_read_b32 v114, a34
    v_accvgpr_read_b32 v115, a35
    v_accvgpr_read_b32 v116, a36
    v_accvgpr_read_b32 v117, a37
    v_accvgpr_read_b32 v118, a38
    v_accvgpr_read_b32 v119, a39
    v_accvgpr_read_b32 v120, a40
    v_accvgpr_read_b32 v121, a41
    v_accvgpr_read_b32 v122, a42
    v_accvgpr_read_b32 v123, a43
    v_accvgpr_read_b32 v124, a44
    v_accvgpr_read_b32 v125, a45
    v_accvgpr_read_b32 v126, a46
    v_accvgpr_read_b32 v127, a47
    s_call_b64 s[40:41], R_0
    s_call_b64 s[40:41], A_3
    s_branch B_c4
T_c5:
    s_nop 15
    v_mov_b32 v112, v48
    v_mov_b32 v113, v49
    v_mov_b32 v114, v50
    v_mov_b32 v115, v51
    v_mov_b32 v116, v52
    v_mov_b32 v117, v53
    v_mov_b32 v118, v54
    v_mov_b32 v119, v55
    v_mov_b32 v120, v56
    v_mov_b32 v121, v57
    v_mov_b32 v122, v58
    v_mov_b32 v123, v59
    v_mov_b32 v124, v60
    v_mov_b32 v125, v61
    v_mov_b32 v126, v62
    v_mov_b32 v127, v63
    s_call_b64 s[40:41], R_1
    s_call_b64 s[40:41], A_3
    s_branch B_c5
T_c6:
    s_nop 15
    v_accvgpr_read_b32 v112, a48
    v_accvgpr_read_b32 v113, a49
    v_accvgpr_read_b32 v114, a50
    v_accvgpr_read_b32 v115, a51
    v_accvgpr_read_b32 v116, a52
    v_accvgpr_read_b32 v117, a53
    v_accvgpr_read_b32 v118, a54
    v_accvgpr_read_b32 v119, a55
    v_accvgpr_read_b32 v120, a56
    v_accvgpr_read_b32 v121, a57
    v_accvgpr_read_b32 v122, a58
    v_accvgpr_read_b32 v123, a59
    v_accvgpr_read_b32 v124, a60
    v_accvgpr_read_b32 v125, a61
    v_accvgpr_read_b32 v126, a62
    v_accvgpr_read_b32 v127, a63
    s_call_b64 s[40:41], R_0
    s_call_b64 s[40:41], A_4
    s_branch B_c6
T_c7:
    s_nop 15
    v_mov_b32 v112, v48
    v_mov_b32 v113, v49
    v_mov_b32 v114, v50
    v_mov_b32 v115, v51
    v_mov_b32 v116, v52
    v_mov_b32 v117, v53
    v_mov_b32 v118, v54
    v_mov_b32 v119, v55
    v_mov_b32 v120, v56
    v_mov_b32 v121, v57
    v_mov_b32 v122, v58
    v_mov_b32 v123, v59
    v_mov_b32 v124, v60
    v_mov_b32 v125, v61
    v_mov_b32 v126, v62
    v_mov_b32 v127, v63
    s_call_b64 s[40:41], R_1
    s_call_b64 s[40:41], A_4
    s_branch B_c7
T_c8:
    s_nop 15
    v_accvgpr_read_b32 v112, a64
    v_accvgpr_read_b32 v113, a65
    v_accvgpr_read_b32 v114, a66
    v_accvgpr_read_b32 v115, a67
    v_accvgpr_read_b32 v116, a68
    v_accvgpr_read_b32 v117, a69
    v_accvgpr_read_b32 v118, a70
    v_accvgpr_read_b32 v119, a71
    v_accvgpr_read_b32 v120, a72
    v_accvgpr_read_b32 v121, a73
    v_accvgpr_read_b32 v122, a74
    v_accvgpr_read_b32 v123, a75
    v_accvgpr_read_b32 v124, a76
    v_accvgpr_read_b32 v125, a77
    v_accvgpr_read_b32 v126, a78
    v_accvgpr_read_b32 v127, a79
    s_call_b64 s[40:41], R_0
    s_call_b64 s[40:41], A_5
    s_branch B_c8
T_c9:
    s_nop 15
    v_mov_b32 v112, v48
    v_mov_b32 v113, v49
    v_mov_b32 v114, v50
    v_mov_b32 v115, v51
    v_mov_b32 v116, v52
    v_mov_b32 v117, v53
    v_mov_b32 v118, v54
    v_mov_b32 v119, v55
    v_mov_b32 v120, v56
    v_mov_b32 v121, v57
    v_mov_b32 v122, v58
    v_mov_b32 v123, v59
    v_mov_b32 v124, v60
    v_mov_b32 v125, v61
    v_mov_b32 v126, v62
    v_mov_b32 v127, v63
    s_call_b64 s[40:41], R_1
    s_call_b64 s[40:41], A_5
    s_branch B_c9
T_c10:
    s_nop 15
    v_accvgpr_read_b32 v112, a80
    v_accvgpr_read_b32 v113, a81
    v_accvgpr_read_b32 v114, a82
    v_accvgpr_read_b32 v115, a83
    v_accvgpr_read_b32 v116, a84
    v_accvgpr_read_b32 v117, a85
    v_accvgpr_read_b32 v118, a86
    v_accvgpr_read_b32 v119, a87
    v_accvgpr_read_b32 v120, a88
    v_accvgpr_read_b32 v121, a89
    v_accvgpr_read_b32 v122, a90
    v_accvgpr_read_b32 v123, a91
    v_accvgpr_read_b32 v124, a92
    v_accvgpr_read_b32 v125, a93
    v_accvgpr_read_b32 v126, a94
    v_accvgpr_read_b32 v127, a95
    s_call_b64 s[40:41], R_0
    s_call_b64 s[40:41], A_6
    s_branch B_c10
T_c11:
    s_nop 15
    v_mov_b32 v112, v48
    v_mov_b32 v113, v49
    v_mov_b32 v114, v50
    v_mov_b32 v115, v51
    v_mov_b32 v116, v52
    v_mov_b32 v117, v53
    v_mov_b32 v118, v54
    v_mov_b32 v119, v55
    v_mov_b32 v120, v56
    v_mov_b32 v121, v57
    v_mov_b32 v122, v58
    v_mov_b32 v123, v59
    v_mov_b32 v124, v60
    v_mov_b32 v125, v61
    v_mov_b32 v126, v62
    v_mov_b32 v127, v63
    s_call_b64 s[40:41], R_1
    s_call_b64 s[40:41], A_6
    s_branch B_c11
T_c12:
    s_nop 15
    v_accvgpr_read_b32 v112, a96
    v_accvgpr_read_b32 v113, a97
    v_accvgpr_read_b32 v114, a98
    v_accvgpr_read_b32 v115, a99
    v_accvgpr_read_b32 v116, a100
    v_accvgpr_read_b32 v117, a101
    v_accvgpr_read_b32 v118, a102
    v_accvgpr_read_b32 v119, a103
    v_accvgpr_read_b32 v120, a104
    v_accvgpr_read_b32 v121, a105
    v_accvgpr_read_b32 v122, a106
    v_accvgpr_read_b32 v123, a107
    v_accvgpr_read_b32 v124, a108
    v_accvgpr_read_b32 v125, a109
    v_accvgpr_read_b32 v126, a110
    v_accvgpr_read_b32 v127, a111
    s_call_b64 s[40:41], R_0
    s_call_b64 s[40:41], A_7
    s_branch B_c12
T_c13:
    s_nop 15
    v_mov_b32 v112, v48
    v_mov_b32 v113, v49
    v_mov_b32 v114, v50
    v_mov_b32 v115, v51
    v_mov_b32 v116, v52
    v_mov_b32 v117, v53
    v_mov_b32 v118, v54
    v_mov_b32 v119, v55
    v_mov_b32 v120, v56
    v_mov_b32 v121, v57
    v_mov_b32 v122, v58
    v_mov_b32 v123, v59
    v_mov_b32 v124, v60
    v_mov_b32 v125, v61
    v_mov_b32 v126, v62
    v_mov_b32 v127, v63
    s_call_b64 s[40:41], R_1
    s_call_b64 s[40:41], A_7
    s_branch B_c13
T_c14:
    s_nop 15
    v_accvgpr_read_b32 v112, a112
    v_accvgpr_read_b32 v113, a113
    v_accvgpr_read_b32 v114, a114
    v_accvgpr_read_b32 v115, a115
    v_accvgpr_read_b32 v116, a116
    v_accvgpr_read_b32 v117, a117
    v_accvgpr_read_b32 v118, a118
    v_accvgpr_read_b32 v119, a119
    v_accvgpr_read_b32 v120, a120
    v_accvgpr_read_b32 v121, a121
    v_accvgpr_read_b32 v122, a122
    v_accvgpr_read_b32 v123, a123
    v_accvgpr_read_b32 v124, a124
    v_accvgpr_read_b32 v125, a125
    v_accvgpr_read_b32 v126, a126
    v_accvgpr_read_b32 v127, a127
    s_call_b64 s[40:41], R_0
    s_branch B_c14
T_c15:
    s_nop 15
    v_mov_b32 v112, v48
    v_mov_b32 v113, v49
    v_mov_b32 v114, v50
    v_mov_b32 v115, v51
    v_mov_b32 v116, v52
    v_mov_b32 v117, v53
    v_mov_b32 v118, v54
    v_mov_b32 v119, v55
    v_mov_b32 v120, v56
    v_mov_b32 v121, v57
    v_mov_b32 v122, v58
    v_mov_b32 v123, v59
    v_mov_b32 v124, v60
    v_mov_b32 v125, v61
    v_mov_b32 v126, v62
    v_mov_b32 v127, v63
    s_call_b64 s[40:41], R_1
    s_branch B_c15
R_f:
    v_max3_f32 v26, v112, v113, v114
    v_max3_f32 v26, v26, v115, v116
    v_max3_f32 v26, v26, v117, v118
    v_max_f32 v26, v26, v119
    v_mov_b32 v27, v26
    s_nop 1
    v_permlane32_swap_b32 v26, v27
    v_max_f32 v26, v26, v27
    v_mov_b32 v27, v26
    s_nop 1
    v_permlane16_swap_b32 v26, v27
    v_max_f32 v26, v26, v27
    v_sub_f32 v112, v112, v26
    v_sub_f32 v113, v113, v26
    v_sub_f32 v114, v114, v26
    v_sub_f32 v115, v115, v26
    v_sub_f32 v116, v116, v26
    v_sub_f32 v117, v117, v26
    v_sub_f32 v118, v118, v26
    v_sub_f32 v119, v119, v26
    v_sub_f32 v48, v48, v26
    v_sub_f32 v49, v49, v26
    v_sub_f32 v50, v50, v26
    v_sub_f32 v51, v51, v26
    v_sub_f32 v52, v52, v26
    v_sub_f32 v53, v53, v26
    v_sub_f32 v54, v54, v26
    v_sub_f32 v55, v55, v26
    v_sub_f32 v40, v40, v26
    v_sub_f32 v41, v41, v26
    v_sub_f32 v42, v42, v26
    v_sub_f32 v43, v43, v26
    v_max3_f32 v28, v120, v121, v122
    v_max3_f32 v28, v28, v123, v124
    v_max3_f32 v28, v28, v125, v126
    v_max_f32 v28, v28, v127
    v_mov_b32 v29, v28
    s_nop 1
    v_permlane32_swap_b32 v28, v29
    v_max_f32 v28, v28, v29
    v_mov_b32 v29, v28
    s_nop 1
    v_permlane16_swap_b32 v28, v29
    v_max_f32 v28, v28, v29
    v_sub_f32 v120, v120, v28
    v_sub_f32 v121, v121, v28
    v_sub_f32 v122, v122, v28
    v_sub_f32 v123, v123, v28
    v_sub_f32 v124, v124, v28
    v_sub_f32 v125, v125, v28
    v_sub_f32 v126, v126, v28
    v_sub_f32 v127, v127, v28
    v_sub_f32 v56, v56, v28
    v_sub_f32 v57, v57, v28
    v_sub_f32 v58, v58, v28
    v_sub_f32 v59, v59, v28
    v_sub_f32 v60, v60, v28
    v_sub_f32 v61, v61, v28
    v_sub_f32 v62, v62, v28
    v_sub_f32 v63, v63, v28
    v_sub_f32 v44, v44, v28
    v_sub_f32 v45, v45, v28
    v_sub_f32 v46, v46, v28
    v_sub_f32 v47, v47, v28
    v_exp_f32 v112, v112
    v_exp_f32 v113, v113
    v_exp_f32 v114, v114
    v_exp_f32 v115, v115
    v_exp_f32 v116, v116
    v_exp_f32 v117, v117
    v_exp_f32 v118, v118
    v_exp_f32 v119, v119
    v_exp_f32 v120, v120
    v_exp_f32 v121, v121
    v_exp_f32 v122, v122
    v_exp_f32 v123, v123
    v_exp_f32 v124, v124
    v_exp_f32 v125, v125
    v_exp_f32 v126, v126
    v_exp_f32 v127, v127
    s_nop 0
    v_add_f32 v21, v23, v112
    v_add_f32 v21, v21, v113
    v_add_f32 v21, v21, v114
    v_add_f32 v21, v21, v115
    v_add_f32 v21, v21, v116
    v_add_f32 v21, v21, v117
    v_add_f32 v21, v21, v118
    v_add_f32 v21, v21, v119
    v_add_f32 v22, v24, v120
    v_add_f32 v22, v22, v121
    v_add_f32 v22, v22, v122
    v_add_f32 v22, v22, v123
    v_add_f32 v22, v22, v124
    v_add_f32 v22, v22, v125
    v_add_f32 v22, v22, v126
    v_add_f32 v22, v22, v127
    v_cvt_pk_bf16_f32 v96, v112, v113
    v_cvt_pk_bf16_f32 v97, v114, v115
    v_cvt_pk_bf16_f32 v98, v116, v117
    v_cvt_pk_bf16_f32 v99, v118, v119
    v_cvt_pk_bf16_f32 v100, v120, v121
    v_cvt_pk_bf16_f32 v101, v122, v123
    v_cvt_pk_bf16_f32 v102, v124, v125
    v_cvt_pk_bf16_f32 v103, v126, v127
    s_nop 1
    s_setpc_b64 s[40:41]
R_0:
    v_max3_f32 v26, v112, v113, v114
    v_max3_f32 v26, v26, v115, v116
    v_max3_f32 v26, v26, v117, v118
    v_max_f32 v26, v26, v119
    v_mov_b32 v27, v26
    s_nop 1
    v_permlane32_swap_b32 v26, v27
    v_max_f32 v26, v26, v27
    v_mov_b32 v27, v26
    s_nop 1
    v_permlane16_swap_b32 v26, v27
    v_max_f32 v26, v26, v27
    v_max_f32 v26, 0, v26
    v_exp_f32 v30, -v26
    v_sub_f32 v112, v112, v26
    v_sub_f32 v113, v113, v26
    v_sub_f32 v114, v114, v26
    v_sub_f32 v115, v115, v26
    v_sub_f32 v116, v116, v26
    v_sub_f32 v117, v117, v26
    v_sub_f32 v118, v118, v26
    v_sub_f32 v119, v119, v26
    v_sub_f32 v48, v48, v26
    v_sub_f32 v49, v49, v26
    v_sub_f32 v50, v50, v26
    v_sub_f32 v51, v51, v26
    v_sub_f32 v52, v52, v26
    v_sub_f32 v53, v53, v26
    v_sub_f32 v54, v54, v26
    v_sub_f32 v55, v55, v26
    v_sub_f32 v40, v40, v26
    v_sub_f32 v41, v41, v26
    v_sub_f32 v42, v42, v26
    v_sub_f32 v43, v43, v26
    v_mul_f32 v23, v23, v30
    v_max3_f32 v28, v120, v121, v122
    v_max3_f32 v28, v28, v123, v124
    v_max3_f32 v28, v28, v125, v126
    v_max_f32 v28, v28, v127
    v_mov_b32 v29, v28
    s_nop 1
    v_permlane32_swap_b32 v28, v29
    v_max_f32 v28, v28, v29
    v_mov_b32 v29, v28
    s_nop 1
    v_permlane16_swap_b32 v28, v29
    v_max_f32 v28, v28, v29
    v_max_f32 v28, 0, v28
    v_exp_f32 v31, -v28
    v_sub_f32 v120, v120, v28
    v_sub_f32 v121, v121, v28
    v_sub_f32 v122, v122, v28
    v_sub_f32 v123, v123, v28
    v_sub_f32 v124, v124, v28
    v_sub_f32 v125, v125, v28
    v_sub_f32 v126, v126, v28
    v_sub_f32 v127, v127, v28
    v_sub_f32 v56, v56, v28
    v_sub_f32 v57, v57, v28
    v_sub_f32 v58, v58, v28
    v_sub_f32 v59, v59, v28
    v_sub_f32 v60, v60, v28
    v_sub_f32 v61, v61, v28
    v_sub_f32 v62, v62, v28
    v_sub_f32 v63, v63, v28
    v_sub_f32 v44, v44, v28
    v_sub_f32 v45, v45, v28
    v_sub_f32 v46, v46, v28
    v_sub_f32 v47, v47, v28
    v_mul_f32 v24, v24, v31
    v_exp_f32 v112, v112
    v_exp_f32 v113, v113
    v_exp_f32 v114, v114
    v_exp_f32 v115, v115
    v_exp_f32 v116, v116
    v_exp_f32 v117, v117
    v_exp_f32 v118, v118
    v_exp_f32 v119, v119
    v_exp_f32 v120, v120
    v_exp_f32 v121, v121
    v_exp_f32 v122, v122
    v_exp_f32 v123, v123
    v_exp_f32 v124, v124
    v_exp_f32 v125, v125
    v_exp_f32 v126, v126
    v_exp_f32 v127, v127
    s_nop 0
    v_add_f32 v21, v23, v112
    v_add_f32 v21, v21, v113
    v_add_f32 v21, v21, v114
    v_add_f32 v21, v21, v115
    v_add_f32 v21, v21, v116
    v_add_f32 v21, v21, v117
    v_add_f32 v21, v21, v118
    v_add_f32 v21, v21, v119
    v_add_f32 v22, v24, v120
    v_add_f32 v22, v22, v121
    v_add_f32 v22, v22, v122
    v_add_f32 v22, v22, v123
    v_add_f32 v22, v22, v124
    v_add_f32 v22, v22, v125
    v_add_f32 v22, v22, v126
    v_add_f32 v22, v22, v127
    v_cvt_pk_bf16_f32 v96, v112, v113
    v_cvt_pk_bf16_f32 v97, v114, v115
    v_cvt_pk_bf16_f32 v98, v116, v117
    v_cvt_pk_bf16_f32 v99, v118, v119
    v_cvt_pk_bf16_f32 v100, v120, v121
    v_cvt_pk_bf16_f32 v101, v122, v123
    v_cvt_pk_bf16_f32 v102, v124, v125
    v_cvt_pk_bf16_f32 v103, v126, v127
    v_mul_f32 v128, v128, v30
    v_mul_f32 v129, v129, v30
    v_mul_f32 v130, v130, v30
    v_mul_f32 v131, v131, v30
    v_mul_f32 v132, v132, v31
    v_mul_f32 v133, v133, v31
    v_mul_f32 v134, v134, v31
    v_mul_f32 v135, v135, v31
    v_mul_f32 v136, v136, v30
    v_mul_f32 v137, v137, v30
    v_mul_f32 v138, v138, v30
    v_mul_f32 v139, v139, v30
    v_mul_f32 v140, v140, v31
    v_mul_f32 v141, v141, v31
    v_mul_f32 v142, v142, v31
    v_mul_f32 v143, v143, v31
    v_mul_f32 v144, v144, v30
    v_mul_f32 v145, v145, v30
    v_mul_f32 v146, v146, v30
    v_mul_f32 v147, v147, v30
    v_mul_f32 v148, v148, v31
    v_mul_f32 v149, v149, v31
    v_mul_f32 v150, v150, v31
    v_mul_f32 v151, v151, v31
    v_mul_f32 v152, v152, v30
    v_mul_f32 v153, v153, v30
    v_mul_f32 v154, v154, v30
    v_mul_f32 v155, v155, v30
    v_mul_f32 v156, v156, v31
    v_mul_f32 v157, v157, v31
    v_mul_f32 v158, v158, v31
    v_mul_f32 v159, v159, v31
    v_mul_f32 v160, v160, v30
    v_mul_f32 v161, v161, v30
    v_mul_f32 v162, v162, v30
    v_mul_f32 v163, v163, v30
    v_mul_f32 v164, v164, v31
    v_mul_f32 v165, v165, v31
    v_mul_f32 v166, v166, v31
    v_mul_f32 v167, v167, v31
    v_mul_f32 v168, v168, v30
    v_mul_f32 v169, v169, v30
    v_mul_f32 v170, v170, v30
    v_mul_f32 v171, v171, v30
    v_mul_f32 v172, v172, v31
    v_mul_f32 v173, v173, v31
    v_mul_f32 v174, v174, v31
    v_mul_f32 v175, v175, v31
    v_mul_f32 v176, v176, v30
    v_mul_f32 v177, v177, v30
    v_mul_f32 v178, v178, v30
    v_mul_f32 v179, v179, v30
    v_mul_f32 v180, v180, v31
    v_mul_f32 v181, v181, v31
    v_mul_f32 v182, v182, v31
    v_mul_f32 v183, v183, v31
    v_mul_f32 v184, v184, v30
    v_mul_f32 v185, v185, v30
    v_mul_f32 v186, v186, v30
    v_mul_f32 v187, v187, v30
    v_mul_f32 v188, v188, v31
    v_mul_f32 v189, v189, v31
    v_mul_f32 v190, v190, v31
    v_mul_f32 v191, v191, v31
    v_mul_f32 v192, v192, v30
    v_mul_f32 v193, v193, v30
    v_mul_f32 v194, v194, v30
    v_mul_f32 v195, v195, v30
    v_mul_f32 v196, v196, v31
    v_mul_f32 v197, v197, v31
    v_mul_f32 v198, v198, v31
    v_mul_f32 v199, v199, v31
    v_mul_f32 v200, v200, v30
    v_mul_f32 v201, v201, v30
    v_mul_f32 v202, v202, v30
    v_mul_f32 v203, v203, v30
    v_mul_f32 v204, v204, v31
    v_mul_f32 v205, v205, v31
    v_mul_f32 v206, v206, v31
    v_mul_f32 v207, v207, v31
    v_mul_f32 v208, v208, v30
    v_mul_f32 v209, v209, v30
    v_mul_f32 v210, v210, v30
    v_mul_f32 v211, v211, v30
    v_mul_f32 v212, v212, v31
    v_mul_f32 v213, v213, v31
    v_mul_f32 v214, v214, v31
    v_mul_f32 v215, v215, v31
    v_mul_f32 v216, v216, v30
    v_mul_f32 v217, v217, v30
    v_mul_f32 v218, v218, v30
    v_mul_f32 v219, v219, v30
    v_mul_f32 v220, v220, v31
    v_mul_f32 v221, v221, v31
    v_mul_f32 v222, v222, v31
    v_mul_f32 v223, v223, v31
    v_mul_f32 v224, v224, v30
    v_mul_f32 v225, v225, v30
    v_mul_f32 v226, v226, v30
    v_mul_f32 v227, v227, v30
    v_mul_f32 v228, v228, v31
    v_mul_f32 v229, v229, v31
    v_mul_f32 v230, v230, v31
    v_mul_f32 v231, v231, v31
    v_mul_f32 v232, v232, v30
    v_mul_f32 v233, v233, v30
    v_mul_f32 v234, v234, v30
    v_mul_f32 v235, v235, v30
    v_mul_f32 v236, v236, v31
    v_mul_f32 v237, v237, v31
    v_mul_f32 v238, v238, v31
    v_mul_f32 v239, v239, v31
    v_mul_f32 v240, v240, v30
    v_mul_f32 v241, v241, v30
    v_mul_f32 v242, v242, v30
    v_mul_f32 v243, v243, v30
    v_mul_f32 v244, v244, v31
    v_mul_f32 v245, v245, v31
    v_mul_f32 v246, v246, v31
    v_mul_f32 v247, v247, v31
    v_mul_f32 v248, v248, v30
    v_mul_f32 v249, v249, v30
    v_mul_f32 v250, v250, v30
    v_mul_f32 v251, v251, v30
    v_mul_f32 v252, v252, v31
    v_mul_f32 v253, v253, v31
    v_mul_f32 v254, v254, v31
    v_mul_f32 v255, v255, v31
    s_nop 1
    s_setpc_b64 s[40:41]
R_1:
    v_max3_f32 v26, v112, v113, v114
    v_max3_f32 v26, v26, v115, v116
    v_max3_f32 v26, v26, v117, v118
    v_max_f32 v26, v26, v119
    v_mov_b32 v27, v26
    s_nop 1
    v_permlane32_swap_b32 v26, v27
    v_max_f32 v26, v26, v27
    v_mov_b32 v27, v26
    s_nop 1
    v_permlane16_swap_b32 v26, v27
    v_max_f32 v26, v26, v27
    v_max_f32 v26, 0, v26
    v_exp_f32 v30, -v26
    v_sub_f32 v112, v112, v26
    v_sub_f32 v113, v113, v26
    v_sub_f32 v114, v114, v26
    v_sub_f32 v115, v115, v26
    v_sub_f32 v116, v116, v26
    v_sub_f32 v117, v117, v26
    v_sub_f32 v118, v118, v26
    v_sub_f32 v119, v119, v26
    v_sub_f32 v48, v48, v26
    v_sub_f32 v49, v49, v26
    v_sub_f32 v50, v50, v26
    v_sub_f32 v51, v51, v26
    v_sub_f32 v52, v52, v26
    v_sub_f32 v53, v53, v26
    v_sub_f32 v54, v54, v26
    v_sub_f32 v55, v55, v26
    v_sub_f32 v40, v40, v26
    v_sub_f32 v41, v41, v26
    v_sub_f32 v42, v42, v26
    v_sub_f32 v43, v43, v26
    v_mul_f32 v21, v21, v30
    v_max3_f32 v28, v120, v121, v122
    v_max3_f32 v28, v28, v123, v124
    v_max3_f32 v28, v28, v125, v126
    v_max_f32 v28, v28, v127
    v_mov_b32 v29, v28
    s_nop 1
    v_permlane32_swap_b32 v28, v29
    v_max_f32 v28, v28, v29
    v_mov_b32 v29, v28
    s_nop 1
    v_permlane16_swap_b32 v28, v29
    v_max_f32 v28, v28, v29
    v_max_f32 v28, 0, v28
    v_exp_f32 v31, -v28
    v_sub_f32 v120, v120, v28
    v_sub_f32 v121, v121, v28
    v_sub_f32 v122, v122, v28
    v_sub_f32 v123, v123, v28
    v_sub_f32 v124, v124, v28
    v_sub_f32 v125, v125, v28
    v_sub_f32 v126, v126, v28
    v_sub_f32 v127, v127, v28
    v_sub_f32 v56, v56, v28
    v_sub_f32 v57, v57, v28
    v_sub_f32 v58, v58, v28
    v_sub_f32 v59, v59, v28
    v_sub_f32 v60, v60, v28
    v_sub_f32 v61, v61, v28
    v_sub_f32 v62, v62, v28
    v_sub_f32 v63, v63, v28
    v_sub_f32 v44, v44, v28
    v_sub_f32 v45, v45, v28
    v_sub_f32 v46, v46, v28
    v_sub_f32 v47, v47, v28
    v_mul_f32 v22, v22, v31
    v_exp_f32 v112, v112
    v_exp_f32 v113, v113
    v_exp_f32 v114, v114
    v_exp_f32 v115, v115
    v_exp_f32 v116, v116
    v_exp_f32 v117, v117
    v_exp_f32 v118, v118
    v_exp_f32 v119, v119
    v_exp_f32 v120, v120
    v_exp_f32 v121, v121
    v_exp_f32 v122, v122
    v_exp_f32 v123, v123
    v_exp_f32 v124, v124
    v_exp_f32 v125, v125
    v_exp_f32 v126, v126
    v_exp_f32 v127, v127
    s_nop 0
    v_add_f32 v23, v21, v112
    v_add_f32 v23, v23, v113
    v_add_f32 v23, v23, v114
    v_add_f32 v23, v23, v115
    v_add_f32 v23, v23, v116
    v_add_f32 v23, v23, v117
    v_add_f32 v23, v23, v118
    v_add_f32 v23, v23, v119
    v_add_f32 v24, v22, v120
    v_add_f32 v24, v24, v121
    v_add_f32 v24, v24, v122
    v_add_f32 v24, v24, v123
    v_add_f32 v24, v24, v124
    v_add_f32 v24, v24, v125
    v_add_f32 v24, v24, v126
    v_add_f32 v24, v24, v127
    v_cvt_pk_bf16_f32 v104, v112, v113
    v_cvt_pk_bf16_f32 v105, v114, v115
    v_cvt_pk_bf16_f32 v106, v116, v117
    v_cvt_pk_bf16_f32 v107, v118, v119
    v_cvt_pk_bf16_f32 v108, v120, v121
    v_cvt_pk_bf16_f32 v109, v122, v123
    v_cvt_pk_bf16_f32 v110, v124, v125
    v_cvt_pk_bf16_f32 v111, v126, v127
    v_mul_f32 v128, v128, v30
    v_mul_f32 v129, v129, v30
    v_mul_f32 v130, v130, v30
    v_mul_f32 v131, v131, v30
    v_mul_f32 v132, v132, v31
    v_mul_f32 v133, v133, v31
    v_mul_f32 v134, v134, v31
    v_mul_f32 v135, v135, v31
    v_mul_f32 v136, v136, v30
    v_mul_f32 v137, v137, v30
    v_mul_f32 v138, v138, v30
    v_mul_f32 v139, v139, v30
    v_mul_f32 v140, v140, v31
    v_mul_f32 v141, v141, v31
    v_mul_f32 v142, v142, v31
    v_mul_f32 v143, v143, v31
    v_mul_f32 v144, v144, v30
    v_mul_f32 v145, v145, v30
    v_mul_f32 v146, v146, v30
    v_mul_f32 v147, v147, v30
    v_mul_f32 v148, v148, v31
    v_mul_f32 v149, v149, v31
    v_mul_f32 v150, v150, v31
    v_mul_f32 v151, v151, v31
    v_mul_f32 v152, v152, v30
    v_mul_f32 v153, v153, v30
    v_mul_f32 v154, v154, v30
    v_mul_f32 v155, v155, v30
    v_mul_f32 v156, v156, v31
    v_mul_f32 v157, v157, v31
    v_mul_f32 v158, v158, v31
    v_mul_f32 v159, v159, v31
    v_mul_f32 v160, v160, v30
    v_mul_f32 v161, v161, v30
    v_mul_f32 v162, v162, v30
    v_mul_f32 v163, v163, v30
    v_mul_f32 v164, v164, v31
    v_mul_f32 v165, v165, v31
    v_mul_f32 v166, v166, v31
    v_mul_f32 v167, v167, v31
    v_mul_f32 v168, v168, v30
    v_mul_f32 v169, v169, v30
    v_mul_f32 v170, v170, v30
    v_mul_f32 v171, v171, v30
    v_mul_f32 v172, v172, v31
    v_mul_f32 v173, v173, v31
    v_mul_f32 v174, v174, v31
    v_mul_f32 v175, v175, v31
    v_mul_f32 v176, v176, v30
    v_mul_f32 v177, v177, v30
    v_mul_f32 v178, v178, v30
    v_mul_f32 v179, v179, v30
    v_mul_f32 v180, v180, v31
    v_mul_f32 v181, v181, v31
    v_mul_f32 v182, v182, v31
    v_mul_f32 v183, v183, v31
    v_mul_f32 v184, v184, v30
    v_mul_f32 v185, v185, v30
    v_mul_f32 v186, v186, v30
    v_mul_f32 v187, v187, v30
    v_mul_f32 v188, v188, v31
    v_mul_f32 v189, v189, v31
    v_mul_f32 v190, v190, v31
    v_mul_f32 v191, v191, v31
    v_mul_f32 v192, v192, v30
    v_mul_f32 v193, v193, v30
    v_mul_f32 v194, v194, v30
    v_mul_f32 v195, v195, v30
    v_mul_f32 v196, v196, v31
    v_mul_f32 v197, v197, v31
    v_mul_f32 v198, v198, v31
    v_mul_f32 v199, v199, v31
    v_mul_f32 v200, v200, v30
    v_mul_f32 v201, v201, v30
    v_mul_f32 v202, v202, v30
    v_mul_f32 v203, v203, v30
    v_mul_f32 v204, v204, v31
    v_mul_f32 v205, v205, v31
    v_mul_f32 v206, v206, v31
    v_mul_f32 v207, v207, v31
    v_mul_f32 v208, v208, v30
    v_mul_f32 v209, v209, v30
    v_mul_f32 v210, v210, v30
    v_mul_f32 v211, v211, v30
    v_mul_f32 v212, v212, v31
    v_mul_f32 v213, v213, v31
    v_mul_f32 v214, v214, v31
    v_mul_f32 v215, v215, v31
    v_mul_f32 v216, v216, v30
    v_mul_f32 v217, v217, v30
    v_mul_f32 v218, v218, v30
    v_mul_f32 v219, v219, v30
    v_mul_f32 v220, v220, v31
    v_mul_f32 v221, v221, v31
    v_mul_f32 v222, v222, v31
    v_mul_f32 v223, v223, v31
    v_mul_f32 v224, v224, v30
    v_mul_f32 v225, v225, v30
    v_mul_f32 v226, v226, v30
    v_mul_f32 v227, v227, v30
    v_mul_f32 v228, v228, v31
    v_mul_f32 v229, v229, v31
    v_mul_f32 v230, v230, v31
    v_mul_f32 v231, v231, v31
    v_mul_f32 v232, v232, v30
    v_mul_f32 v233, v233, v30
    v_mul_f32 v234, v234, v30
    v_mul_f32 v235, v235, v30
    v_mul_f32 v236, v236, v31
    v_mul_f32 v237, v237, v31
    v_mul_f32 v238, v238, v31
    v_mul_f32 v239, v239, v31
    v_mul_f32 v240, v240, v30
    v_mul_f32 v241, v241, v30
    v_mul_f32 v242, v242, v30
    v_mul_f32 v243, v243, v30
    v_mul_f32 v244, v244, v31
    v_mul_f32 v245, v245, v31
    v_mul_f32 v246, v246, v31
    v_mul_f32 v247, v247, v31
    v_mul_f32 v248, v248, v30
    v_mul_f32 v249, v249, v30
    v_mul_f32 v250, v250, v30
    v_mul_f32 v251, v251, v30
    v_mul_f32 v252, v252, v31
    v_mul_f32 v253, v253, v31
    v_mul_f32 v254, v254, v31
    v_mul_f32 v255, v255, v31
    s_nop 1
    s_setpc_b64 s[40:41]
A_0:
    v_accvgpr_read_b32 v112, a0
    v_accvgpr_read_b32 v113, a1
    v_accvgpr_read_b32 v114, a2
    v_accvgpr_read_b32 v115, a3
    v_accvgpr_read_b32 v116, a4
    v_accvgpr_read_b32 v117, a5
    v_accvgpr_read_b32 v118, a6
    v_accvgpr_read_b32 v119, a7
    v_accvgpr_read_b32 v120, a8
    v_accvgpr_read_b32 v121, a9
    v_accvgpr_read_b32 v122, a10
    v_accvgpr_read_b32 v123, a11
    v_accvgpr_read_b32 v124, a12
    v_accvgpr_read_b32 v125, a13
    v_accvgpr_read_b32 v126, a14
    v_accvgpr_read_b32 v127, a15
    v_sub_f32 v112, v112, v26
    v_sub_f32 v113, v113, v26
    v_sub_f32 v114, v114, v26
    v_sub_f32 v115, v115, v26
    v_sub_f32 v116, v116, v26
    v_sub_f32 v117, v117, v26
    v_sub_f32 v118, v118, v26
    v_sub_f32 v119, v119, v26
    v_sub_f32 v120, v120, v28
    v_sub_f32 v121, v121, v28
    v_sub_f32 v122, v122, v28
    v_sub_f32 v123, v123, v28
    v_sub_f32 v124, v124, v28
    v_sub_f32 v125, v125, v28
    v_sub_f32 v126, v126, v28
    v_sub_f32 v127, v127, v28
    v_accvgpr_write_b32 a0, v112
    v_accvgpr_write_b32 a1, v113
    v_accvgpr_write_b32 a2, v114
    v_accvgpr_write_b32 a3, v115
    v_accvgpr_write_b32 a4, v116
    v_accvgpr_write_b32 a5, v117
    v_accvgpr_write_b32 a6, v118
    v_accvgpr_write_b32 a7, v119
    v_accvgpr_write_b32 a8, v120
    v_accvgpr_write_b32 a9, v121
    v_accvgpr_write_b32 a10, v122
    v_accvgpr_write_b32 a11, v123
    v_accvgpr_write_b32 a12, v124
    v_accvgpr_write_b32 a13, v125
    v_accvgpr_write_b32 a14, v126
    v_accvgpr_write_b32 a15, v127
A_1:
    v_accvgpr_read_b32 v112, a16
    v_accvgpr_read_b32 v113, a17
    v_accvgpr_read_b32 v114, a18
    v_accvgpr_read_b32 v115, a19
    v_accvgpr_read_b32 v116, a20
    v_accvgpr_read_b32 v117, a21
    v_accvgpr_read_b32 v118, a22
    v_accvgpr_read_b32 v119, a23
    v_accvgpr_read_b32 v120, a24
    v_accvgpr_read_b32 v121, a25
    v_accvgpr_read_b32 v122, a26
    v_accvgpr_read_b32 v123, a27
    v_accvgpr_read_b32 v124, a28
    v_accvgpr_read_b32 v125, a29
    v_accvgpr_read_b32 v126, a30
    v_accvgpr_read_b32 v127, a31
    v_sub_f32 v112, v112, v26
    v_sub_f32 v113, v113, v26
    v_sub_f32 v114, v114, v26
    v_sub_f32 v115, v115, v26
    v_sub_f32 v116, v116, v26
    v_sub_f32 v117, v117, v26
    v_sub_f32 v118, v118, v26
    v_sub_f32 v119, v119, v26
    v_sub_f32 v120, v120, v28
    v_sub_f32 v121, v121, v28
    v_sub_f32 v122, v122, v28
    v_sub_f32 v123, v123, v28
    v_sub_f32 v124, v124, v28
    v_sub_f32 v125, v125, v28
    v_sub_f32 v126, v126, v28
    v_sub_f32 v127, v127, v28
    v_accvgpr_write_b32 a16, v112
    v_accvgpr_write_b32 a17, v113
    v_accvgpr_write_b32 a18, v114
    v_accvgpr_write_b32 a19, v115
    v_accvgpr_write_b32 a20, v116
    v_accvgpr_write_b32 a21, v117
    v_accvgpr_write_b32 a22, v118
    v_accvgpr_write_b32 a23, v119
    v_accvgpr_write_b32 a24, v120
    v_accvgpr_write_b32 a25, v121
    v_accvgpr_write_b32 a26, v122
    v_accvgpr_write_b32 a27, v123
    v_accvgpr_write_b32 a28, v124
    v_accvgpr_write_b32 a29, v125
    v_accvgpr_write_b32 a30, v126
    v_accvgpr_write_b32 a31, v127
A_2:
    v_accvgpr_read_b32 v112, a32
    v_accvgpr_read_b32 v113, a33
    v_accvgpr_read_b32 v114, a34
    v_accvgpr_read_b32 v115, a35
    v_accvgpr_read_b32 v116, a36
    v_accvgpr_read_b32 v117, a37
    v_accvgpr_read_b32 v118, a38
    v_accvgpr_read_b32 v119, a39
    v_accvgpr_read_b32 v120, a40
    v_accvgpr_read_b32 v121, a41
    v_accvgpr_read_b32 v122, a42
    v_accvgpr_read_b32 v123, a43
    v_accvgpr_read_b32 v124, a44
    v_accvgpr_read_b32 v125, a45
    v_accvgpr_read_b32 v126, a46
    v_accvgpr_read_b32 v127, a47
    v_sub_f32 v112, v112, v26
    v_sub_f32 v113, v113, v26
    v_sub_f32 v114, v114, v26
    v_sub_f32 v115, v115, v26
    v_sub_f32 v116, v116, v26
    v_sub_f32 v117, v117, v26
    v_sub_f32 v118, v118, v26
    v_sub_f32 v119, v119, v26
    v_sub_f32 v120, v120, v28
    v_sub_f32 v121, v121, v28
    v_sub_f32 v122, v122, v28
    v_sub_f32 v123, v123, v28
    v_sub_f32 v124, v124, v28
    v_sub_f32 v125, v125, v28
    v_sub_f32 v126, v126, v28
    v_sub_f32 v127, v127, v28
    v_accvgpr_write_b32 a32, v112
    v_accvgpr_write_b32 a33, v113
    v_accvgpr_write_b32 a34, v114
    v_accvgpr_write_b32 a35, v115
    v_accvgpr_write_b32 a36, v116
    v_accvgpr_write_b32 a37, v117
    v_accvgpr_write_b32 a38, v118
    v_accvgpr_write_b32 a39, v119
    v_accvgpr_write_b32 a40, v120
    v_accvgpr_write_b32 a41, v121
    v_accvgpr_write_b32 a42, v122
    v_accvgpr_write_b32 a43, v123
    v_accvgpr_write_b32 a44, v124
    v_accvgpr_write_b32 a45, v125
    v_accvgpr_write_b32 a46, v126
    v_accvgpr_write_b32 a47, v127
A_3:
    v_accvgpr_read_b32 v112, a48
    v_accvgpr_read_b32 v113, a49
    v_accvgpr_read_b32 v114, a50
    v_accvgpr_read_b32 v115, a51
    v_accvgpr_read_b32 v116, a52
    v_accvgpr_read_b32 v117, a53
    v_accvgpr_read_b32 v118, a54
    v_accvgpr_read_b32 v119, a55
    v_accvgpr_read_b32 v120, a56
    v_accvgpr_read_b32 v121, a57
    v_accvgpr_read_b32 v122, a58
    v_accvgpr_read_b32 v123, a59
    v_accvgpr_read_b32 v124, a60
    v_accvgpr_read_b32 v125, a61
    v_accvgpr_read_b32 v126, a62
    v_accvgpr_read_b32 v127, a63
    v_sub_f32 v112, v112, v26
    v_sub_f32 v113, v113, v26
    v_sub_f32 v114, v114, v26
    v_sub_f32 v115, v115, v26
    v_sub_f32 v116, v116, v26
    v_sub_f32 v117, v117, v26
    v_sub_f32 v118, v118, v26
    v_sub_f32 v119, v119, v26
    v_sub_f32 v120, v120, v28
    v_sub_f32 v121, v121, v28
    v_sub_f32 v122, v122, v28
    v_sub_f32 v123, v123, v28
    v_sub_f32 v124, v124, v28
    v_sub_f32 v125, v125, v28
    v_sub_f32 v126, v126, v28
    v_sub_f32 v127, v127, v28
    v_accvgpr_write_b32 a48, v112
    v_accvgpr_write_b32 a49, v113
    v_accvgpr_write_b32 a50, v114
    v_accvgpr_write_b32 a51, v115
    v_accvgpr_write_b32 a52, v116
    v_accvgpr_write_b32 a53, v117
    v_accvgpr_write_b32 a54, v118
    v_accvgpr_write_b32 a55, v119
    v_accvgpr_write_b32 a56, v120
    v_accvgpr_write_b32 a57, v121
    v_accvgpr_write_b32 a58, v122
    v_accvgpr_write_b32 a59, v123
    v_accvgpr_write_b32 a60, v124
    v_accvgpr_write_b32 a61, v125
    v_accvgpr_write_b32 a62, v126
    v_accvgpr_write_b32 a63, v127
A_4:
    v_accvgpr_read_b32 v112, a64
    v_accvgpr_read_b32 v113, a65
    v_accvgpr_read_b32 v114, a66
    v_accvgpr_read_b32 v115, a67
    v_accvgpr_read_b32 v116, a68
    v_accvgpr_read_b32 v117, a69
    v_accvgpr_read_b32 v118, a70
    v_accvgpr_read_b32 v119, a71
    v_accvgpr_read_b32 v120, a72
    v_accvgpr_read_b32 v121, a73
    v_accvgpr_read_b32 v122, a74
    v_accvgpr_read_b32 v123, a75
    v_accvgpr_read_b32 v124, a76
    v_accvgpr_read_b32 v125, a77
    v_accvgpr_read_b32 v126, a78
    v_accvgpr_read_b32 v127, a79
    v_sub_f32 v112, v112, v26
    v_sub_f32 v113, v113, v26
    v_sub_f32 v114, v114, v26
    v_sub_f32 v115, v115, v26
    v_sub_f32 v116, v116, v26
    v_sub_f32 v117, v117, v26
    v_sub_f32 v118, v118, v26
    v_sub_f32 v119, v119, v26
    v_sub_f32 v120, v120, v28
    v_sub_f32 v121, v121, v28
    v_sub_f32 v122, v122, v28
    v_sub_f32 v123, v123, v28
    v_sub_f32 v124, v124, v28
    v_sub_f32 v125, v125, v28
    v_sub_f32 v126, v126, v28
    v_sub_f32 v127, v127, v28
    v_accvgpr_write_b32 a64, v112
    v_accvgpr_write_b32 a65, v113
    v_accvgpr_write_b32 a66, v114
    v_accvgpr_write_b32 a67, v115
    v_accvgpr_write_b32 a68, v116
    v_accvgpr_write_b32 a69, v117
    v_accvgpr_write_b32 a70, v118
    v_accvgpr_write_b32 a71, v119
    v_accvgpr_write_b32 a72, v120
    v_accvgpr_write_b32 a73, v121
    v_accvgpr_write_b32 a74, v122
    v_accvgpr_write_b32 a75, v123
    v_accvgpr_write_b32 a76, v124
    v_accvgpr_write_b32 a77, v125
    v_accvgpr_write_b32 a78, v126
    v_accvgpr_write_b32 a79, v127
A_5:
    v_accvgpr_read_b32 v112, a80
    v_accvgpr_read_b32 v113, a81
    v_accvgpr_read_b32 v114, a82
    v_accvgpr_read_b32 v115, a83
    v_accvgpr_read_b32 v116, a84
    v_accvgpr_read_b32 v117, a85
    v_accvgpr_read_b32 v118, a86
    v_accvgpr_read_b32 v119, a87
    v_accvgpr_read_b32 v120, a88
    v_accvgpr_read_b32 v121, a89
    v_accvgpr_read_b32 v122, a90
    v_accvgpr_read_b32 v123, a91
    v_accvgpr_read_b32 v124, a92
    v_accvgpr_read_b32 v125, a93
    v_accvgpr_read_b32 v126, a94
    v_accvgpr_read_b32 v127, a95
    v_sub_f32 v112, v112, v26
    v_sub_f32 v113, v113, v26
    v_sub_f32 v114, v114, v26
    v_sub_f32 v115, v115, v26
    v_sub_f32 v116, v116, v26
    v_sub_f32 v117, v117, v26
    v_sub_f32 v118, v118, v26
    v_sub_f32 v119, v119, v26
    v_sub_f32 v120, v120, v28
    v_sub_f32 v121, v121, v28
    v_sub_f32 v122, v122, v28
    v_sub_f32 v123, v123, v28
    v_sub_f32 v124, v124, v28
    v_sub_f32 v125, v125, v28
    v_sub_f32 v126, v126, v28
    v_sub_f32 v127, v127, v28
    v_accvgpr_write_b32 a80, v112
    v_accvgpr_write_b32 a81, v113
    v_accvgpr_write_b32 a82, v114
    v_accvgpr_write_b32 a83, v115
    v_accvgpr_write_b32 a84, v116
    v_accvgpr_write_b32 a85, v117
    v_accvgpr_write_b32 a86, v118
    v_accvgpr_write_b32 a87, v119
    v_accvgpr_write_b32 a88, v120
    v_accvgpr_write_b32 a89, v121
    v_accvgpr_write_b32 a90, v122
    v_accvgpr_write_b32 a91, v123
    v_accvgpr_write_b32 a92, v124
    v_accvgpr_write_b32 a93, v125
    v_accvgpr_write_b32 a94, v126
    v_accvgpr_write_b32 a95, v127
A_6:
    v_accvgpr_read_b32 v112, a96
    v_accvgpr_read_b32 v113, a97
    v_accvgpr_read_b32 v114, a98
    v_accvgpr_read_b32 v115, a99
    v_accvgpr_read_b32 v116, a100
    v_accvgpr_read_b32 v117, a101
    v_accvgpr_read_b32 v118, a102
    v_accvgpr_read_b32 v119, a103
    v_accvgpr_read_b32 v120, a104
    v_accvgpr_read_b32 v121, a105
    v_accvgpr_read_b32 v122, a106
    v_accvgpr_read_b32 v123, a107
    v_accvgpr_read_b32 v124, a108
    v_accvgpr_read_b32 v125, a109
    v_accvgpr_read_b32 v126, a110
    v_accvgpr_read_b32 v127, a111
    v_sub_f32 v112, v112, v26
    v_sub_f32 v113, v113, v26
    v_sub_f32 v114, v114, v26
    v_sub_f32 v115, v115, v26
    v_sub_f32 v116, v116, v26
    v_sub_f32 v117, v117, v26
    v_sub_f32 v118, v118, v26
    v_sub_f32 v119, v119, v26
    v_sub_f32 v120, v120, v28
    v_sub_f32 v121, v121, v28
    v_sub_f32 v122, v122, v28
    v_sub_f32 v123, v123, v28
    v_sub_f32 v124, v124, v28
    v_sub_f32 v125, v125, v28
    v_sub_f32 v126, v126, v28
    v_sub_f32 v127, v127, v28
    v_accvgpr_write_b32 a96, v112
    v_accvgpr_write_b32 a97, v113
    v_accvgpr_write_b32 a98, v114
    v_accvgpr_write_b32 a99, v115
    v_accvgpr_write_b32 a100, v116
    v_accvgpr_write_b32 a101, v117
    v_accvgpr_write_b32 a102, v118
    v_accvgpr_write_b32 a103, v119
    v_accvgpr_write_b32 a104, v120
    v_accvgpr_write_b32 a105, v121
    v_accvgpr_write_b32 a106, v122
    v_accvgpr_write_b32 a107, v123
    v_accvgpr_write_b32 a108, v124
    v_accvgpr_write_b32 a109, v125
    v_accvgpr_write_b32 a110, v126
    v_accvgpr_write_b32 a111, v127
A_7:
    v_accvgpr_read_b32 v112, a112
    v_accvgpr_read_b32 v113, a113
    v_accvgpr_read_b32 v114, a114
    v_accvgpr_read_b32 v115, a115
    v_accvgpr_read_b32 v116, a116
    v_accvgpr_read_b32 v117, a117
    v_accvgpr_read_b32 v118, a118
    v_accvgpr_read_b32 v119, a119
    v_accvgpr_read_b32 v120, a120
    v_accvgpr_read_b32 v121, a121
    v_accvgpr_read_b32 v122, a122
    v_accvgpr_read_b32 v123, a123
    v_accvgpr_read_b32 v124, a124
    v_accvgpr_read_b32 v125, a125
    v_accvgpr_read_b32 v126, a126
    v_accvgpr_read_b32 v127, a127
    v_sub_f32 v112, v112, v26
    v_sub_f32 v113, v113, v26
    v_sub_f32 v114, v114, v26
    v_sub_f32 v115, v115, v26
    v_sub_f32 v116, v116, v26
    v_sub_f32 v117, v117, v26
    v_sub_f32 v118, v118, v26
    v_sub_f32 v119, v119, v26
    v_sub_f32 v120, v120, v28
    v_sub_f32 v121, v121, v28
    v_sub_f32 v122, v122, v28
    v_sub_f32 v123, v123, v28
    v_sub_f32 v124, v124, v28
    v_sub_f32 v125, v125, v28
    v_sub_f32 v126, v126, v28
    v_sub_f32 v127, v127, v28
    v_accvgpr_write_b32 a112, v112
    v_accvgpr_write_b32 a113, v113
    v_accvgpr_write_b32 a114, v114
    v_accvgpr_write_b32 a115, v115
    v_accvgpr_write_b32 a116, v116
    v_accvgpr_write_b32 a117, v117
    v_accvgpr_write_b32 a118, v118
    v_accvgpr_write_b32 a119, v119
    v_accvgpr_write_b32 a120, v120
    v_accvgpr_write_b32 a121, v121
    v_accvgpr_write_b32 a122, v122
    v_accvgpr_write_b32 a123, v123
    v_accvgpr_write_b32 a124, v124
    v_accvgpr_write_b32 a125, v125
    v_accvgpr_write_b32 a126, v126
    v_accvgpr_write_b32 a127, v127
    s_nop 1
    s_setpc_b64 s[40:41]
    s_endpgm
.section .rodata,"a"
.p2align 6
.amdhsa_kernel concat_heads__gqa_block_cached__mha_block_cached__near_ridge_kernel
  .amdhsa_next_free_vgpr 512
  .amdhsa_next_free_sgpr 102
  .amdhsa_accum_offset 256
  .amdhsa_group_segment_fixed_size 0
  .amdhsa_kernarg_size 104
  .amdhsa_user_sgpr_count 2
  .amdhsa_user_sgpr_kernarg_segment_ptr 1
  .amdhsa_system_sgpr_workgroup_id_x 1
.end_amdhsa_kernel
```
